```python
import torch

def _softmax(x, axis=-1):
    return torch.softmax(x, dim=axis)
def _gelu(x):
    return torch.nn.functional.gelu(x, approximate="tanh")
def _silu(x):
    return torch.nn.functional.silu(x)
def _sigmoid(x):
    return torch.sigmoid(x)
def _layernorm(x, axis=-1, eps=1e-5):
    m = x.mean(dim=axis, keepdim=True)
    v = x.var(dim=axis, keepdim=True, unbiased=False)
    return (x - m) / torch.sqrt(v + eps)
def _scatter_add(tgt, idx, src, axis=0):
    return tgt.clone().index_add_(axis, idx, src)
def _segment_sum(src, seg, n):
    out = torch.zeros((n,) + src.shape[1:], dtype=src.dtype)
    return out.index_add_(0, seg, src)
def _pad(x, pw):
    flat = tuple(v for pair in reversed(pw) for v in pair)
    return torch.nn.functional.pad(x, flat)

kernel_name = 'standalone__convnext_block__vision'

def setup_inputs():

    _w = (lambda a: (lambda t: t.to(torch.bfloat16) if t.is_floating_point() else t)(torch.as_tensor(a)))
    H = W = 384
    C = 192
    return {
        "x": _w((lambda *s: torch.randn(*s, dtype=torch.bfloat16) * 0.05)(1, H, W, C)),
        "dw": _w((lambda *s: torch.randn(*s, dtype=torch.bfloat16) * 0.05)(7, 7, C)),
        "w1": _w((lambda *s: torch.randn(*s, dtype=torch.bfloat16) * 0.05)(C, 4 * C)),
        "w2": _w((lambda *s: torch.randn(*s, dtype=torch.bfloat16) * 0.05)(4 * C, C)),
    }

def reference(x, dw, w1, w2):
    B, H, W, C = x.shape
    pad = 3
    xp = _pad(x, ((0,0),(pad,pad),(pad,pad),(0,0)))
    out = torch.zeros_like(x)
    for i in range(7):
        for j in range(7):
            out = out + xp[:, i:i+H, j:j+W, :] * dw[i, j][None, None, None, :]
    h = _layernorm(out, axis=-1)
    return x + _gelu(h @ w1) @ w2
```

```asm
; @launch grid=(256,1,1) block=(512,1,1) lds=163840
.amdgcn_target "amdgcn-amd-amdhsa--gfx950"
.text
.globl standalone__convnext_block__vision_kernel
.p2align 8
.type standalone__convnext_block__vision_kernel,@function
standalone__convnext_block__vision_kernel:
  s_cmp_ge_u32 s2, 256
  s_cbranch_scc1 standalone__convnext_block__vision_kernel_end
  s_load_dwordx4 s[36:39], s[0:1], 0
  s_load_dwordx2 s[40:41], s[0:1], 32
  s_load_dwordx2 s[42:43], s[0:1], 48
  s_load_dwordx4 s[72:75], s[0:1], 16
  s_load_dwordx2 s[76:77], s[0:1], 40
  v_lshrrev_b32 v35, 6, v0
  v_and_b32 v32, 63, v0
  v_readfirstlane_b32 s3, v35
  v_and_b32 v33, 15, v32
  v_lshrrev_b32 v34, 4, v32
  v_lshlrev_b32 v1, 4, v32
  s_and_b32 s33, s3, 3
  s_lshr_b32 s35, s3, 2
  s_mov_b32 s26, 0x05040100
  s_mov_b32 s27, 0x07060302
  s_mov_b32 s29, 0xc09d30fc
  s_mov_b32 s30, 0x3eeff558
  s_mov_b32 s92, 0x44ea44ea
  s_mov_b32 s93, 0x37803780
  s_and_b32 s24, s2, 7
  s_lshl_b32 s24, s24, 5
  s_lshr_b32 s25, s2, 3
  s_add_u32 s24, s24, s25
  s_lshr_b32 s44, s24, 5
  s_mul_i32 s44, s44, 48
  s_bfe_u32 s25, s24, 0x10004
  s_lshl_b32 s25, s25, 3
  s_add_u32 s44, s44, s25
  s_and_b32 s45, s24, 15
  s_mul_i32 s45, s45, 24
  s_mul_i32 s58, s3, 7168
  s_mul_i32 s57, s3, 3072
  s_mul_i32 s59, s3, 2688
  s_cmp_eq_u32 s3, 7
  s_cselect_b32 s59, 0x100000, s59
  s_waitcnt lgkmcnt(0)
  s_mov_b32 s4, s36
  s_and_b32 s5, s37, 0xffff
  s_mov_b32 s6, 56623104
  s_mov_b32 s7, 0x00020000
  s_mov_b32 s16, s36
  s_and_b32 s17, s37, 0xffff
  s_mov_b32 s18, 56623104
  s_mov_b32 s19, 0x00020000
  s_mov_b32 s12, s38
  s_and_b32 s13, s39, 0xffff
  s_mov_b32 s14, 18816
  s_mov_b32 s15, 0x00020000
  s_mov_b32 s8, s42
  s_and_b32 s9, s43, 0xffff
  s_mov_b32 s10, 589824
  s_mov_b32 s11, 0x00020000
  s_mov_b32 s20, s40
  s_and_b32 s21, s41, 0xffff
  s_mov_b32 s22, 56623104
  s_mov_b32 s23, 0x00020000
  s_mov_b32 s22, 0
  s_lshl_b32 s50, s2, 3
  s_add_u32 s50, s50, s3
  s_mul_i32 s51, s50, 2731
  s_lshr_b32 s51, s51, 16
  s_mul_i32 s24, s51, 24
  s_sub_u32 s52, s50, s24
  s_cmp_ge_u32 s52, 12
  s_cbranch_scc1 standalone__convnext_block__vision_kernel_pw2
  s_mov_b32 s64, s72
  s_and_b32 s65, s73, 0xffff
  s_mov_b32 s66, 294912
  s_mov_b32 s67, 0x00020000
  s_add_u32 s53, s51, 1
  s_cmp_eq_u32 s53, 24
  s_cselect_b32 s53, 0, s53
  s_cmp_ge_u32 s52, 6
  s_cselect_b32 s24, 1, 0
  s_mul_i32 s25, s24, 6
  s_sub_u32 s25, s52, s25
  s_mul_i32 s25, s25, 49152
  s_lshl_b32 s24, s24, 5
  s_add_u32 s25, s25, s24
  s_lshl_b32 s24, s53, 6
  s_add_u32 s68, s25, s24
  v_mul_u32_u24 v35, 12288, v34
  v_lshl_add_u32 v35, v33, 1, v35
  s_mov_b32 s69, 1536
  s_mov_b32 s70, 1536
  s_branch standalone__convnext_block__vision_kernel_pst
standalone__convnext_block__vision_kernel_pw2:
  s_mov_b32 s64, s74
  s_and_b32 s65, s75, 0xffff
  s_mov_b32 s66, 294912
  s_mov_b32 s67, 0x00020000
  s_add_u32 s53, s51, 23
  s_cmp_ge_u32 s53, 24
  s_cselect_b32 s24, 24, 0
  s_sub_u32 s53, s53, s24
  s_sub_u32 s24, s52, 12
  s_lshr_b32 s25, s24, 1
  s_lshl_b32 s25, s25, 6
  s_and_b32 s24, s24, 1
  s_lshl_b32 s24, s24, 3
  s_add_u32 s25, s25, s24
  s_mul_i32 s24, s53, 12288
  s_add_u32 s68, s25, s24
  v_lshrrev_b32 v36, 2, v33
  v_and_b32 v37, 3, v33
  v_lshl_add_u32 v36, v36, 3, v37
  v_mul_u32_u24 v35, 1536, v34
  v_lshl_add_u32 v35, v36, 1, v35
  s_mov_b32 s69, 384
  s_mov_b32 s70, 4992
standalone__convnext_block__vision_kernel_pst:
  s_cmp_lt_u32 s50, 576
  s_cselect_b32 s66, s66, 0
  buffer_load_ushort v60, v35, s[64:67], s68 offen
  s_add_u32 s68, s68, s69
  buffer_load_ushort v61, v35, s[64:67], s68 offen
  s_add_u32 s68, s68, s69
  buffer_load_ushort v62, v35, s[64:67], s68 offen
  s_add_u32 s68, s68, s69
  buffer_load_ushort v63, v35, s[64:67], s68 offen
  s_add_u32 s68, s68, s70
  buffer_load_ushort v64, v35, s[64:67], s68 offen
  s_add_u32 s68, s68, s69
  buffer_load_ushort v65, v35, s[64:67], s68 offen
  s_add_u32 s68, s68, s69
  buffer_load_ushort v66, v35, s[64:67], s68 offen
  s_add_u32 s68, s68, s69
  buffer_load_ushort v67, v35, s[64:67], s68 offen
  s_mov_b32 s80, s76
  s_and_b32 s81, s77, 0xffff
  s_mov_b32 s82, 256
  s_mov_b32 s83, 0x00020000
  s_mov_b32 s84, s76
  s_and_b32 s85, s77, 0xffff
  s_mov_b32 s86, 256
  s_mov_b32 s87, 0x00020000
  s_cmp_lt_u32 s2, 72
  s_cselect_b32 s86, s86, 0
  s_mov_b32 s88, s42
  s_and_b32 s89, s43, 0xffff
  s_mov_b32 s90, 589824
  s_mov_b32 s91, 0x00020000
  s_cmp_lt_u32 s2, 72
  s_cselect_b32 s90, s90, 0
  s_mov_b32 s32, s44
  s_sub_u32 s31, s32, 3
  s_mul_i32 s31, s31, 384
  s_add_u32 s31, s31, s45
  s_sub_u32 s31, s31, 3
  s_mul_i32 s31, s31, 384
  s_mul_i32 s24, s3, 448
  s_sub_u32 s25, s45, 3
  v_add_u32 v35, s24, v32
  v_mul_u32_u24 v36, 4370, v35
  v_lshrrev_b32 v36, 20, v36
  v_mul_u32_u24 v37, 240, v36
  v_sub_u32 v37, v35, v37
  v_lshrrev_b32 v38, 3, v37
  v_and_b32 v37, 7, v37
  v_cmp_le_u32 vcc, 15, v38
  v_mov_b32 v40, 0
  s_nop 0
  v_addc_co_u32 v40, vcc, 0, v40, vcc
  v_mul_u32_u24 v39, 15, v40
  v_sub_u32 v39, v38, v39
  v_lshrrev_b32 v38, 1, v39
  v_sub_u32 v37, v37, v38
  v_and_b32 v37, 7, v37
  v_lshl_add_u32 v39, v39, 1, v40
  s_mov_b32 s28, 147456
  v_mul_lo_u32 v2, v36, s28
  v_mul_u32_u24 v41, 384, v39
  v_add_u32 v2, v2, v41
  v_lshl_add_u32 v2, v37, 4, v2
  v_add_u32 v41, s25, v39
  v_cmp_gt_u32 vcc, 384, v41
  s_movk_i32 s28, 3360
  v_cmp_gt_u32 s[48:49], s28, v35
  s_nop 1
  s_and_b64 vcc, vcc, s[48:49]
  v_mov_b32 v41, 0x40000000
  s_nop 0
  v_cndmask_b32 v2, v41, v2, vcc
  s_add_u32 m0, s58, 98304
  v_add_u32 v30, s31, v2
  buffer_load_dwordx4 v30, s[4:7], 0 offen lds
  v_add_u32 v35, s24, v32
  v_add_u32 v35, 64, v35
  v_mul_u32_u24 v36, 4370, v35
  v_lshrrev_b32 v36, 20, v36
  v_mul_u32_u24 v37, 240, v36
  v_sub_u32 v37, v35, v37
  v_lshrrev_b32 v38, 3, v37
  v_and_b32 v37, 7, v37
  v_cmp_le_u32 vcc, 15, v38
  v_mov_b32 v40, 0
  s_nop 0
  v_addc_co_u32 v40, vcc, 0, v40, vcc
  v_mul_u32_u24 v39, 15, v40
  v_sub_u32 v39, v38, v39
  v_lshrrev_b32 v38, 1, v39
  v_sub_u32 v37, v37, v38
  v_and_b32 v37, 7, v37
  v_lshl_add_u32 v39, v39, 1, v40
  s_mov_b32 s28, 147456
  v_mul_lo_u32 v3, v36, s28
  v_mul_u32_u24 v41, 384, v39
  v_add_u32 v3, v3, v41
  v_lshl_add_u32 v3, v37, 4, v3
  v_add_u32 v41, s25, v39
  v_cmp_gt_u32 vcc, 384, v41
  s_movk_i32 s28, 3360
  v_cmp_gt_u32 s[48:49], s28, v35
  s_nop 1
  s_and_b64 vcc, vcc, s[48:49]
  v_mov_b32 v41, 0x40000000
  s_nop 0
  v_cndmask_b32 v3, v41, v3, vcc
  s_add_u32 m0, s58, 99328
  v_add_u32 v30, s31, v3
  buffer_load_dwordx4 v30, s[4:7], 0 offen lds
  v_add_u32 v35, s24, v32
  v_add_u32 v35, 128, v35
  v_mul_u32_u24 v36, 4370, v35
  v_lshrrev_b32 v36, 20, v36
  v_mul_u32_u24 v37, 240, v36
  v_sub_u32 v37, v35, v37
  v_lshrrev_b32 v38, 3, v37
  v_and_b32 v37, 7, v37
  v_cmp_le_u32 vcc, 15, v38
  v_mov_b32 v40, 0
  s_nop 0
  v_addc_co_u32 v40, vcc, 0, v40, vcc
  v_mul_u32_u24 v39, 15, v40
  v_sub_u32 v39, v38, v39
  v_lshrrev_b32 v38, 1, v39
  v_sub_u32 v37, v37, v38
  v_and_b32 v37, 7, v37
  v_lshl_add_u32 v39, v39, 1, v40
  s_mov_b32 s28, 147456
  v_mul_lo_u32 v4, v36, s28
  v_mul_u32_u24 v41, 384, v39
  v_add_u32 v4, v4, v41
  v_lshl_add_u32 v4, v37, 4, v4
  v_add_u32 v41, s25, v39
  v_cmp_gt_u32 vcc, 384, v41
  s_movk_i32 s28, 3360
  v_cmp_gt_u32 s[48:49], s28, v35
  s_nop 1
  s_and_b64 vcc, vcc, s[48:49]
  v_mov_b32 v41, 0x40000000
  s_nop 0
  v_cndmask_b32 v4, v41, v4, vcc
  s_add_u32 m0, s58, 100352
  v_add_u32 v30, s31, v4
  buffer_load_dwordx4 v30, s[4:7], 0 offen lds
  v_add_u32 v35, s24, v32
  v_add_u32 v35, 192, v35
  v_mul_u32_u24 v36, 4370, v35
  v_lshrrev_b32 v36, 20, v36
  v_mul_u32_u24 v37, 240, v36
  v_sub_u32 v37, v35, v37
  v_lshrrev_b32 v38, 3, v37
  v_and_b32 v37, 7, v37
  v_cmp_le_u32 vcc, 15, v38
  v_mov_b32 v40, 0
  s_nop 0
  v_addc_co_u32 v40, vcc, 0, v40, vcc
  v_mul_u32_u24 v39, 15, v40
  v_sub_u32 v39, v38, v39
  v_lshrrev_b32 v38, 1, v39
  v_sub_u32 v37, v37, v38
  v_and_b32 v37, 7, v37
  v_lshl_add_u32 v39, v39, 1, v40
  s_mov_b32 s28, 147456
  v_mul_lo_u32 v5, v36, s28
  v_mul_u32_u24 v41, 384, v39
  v_add_u32 v5, v5, v41
  v_lshl_add_u32 v5, v37, 4, v5
  v_add_u32 v41, s25, v39
  v_cmp_gt_u32 vcc, 384, v41
  s_movk_i32 s28, 3360
  v_cmp_gt_u32 s[48:49], s28, v35
  s_nop 1
  s_and_b64 vcc, vcc, s[48:49]
  v_mov_b32 v41, 0x40000000
  s_nop 0
  v_cndmask_b32 v5, v41, v5, vcc
  s_add_u32 m0, s58, 101376
  v_add_u32 v30, s31, v5
  buffer_load_dwordx4 v30, s[4:7], 0 offen lds
  v_add_u32 v35, s24, v32
  v_add_u32 v35, 256, v35
  v_mul_u32_u24 v36, 4370, v35
  v_lshrrev_b32 v36, 20, v36
  v_mul_u32_u24 v37, 240, v36
  v_sub_u32 v37, v35, v37
  v_lshrrev_b32 v38, 3, v37
  v_and_b32 v37, 7, v37
  v_cmp_le_u32 vcc, 15, v38
  v_mov_b32 v40, 0
  s_nop 0
  v_addc_co_u32 v40, vcc, 0, v40, vcc
  v_mul_u32_u24 v39, 15, v40
  v_sub_u32 v39, v38, v39
  v_lshrrev_b32 v38, 1, v39
  v_sub_u32 v37, v37, v38
  v_and_b32 v37, 7, v37
  v_lshl_add_u32 v39, v39, 1, v40
  s_mov_b32 s28, 147456
  v_mul_lo_u32 v6, v36, s28
  v_mul_u32_u24 v41, 384, v39
  v_add_u32 v6, v6, v41
  v_lshl_add_u32 v6, v37, 4, v6
  v_add_u32 v41, s25, v39
  v_cmp_gt_u32 vcc, 384, v41
  s_movk_i32 s28, 3360
  v_cmp_gt_u32 s[48:49], s28, v35
  s_nop 1
  s_and_b64 vcc, vcc, s[48:49]
  v_mov_b32 v41, 0x40000000
  s_nop 0
  v_cndmask_b32 v6, v41, v6, vcc
  s_add_u32 m0, s58, 102400
  v_add_u32 v30, s31, v6
  buffer_load_dwordx4 v30, s[4:7], 0 offen lds
  v_add_u32 v35, s24, v32
  v_add_u32 v35, 320, v35
  v_mul_u32_u24 v36, 4370, v35
  v_lshrrev_b32 v36, 20, v36
  v_mul_u32_u24 v37, 240, v36
  v_sub_u32 v37, v35, v37
  v_lshrrev_b32 v38, 3, v37
  v_and_b32 v37, 7, v37
  v_cmp_le_u32 vcc, 15, v38
  v_mov_b32 v40, 0
  s_nop 0
  v_addc_co_u32 v40, vcc, 0, v40, vcc
  v_mul_u32_u24 v39, 15, v40
  v_sub_u32 v39, v38, v39
  v_lshrrev_b32 v38, 1, v39
  v_sub_u32 v37, v37, v38
  v_and_b32 v37, 7, v37
  v_lshl_add_u32 v39, v39, 1, v40
  s_mov_b32 s28, 147456
  v_mul_lo_u32 v7, v36, s28
  v_mul_u32_u24 v41, 384, v39
  v_add_u32 v7, v7, v41
  v_lshl_add_u32 v7, v37, 4, v7
  v_add_u32 v41, s25, v39
  v_cmp_gt_u32 vcc, 384, v41
  s_movk_i32 s28, 3360
  v_cmp_gt_u32 s[48:49], s28, v35
  s_nop 1
  s_and_b64 vcc, vcc, s[48:49]
  v_mov_b32 v41, 0x40000000
  s_nop 0
  v_cndmask_b32 v7, v41, v7, vcc
  s_add_u32 m0, s58, 103424
  v_add_u32 v30, s31, v7
  buffer_load_dwordx4 v30, s[4:7], 0 offen lds
  v_add_u32 v35, s24, v32
  v_add_u32 v35, 384, v35
  v_mul_u32_u24 v36, 4370, v35
  v_lshrrev_b32 v36, 20, v36
  v_mul_u32_u24 v37, 240, v36
  v_sub_u32 v37, v35, v37
  v_lshrrev_b32 v38, 3, v37
  v_and_b32 v37, 7, v37
  v_cmp_le_u32 vcc, 15, v38
  v_mov_b32 v40, 0
  s_nop 0
  v_addc_co_u32 v40, vcc, 0, v40, vcc
  v_mul_u32_u24 v39, 15, v40
  v_sub_u32 v39, v38, v39
  v_lshrrev_b32 v38, 1, v39
  v_sub_u32 v37, v37, v38
  v_and_b32 v37, 7, v37
  v_lshl_add_u32 v39, v39, 1, v40
  s_mov_b32 s28, 147456
  v_mul_lo_u32 v8, v36, s28
  v_mul_u32_u24 v41, 384, v39
  v_add_u32 v8, v8, v41
  v_lshl_add_u32 v8, v37, 4, v8
  v_add_u32 v41, s25, v39
  v_cmp_gt_u32 vcc, 384, v41
  s_movk_i32 s28, 3360
  v_cmp_gt_u32 s[48:49], s28, v35
  s_nop 1
  s_and_b64 vcc, vcc, s[48:49]
  v_mov_b32 v41, 0x40000000
  s_nop 0
  v_cndmask_b32 v8, v41, v8, vcc
  s_add_u32 m0, s58, 104448
  v_add_u32 v30, s31, v8
  buffer_load_dwordx4 v30, s[4:7], 0 offen lds
  v_lshrrev_b32 v30, 3, v1
  s_add_u32 s71, s59, 0
  buffer_load_ushort v104, v30, s[12:15], s71 offen offset:0
  buffer_load_ushort v105, v30, s[12:15], s71 offen offset:384
  buffer_load_ushort v106, v30, s[12:15], s71 offen offset:768
  buffer_load_ushort v107, v30, s[12:15], s71 offen offset:1152
  buffer_load_ushort v108, v30, s[12:15], s71 offen offset:1536
  buffer_load_ushort v109, v30, s[12:15], s71 offen offset:1920
  buffer_load_ushort v110, v30, s[12:15], s71 offen offset:2304
  s_add_u32 s71, s59, 128
  buffer_load_ushort v112, v30, s[12:15], s71 offen offset:0
  buffer_load_ushort v113, v30, s[12:15], s71 offen offset:384
  buffer_load_ushort v114, v30, s[12:15], s71 offen offset:768
  buffer_load_ushort v115, v30, s[12:15], s71 offen offset:1152
  buffer_load_ushort v116, v30, s[12:15], s71 offen offset:1536
  buffer_load_ushort v117, v30, s[12:15], s71 offen offset:1920
  buffer_load_ushort v118, v30, s[12:15], s71 offen offset:2304
  s_add_u32 s71, s59, 256
  buffer_load_ushort v248, v30, s[12:15], s71 offen offset:0
  buffer_load_ushort v249, v30, s[12:15], s71 offen offset:384
  buffer_load_ushort v250, v30, s[12:15], s71 offen offset:768
  buffer_load_ushort v251, v30, s[12:15], s71 offen offset:1152
  buffer_load_ushort v252, v30, s[12:15], s71 offen offset:1536
  buffer_load_ushort v253, v30, s[12:15], s71 offen offset:1920
  buffer_load_ushort v254, v30, s[12:15], s71 offen offset:2304
  s_sub_u32 s31, s32, 3
  s_mul_i32 s31, s31, 384
  s_add_u32 s31, s31, s45
  s_sub_u32 s31, s31, 3
  s_mul_i32 s31, s31, 384
  s_add_u32 s31, s31, 128
  s_add_u32 m0, s58, 0
  v_add_u32 v30, s31, v2
  buffer_load_dwordx4 v30, s[4:7], 0 offen lds
  s_add_u32 m0, s58, 1024
  v_add_u32 v31, s31, v3
  buffer_load_dwordx4 v31, s[4:7], 0 offen lds
  s_add_u32 m0, s58, 2048
  v_add_u32 v30, s31, v4
  buffer_load_dwordx4 v30, s[4:7], 0 offen lds
  s_add_u32 m0, s58, 3072
  v_add_u32 v31, s31, v5
  buffer_load_dwordx4 v31, s[4:7], 0 offen lds
  s_add_u32 m0, s58, 4096
  v_add_u32 v30, s31, v6
  buffer_load_dwordx4 v30, s[4:7], 0 offen lds
  s_add_u32 m0, s58, 5120
  v_add_u32 v31, s31, v7
  buffer_load_dwordx4 v31, s[4:7], 0 offen lds
  s_add_u32 m0, s58, 6144
  v_add_u32 v30, s31, v8
  buffer_load_dwordx4 v30, s[4:7], 0 offen lds
  s_waitcnt vmcnt(35)
  v_lshl_or_b32 v68, v61, 16, v60
  v_lshl_or_b32 v69, v63, 16, v62
  v_lshl_or_b32 v70, v65, 16, v64
  v_lshl_or_b32 v71, v67, 16, v66
  s_mul_i32 s24, s51, 24576
  s_lshl_b32 s25, s52, 10
  s_add_u32 s24, s24, s25
  buffer_store_dwordx4 v[68:71], v1, s[88:91], s24 offen sc1
  s_mul_i32 s24, s3, 53
  v_add_u32 v35, s24, v32
  v_mul_u32_u24 v36, 2185, v35
  v_lshrrev_b32 v36, 16, v36
  v_mul_u32_u24 v37, 30, v36
  v_sub_u32 v37, v35, v37
  s_mov_b32 s28, 147456
  v_mul_lo_u32 v38, v36, s28
  v_mul_u32_u24 v39, 384, v37
  v_add_u32 v38, v38, v39
  s_sub_u32 s25, s45, 3
  v_add_u32 v39, s25, v37
  v_cmp_gt_u32 vcc, 384, v39
  s_movk_i32 s28, 420
  v_cmp_gt_u32 s[48:49], s28, v35
  s_nop 1
  s_and_b64 vcc, vcc, s[48:49]
  v_cmp_gt_u32 s[48:49], 53, v32
  s_nop 1
  s_and_b64 vcc, vcc, s[48:49]
  v_mov_b32 v39, 0x40000000
  s_nop 0
  v_cndmask_b32 v0, v39, v38, vcc
  v_lshrrev_b32 v35, 1, v33
  v_add_u32 v35, s3, v35
  v_and_b32 v35, 7, v35
  v_lshlrev_b32 v35, 4, v35
  v_lshl_add_u32 v35, v33, 7, v35
  v_mul_u32_u24 v36, 3840, v34
  v_add_u32 v9, v35, v36
  v_add_u32 v36, 12, v34
  v_min_u32 v36, 13, v36
  v_mul_u32_u24 v36, 3840, v36
  v_add_u32 v10, v35, v36
  v_lshrrev_b32 v35, 1, v33
  v_and_b32 v36, 1, v33
  v_sub_u32 v35, v34, v35
  s_mul_i32 s24, s3, 1920
  s_add_u32 s24, s24, 57344
  v_add_u32 v37, 0, v35
  v_lshl_add_u32 v38, v37, 1, v36
  v_cmp_gt_u32 vcc, 7, v37
  v_mov_b32 v39, 14
  s_nop 0
  v_cndmask_b32 v38, v39, v38, vcc
  v_lshlrev_b32 v38, 4, v38
  v_add_u32 v11, s24, v38
  v_add_u32 v37, 4, v35
  v_lshl_add_u32 v38, v37, 1, v36
  v_cmp_gt_u32 vcc, 7, v37
  v_mov_b32 v39, 14
  s_nop 0
  v_cndmask_b32 v38, v39, v38, vcc
  v_lshlrev_b32 v38, 4, v38
  v_add_u32 v12, s24, v38
  v_add_u32 v37, 8, v35
  v_lshl_add_u32 v38, v37, 1, v36
  v_cmp_gt_u32 vcc, 7, v37
  v_mov_b32 v39, 14
  s_nop 0
  v_cndmask_b32 v38, v39, v38, vcc
  v_lshlrev_b32 v38, 4, v38
  v_add_u32 v13, s24, v38
  v_add_u32 v37, 12, v35
  v_lshl_add_u32 v38, v37, 1, v36
  v_cmp_gt_u32 vcc, 7, v37
  v_mov_b32 v39, 14
  s_nop 0
  v_cndmask_b32 v38, v39, v38, vcc
  v_lshlrev_b32 v38, 4, v38
  v_add_u32 v14, s24, v38
  v_mul_u32_u24 v35, 12, v34
  v_add_u32 v35, v35, v33
  v_lshrrev_b32 v36, 4, v35
  v_and_b32 v35, 15, v35
  v_lshlrev_b32 v35, 4, v35
  v_lshl_add_u32 v35, v36, 10, v35
  s_mul_i32 s24, s35, 3072
  s_lshl_b32 s25, s33, 8
  s_add_u32 s24, s24, s25
  s_add_u32 s24, s24, 73728
  v_add_u32 v15, s24, v35
  v_cmp_gt_u32 s[60:61], 12, v33
  s_mul_i32 s24, s35, 6144
  v_add_u32 v16, s24, v1
  v_add_u32 v17, 49152, v16
  s_mul_i32 s24, s33, 3072
  s_add_u32 s24, s24, 73728
  v_add_u32 v18, s24, v1
  s_lshl_b32 s25, s35, 3
  v_add_u32 v19, s25, v18
  v_add_u32 v20, s57, v1
  s_lshr_b32 s24, s33, 1
  s_add_u32 s46, s44, s24
  s_and_b32 s24, s33, 1
  s_add_u32 s47, s45, s24
  s_mul_i32 s28, s35, 192
  v_add_u32 v35, 0, v33
  v_mul_u32_u24 v36, 43, v35
  v_lshrrev_b32 v36, 9, v36
  v_mul_u32_u24 v37, 12, v36
  v_sub_u32 v37, v35, v37
  v_lshl_add_u32 v36, v36, 1, s46
  v_lshl_add_u32 v37, v37, 1, s47
  v_mul_u32_u24 v36, 384, v36
  v_add_u32 v36, v36, v37
  v_mul_u32_u24 v36, 384, v36
  v_lshl_add_u32 v36, v34, 4, v36
  v_add_u32 v21, s28, v36
  v_add_u32 v35, 16, v33
  v_mul_u32_u24 v36, 43, v35
  v_lshrrev_b32 v36, 9, v36
  v_mul_u32_u24 v37, 12, v36
  v_sub_u32 v37, v35, v37
  v_lshl_add_u32 v36, v36, 1, s46
  v_lshl_add_u32 v37, v37, 1, s47
  v_mul_u32_u24 v36, 384, v36
  v_add_u32 v36, v36, v37
  v_mul_u32_u24 v36, 384, v36
  v_lshl_add_u32 v36, v34, 4, v36
  v_add_u32 v22, s28, v36
  v_add_u32 v35, 32, v33
  v_mul_u32_u24 v36, 43, v35
  v_lshrrev_b32 v36, 9, v36
  v_mul_u32_u24 v37, 12, v36
  v_sub_u32 v37, v35, v37
  v_lshl_add_u32 v36, v36, 1, s46
  v_lshl_add_u32 v37, v37, 1, s47
  v_mul_u32_u24 v36, 384, v36
  v_add_u32 v36, v36, v37
  v_mul_u32_u24 v36, 384, v36
  v_lshl_add_u32 v36, v34, 4, v36
  v_add_u32 v23, s28, v36
  v_lshrrev_b32 v35, 2, v33
  v_and_b32 v36, 3, v33
  v_and_b32 v37, 1, v36
  v_lshlrev_b32 v37, 4, v37
  v_mov_b32 v38, 0x3f80
  v_lshlrev_b32 v38, v37, v38
  v_cmp_eq_u32 vcc, v35, v34
  v_mov_b32 v37, 0
  s_nop 0
  v_cndmask_b32 v38, v37, v38, vcc
  v_cmp_gt_u32 vcc, 2, v36
  s_nop 1
  v_cndmask_b32 v26, v37, v38, vcc
  v_cndmask_b32 v27, v38, v37, vcc
  v_mov_b32 v24, 0
  v_mov_b32 v25, 0
  v_mov_b32 v28, 0
  v_mov_b32 v29, 0
  s_waitcnt vmcnt(8)
  v_lshl_or_b32 v44, v105, 16, v104
  v_lshl_or_b32 v45, v107, 16, v106
  v_lshl_or_b32 v46, v109, 16, v108
  v_mov_b32 v47, v110
  v_lshlrev_b32 v48, 16, v104
  v_lshl_or_b32 v49, v106, 16, v105
  v_lshl_or_b32 v50, v108, 16, v107
  v_lshl_or_b32 v51, v110, 16, v109
  v_mul_u32_u24 v30, 15, v1
  s_lshl_b32 s24, s3, 5
  s_add_u32 s24, s24, 73728
  v_add_u32 v30, s24, v30
  s_cmp_eq_u32 s3, 7
  s_cselect_b32 s24, 0, 16
  v_add_u32 v31, s24, v30
  ds_write_b128 v30, v[44:47]
  ds_write_b128 v31, v[48:51]
  v_lshl_or_b32 v52, v113, 16, v112
  v_lshl_or_b32 v53, v115, 16, v114
  v_lshl_or_b32 v54, v117, 16, v116
  v_mov_b32 v55, v118
  v_lshlrev_b32 v56, 16, v112
  v_lshl_or_b32 v57, v114, 16, v113
  v_lshl_or_b32 v58, v116, 16, v115
  v_lshl_or_b32 v59, v118, 16, v117
  v_mul_u32_u24 v30, 15, v1
  s_lshl_b32 s24, s3, 5
  s_add_u32 s24, s24, 57344
  v_add_u32 v30, s24, v30
  s_cmp_eq_u32 s3, 7
  s_cselect_b32 s24, 0, 16
  v_add_u32 v31, s24, v30
  ds_write_b128 v30, v[52:55]
  ds_write_b128 v31, v[56:59]
  s_mul_i32 s24, s33, 3072
  s_cmp_eq_u32 s35, 0
  s_cselect_b32 s78, 49152, 0
  s_cselect_b32 s79, 565248, 0
  s_add_u32 s78, s78, s24
  s_add_u32 s79, s79, s24
  s_mul_i32 s100, s3, 7
  s_sub_u32 s100, 48, s100
  s_mov_b32 s95, 12288
  s_mov_b32 s56, 0
  s_mov_b32 s54, 0
  s_mov_b32 s55, 0
  s_waitcnt lgkmcnt(0)
  s_barrier
.p2align 6
standalone__convnext_block__vision_kernel_L:
  v_add_u32 v30, 98304, v9
  v_add_u32 v31, 98304, v10
  ds_read_b128 v[160:163], v30 offset:0
  ds_read_b128 v[164:167], v30 offset:1920
  ds_read_b128 v[180:183], v11 offset:16384
  ds_read_b128 v[188:191], v11 offset:16624
  ds_read_b128 v[196:199], v11 offset:16864
  ds_read_b128 v[168:171], v30 offset:15360
  ds_read_b128 v[172:175], v30 offset:17280
  s_setprio 3
  s_waitcnt lgkmcnt(5)
  v_perm_b32 v128, v164, v160, s26
  v_perm_b32 v132, v164, v160, s27
  v_perm_b32 v136, v165, v161, s26
  v_perm_b32 v140, v165, v161, s27
  v_perm_b32 v144, v166, v162, s26
  v_perm_b32 v148, v166, v162, s27
  v_perm_b32 v152, v167, v163, s26
  v_perm_b32 v156, v167, v163, s27
  ds_read_b128 v[160:163], v30 offset:30720
  ds_read_b128 v[164:167], v30 offset:32640
  v_mov_b32_dpp v129, v128 row_shl:1 row_mask:0xf bank_mask:0xf bound_ctrl:1
  v_mov_b32_dpp v130, v128 row_shl:2 row_mask:0xf bank_mask:0xf bound_ctrl:1
  v_mov_b32_dpp v131, v128 row_shl:3 row_mask:0xf bank_mask:0xf bound_ctrl:1
  v_mov_b32_dpp v133, v132 row_shl:1 row_mask:0xf bank_mask:0xf bound_ctrl:1
  v_mov_b32_dpp v134, v132 row_shl:2 row_mask:0xf bank_mask:0xf bound_ctrl:1
  v_mov_b32_dpp v135, v132 row_shl:3 row_mask:0xf bank_mask:0xf bound_ctrl:1
  s_waitcnt lgkmcnt(6)
  v_mfma_f32_16x16x32_bf16 v[32:35], v[180:183], v[128:131], 0
  ds_read_b128 v[204:207], v11 offset:17104
  buffer_store_dwordx4 v[176:179], v21, s[20:23], s54 offen offset:0 sc1
  v_mov_b32_dpp v137, v136 row_shl:1 row_mask:0xf bank_mask:0xf bound_ctrl:1
  v_mov_b32_dpp v138, v136 row_shl:2 row_mask:0xf bank_mask:0xf bound_ctrl:1
  v_mov_b32_dpp v139, v136 row_shl:3 row_mask:0xf bank_mask:0xf bound_ctrl:1
  s_waitcnt lgkmcnt(6)
  v_mfma_f32_16x16x32_bf16 v[36:39], v[188:191], v[132:135], 0
  ds_read_b128 v[180:183], v11 offset:17344
  v_mov_b32_dpp v141, v140 row_shl:1 row_mask:0xf bank_mask:0xf bound_ctrl:1
  v_mov_b32_dpp v142, v140 row_shl:2 row_mask:0xf bank_mask:0xf bound_ctrl:1
  v_mov_b32_dpp v143, v140 row_shl:3 row_mask:0xf bank_mask:0xf bound_ctrl:1
  s_waitcnt lgkmcnt(6)
  v_mfma_f32_16x16x32_bf16 v[40:43], v[196:199], v[136:139], 0
  ds_read_b128 v[188:191], v11 offset:17584
  v_mov_b32_dpp v145, v144 row_shl:1 row_mask:0xf bank_mask:0xf bound_ctrl:1
  v_mov_b32_dpp v146, v144 row_shl:2 row_mask:0xf bank_mask:0xf bound_ctrl:1
  v_mov_b32_dpp v147, v144 row_shl:3 row_mask:0xf bank_mask:0xf bound_ctrl:1
  s_waitcnt lgkmcnt(2)
  v_mfma_f32_16x16x32_bf16 v[44:47], v[204:207], v[140:143], 0
  ds_read_b128 v[196:199], v11 offset:17824
  buffer_store_dwordx4 v[184:187], v22, s[20:23], s54 offen offset:0 sc1
  v_mov_b32_dpp v149, v148 row_shl:1 row_mask:0xf bank_mask:0xf bound_ctrl:1
  v_mov_b32_dpp v150, v148 row_shl:2 row_mask:0xf bank_mask:0xf bound_ctrl:1
  v_mov_b32_dpp v151, v148 row_shl:3 row_mask:0xf bank_mask:0xf bound_ctrl:1
  s_waitcnt lgkmcnt(2)
  v_mfma_f32_16x16x32_bf16 v[48:51], v[180:183], v[144:147], 0
  ds_read_b128 v[204:207], v11 offset:18064
  v_mov_b32_dpp v153, v152 row_shl:1 row_mask:0xf bank_mask:0xf bound_ctrl:1
  v_mov_b32_dpp v154, v152 row_shl:2 row_mask:0xf bank_mask:0xf bound_ctrl:1
  v_mov_b32_dpp v155, v152 row_shl:3 row_mask:0xf bank_mask:0xf bound_ctrl:1
  s_waitcnt lgkmcnt(2)
  v_mfma_f32_16x16x32_bf16 v[52:55], v[188:191], v[148:151], 0
  ds_read_b128 v[180:183], v12 offset:16384
  v_mov_b32_dpp v157, v156 row_shl:1 row_mask:0xf bank_mask:0xf bound_ctrl:1
  v_mov_b32_dpp v158, v156 row_shl:2 row_mask:0xf bank_mask:0xf bound_ctrl:1
  v_mov_b32_dpp v159, v156 row_shl:3 row_mask:0xf bank_mask:0xf bound_ctrl:1
  s_waitcnt lgkmcnt(2)
  v_mfma_f32_16x16x32_bf16 v[56:59], v[196:199], v[152:155], 0
  ds_read_b128 v[188:191], v12 offset:16624
  s_nop 1
  s_waitcnt lgkmcnt(2)
  v_mfma_f32_16x16x32_bf16 v[60:63], v[204:207], v[156:159], 0
  ds_read_b128 v[196:199], v12 offset:16864
  s_setprio 2
  v_perm_b32 v128, v172, v168, s26
  v_perm_b32 v132, v172, v168, s27
  v_perm_b32 v136, v173, v169, s26
  v_perm_b32 v140, v173, v169, s27
  v_perm_b32 v144, v174, v170, s26
  v_perm_b32 v148, v174, v170, s27
  v_perm_b32 v152, v175, v171, s26
  v_perm_b32 v156, v175, v171, s27
  ds_read_b128 v[168:171], v31 offset:0
  ds_read_b128 v[172:175], v31 offset:1920
  v_mov_b32_dpp v129, v128 row_shl:1 row_mask:0xf bank_mask:0xf bound_ctrl:1
  v_mov_b32_dpp v130, v128 row_shl:2 row_mask:0xf bank_mask:0xf bound_ctrl:1
  v_mov_b32_dpp v131, v128 row_shl:3 row_mask:0xf bank_mask:0xf bound_ctrl:1
  v_mov_b32_dpp v133, v132 row_shl:1 row_mask:0xf bank_mask:0xf bound_ctrl:1
  v_mov_b32_dpp v134, v132 row_shl:2 row_mask:0xf bank_mask:0xf bound_ctrl:1
  v_mov_b32_dpp v135, v132 row_shl:3 row_mask:0xf bank_mask:0xf bound_ctrl:1
  s_waitcnt lgkmcnt(4)
  v_mfma_f32_16x16x32_bf16 v[32:35], v[180:183], v[128:131], v[32:35]
  ds_read_b128 v[204:207], v12 offset:17104
  v_mov_b32_dpp v137, v136 row_shl:1 row_mask:0xf bank_mask:0xf bound_ctrl:1
  v_mov_b32_dpp v138, v136 row_shl:2 row_mask:0xf bank_mask:0xf bound_ctrl:1
  v_mov_b32_dpp v139, v136 row_shl:3 row_mask:0xf bank_mask:0xf bound_ctrl:1
  s_waitcnt lgkmcnt(4)
  v_mfma_f32_16x16x32_bf16 v[36:39], v[188:191], v[132:135], v[36:39]
  ds_read_b128 v[180:183], v12 offset:17344
  buffer_store_dwordx4 v[192:195], v23, s[20:23], s54 offen offset:0 sc1
  v_mov_b32_dpp v141, v140 row_shl:1 row_mask:0xf bank_mask:0xf bound_ctrl:1
  v_mov_b32_dpp v142, v140 row_shl:2 row_mask:0xf bank_mask:0xf bound_ctrl:1
  v_mov_b32_dpp v143, v140 row_shl:3 row_mask:0xf bank_mask:0xf bound_ctrl:1
  s_waitcnt lgkmcnt(4)
  v_mfma_f32_16x16x32_bf16 v[40:43], v[196:199], v[136:139], v[40:43]
  ds_read_b128 v[188:191], v12 offset:17584
  v_mov_b32_dpp v145, v144 row_shl:1 row_mask:0xf bank_mask:0xf bound_ctrl:1
  v_mov_b32_dpp v146, v144 row_shl:2 row_mask:0xf bank_mask:0xf bound_ctrl:1
  v_mov_b32_dpp v147, v144 row_shl:3 row_mask:0xf bank_mask:0xf bound_ctrl:1
  s_waitcnt lgkmcnt(2)
  v_mfma_f32_16x16x32_bf16 v[44:47], v[204:207], v[140:143], v[44:47]
  ds_read_b128 v[196:199], v12 offset:17824
  v_mov_b32_dpp v149, v148 row_shl:1 row_mask:0xf bank_mask:0xf bound_ctrl:1
  v_mov_b32_dpp v150, v148 row_shl:2 row_mask:0xf bank_mask:0xf bound_ctrl:1
  v_mov_b32_dpp v151, v148 row_shl:3 row_mask:0xf bank_mask:0xf bound_ctrl:1
  s_waitcnt lgkmcnt(2)
  v_mfma_f32_16x16x32_bf16 v[48:51], v[180:183], v[144:147], v[48:51]
  ds_read_b128 v[204:207], v12 offset:18064
  v_mov_b32_dpp v153, v152 row_shl:1 row_mask:0xf bank_mask:0xf bound_ctrl:1
  v_mov_b32_dpp v154, v152 row_shl:2 row_mask:0xf bank_mask:0xf bound_ctrl:1
  v_mov_b32_dpp v155, v152 row_shl:3 row_mask:0xf bank_mask:0xf bound_ctrl:1
  s_waitcnt lgkmcnt(2)
  v_mfma_f32_16x16x32_bf16 v[52:55], v[188:191], v[148:151], v[52:55]
  ds_read_b128 v[180:183], v13 offset:16384
  v_mov_b32_dpp v157, v156 row_shl:1 row_mask:0xf bank_mask:0xf bound_ctrl:1
  v_mov_b32_dpp v158, v156 row_shl:2 row_mask:0xf bank_mask:0xf bound_ctrl:1
  v_mov_b32_dpp v159, v156 row_shl:3 row_mask:0xf bank_mask:0xf bound_ctrl:1
  s_waitcnt lgkmcnt(2)
  v_mfma_f32_16x16x32_bf16 v[56:59], v[196:199], v[152:155], v[56:59]
  ds_read_b128 v[188:191], v13 offset:16624
  s_nop 1
  s_waitcnt lgkmcnt(2)
  v_mfma_f32_16x16x32_bf16 v[60:63], v[204:207], v[156:159], v[60:63]
  ds_read_b128 v[196:199], v13 offset:16864
  s_setprio 1
  v_perm_b32 v128, v164, v160, s26
  v_perm_b32 v132, v164, v160, s27
  v_perm_b32 v136, v165, v161, s26
  v_perm_b32 v140, v165, v161, s27
  v_perm_b32 v144, v166, v162, s26
  v_perm_b32 v148, v166, v162, s27
  v_perm_b32 v152, v167, v163, s26
  v_perm_b32 v156, v167, v163, s27
  v_mov_b32_dpp v129, v128 row_shl:1 row_mask:0xf bank_mask:0xf bound_ctrl:1
  v_mov_b32_dpp v130, v128 row_shl:2 row_mask:0xf bank_mask:0xf bound_ctrl:1
  v_mov_b32_dpp v131, v128 row_shl:3 row_mask:0xf bank_mask:0xf bound_ctrl:1
  v_mov_b32_dpp v133, v132 row_shl:1 row_mask:0xf bank_mask:0xf bound_ctrl:1
  v_mov_b32_dpp v134, v132 row_shl:2 row_mask:0xf bank_mask:0xf bound_ctrl:1
  v_mov_b32_dpp v135, v132 row_shl:3 row_mask:0xf bank_mask:0xf bound_ctrl:1
  s_waitcnt lgkmcnt(2)
  v_mfma_f32_16x16x32_bf16 v[32:35], v[180:183], v[128:131], v[32:35]
  ds_read_b128 v[204:207], v13 offset:17104
  v_mov_b32_dpp v137, v136 row_shl:1 row_mask:0xf bank_mask:0xf bound_ctrl:1
  v_mov_b32_dpp v138, v136 row_shl:2 row_mask:0xf bank_mask:0xf bound_ctrl:1
  v_mov_b32_dpp v139, v136 row_shl:3 row_mask:0xf bank_mask:0xf bound_ctrl:1
  s_waitcnt lgkmcnt(2)
  v_mfma_f32_16x16x32_bf16 v[36:39], v[188:191], v[132:135], v[36:39]
  ds_read_b128 v[180:183], v13 offset:17344
  v_mov_b32_dpp v141, v140 row_shl:1 row_mask:0xf bank_mask:0xf bound_ctrl:1
  v_mov_b32_dpp v142, v140 row_shl:2 row_mask:0xf bank_mask:0xf bound_ctrl:1
  v_mov_b32_dpp v143, v140 row_shl:3 row_mask:0xf bank_mask:0xf bound_ctrl:1
  s_waitcnt lgkmcnt(2)
  v_mfma_f32_16x16x32_bf16 v[40:43], v[196:199], v[136:139], v[40:43]
  ds_read_b128 v[188:191], v13 offset:17584
  v_mov_b32_dpp v145, v144 row_shl:1 row_mask:0xf bank_mask:0xf bound_ctrl:1
  v_mov_b32_dpp v146, v144 row_shl:2 row_mask:0xf bank_mask:0xf bound_ctrl:1
  v_mov_b32_dpp v147, v144 row_shl:3 row_mask:0xf bank_mask:0xf bound_ctrl:1
  s_waitcnt lgkmcnt(2)
  v_mfma_f32_16x16x32_bf16 v[44:47], v[204:207], v[140:143], v[44:47]
  ds_read_b128 v[196:199], v13 offset:17824
  v_mov_b32_dpp v149, v148 row_shl:1 row_mask:0xf bank_mask:0xf bound_ctrl:1
  v_mov_b32_dpp v150, v148 row_shl:2 row_mask:0xf bank_mask:0xf bound_ctrl:1
  v_mov_b32_dpp v151, v148 row_shl:3 row_mask:0xf bank_mask:0xf bound_ctrl:1
  s_waitcnt lgkmcnt(2)
  v_mfma_f32_16x16x32_bf16 v[48:51], v[180:183], v[144:147], v[48:51]
  ds_read_b128 v[204:207], v13 offset:18064
  v_mov_b32_dpp v153, v152 row_shl:1 row_mask:0xf bank_mask:0xf bound_ctrl:1
  v_mov_b32_dpp v154, v152 row_shl:2 row_mask:0xf bank_mask:0xf bound_ctrl:1
  v_mov_b32_dpp v155, v152 row_shl:3 row_mask:0xf bank_mask:0xf bound_ctrl:1
  s_waitcnt lgkmcnt(2)
  v_mfma_f32_16x16x32_bf16 v[52:55], v[188:191], v[148:151], v[52:55]
  ds_read_b128 v[180:183], v14 offset:16384
  v_mov_b32_dpp v157, v156 row_shl:1 row_mask:0xf bank_mask:0xf bound_ctrl:1
  v_mov_b32_dpp v158, v156 row_shl:2 row_mask:0xf bank_mask:0xf bound_ctrl:1
  v_mov_b32_dpp v159, v156 row_shl:3 row_mask:0xf bank_mask:0xf bound_ctrl:1
  s_waitcnt lgkmcnt(2)
  v_mfma_f32_16x16x32_bf16 v[56:59], v[196:199], v[152:155], v[56:59]
  ds_read_b128 v[188:191], v14 offset:16624
  s_nop 1
  s_waitcnt lgkmcnt(2)
  v_mfma_f32_16x16x32_bf16 v[60:63], v[204:207], v[156:159], v[60:63]
  ds_read_b128 v[196:199], v14 offset:16864
  s_setprio 0
  v_perm_b32 v128, v172, v168, s26
  v_perm_b32 v132, v172, v168, s27
  v_perm_b32 v136, v173, v169, s26
  v_perm_b32 v140, v173, v169, s27
  v_perm_b32 v144, v174, v170, s26
  v_perm_b32 v148, v174, v170, s27
  v_perm_b32 v152, v175, v171, s26
  v_perm_b32 v156, v175, v171, s27
  v_mov_b32_dpp v129, v128 row_shl:1 row_mask:0xf bank_mask:0xf bound_ctrl:1
  v_mov_b32_dpp v130, v128 row_shl:2 row_mask:0xf bank_mask:0xf bound_ctrl:1
  v_mov_b32_dpp v131, v128 row_shl:3 row_mask:0xf bank_mask:0xf bound_ctrl:1
  v_mov_b32_dpp v133, v132 row_shl:1 row_mask:0xf bank_mask:0xf bound_ctrl:1
  v_mov_b32_dpp v134, v132 row_shl:2 row_mask:0xf bank_mask:0xf bound_ctrl:1
  v_mov_b32_dpp v135, v132 row_shl:3 row_mask:0xf bank_mask:0xf bound_ctrl:1
  s_waitcnt lgkmcnt(2)
  v_mfma_f32_16x16x32_bf16 v[32:35], v[180:183], v[128:131], v[32:35]
  ds_read_b128 v[204:207], v14 offset:17104
  v_mov_b32_dpp v137, v136 row_shl:1 row_mask:0xf bank_mask:0xf bound_ctrl:1
  v_mov_b32_dpp v138, v136 row_shl:2 row_mask:0xf bank_mask:0xf bound_ctrl:1
  v_mov_b32_dpp v139, v136 row_shl:3 row_mask:0xf bank_mask:0xf bound_ctrl:1
  s_waitcnt lgkmcnt(2)
  v_mfma_f32_16x16x32_bf16 v[36:39], v[188:191], v[132:135], v[36:39]
  ds_read_b128 v[180:183], v14 offset:17344
  v_mov_b32_dpp v141, v140 row_shl:1 row_mask:0xf bank_mask:0xf bound_ctrl:1
  v_mov_b32_dpp v142, v140 row_shl:2 row_mask:0xf bank_mask:0xf bound_ctrl:1
  v_mov_b32_dpp v143, v140 row_shl:3 row_mask:0xf bank_mask:0xf bound_ctrl:1
  s_waitcnt lgkmcnt(2)
  v_mfma_f32_16x16x32_bf16 v[40:43], v[196:199], v[136:139], v[40:43]
  ds_read_b128 v[188:191], v14 offset:17584
  v_mov_b32_dpp v145, v144 row_shl:1 row_mask:0xf bank_mask:0xf bound_ctrl:1
  v_mov_b32_dpp v146, v144 row_shl:2 row_mask:0xf bank_mask:0xf bound_ctrl:1
  v_mov_b32_dpp v147, v144 row_shl:3 row_mask:0xf bank_mask:0xf bound_ctrl:1
  s_waitcnt lgkmcnt(2)
  v_mfma_f32_16x16x32_bf16 v[44:47], v[204:207], v[140:143], v[44:47]
  ds_read_b128 v[196:199], v14 offset:17824
  v_mov_b32_dpp v149, v148 row_shl:1 row_mask:0xf bank_mask:0xf bound_ctrl:1
  v_mov_b32_dpp v150, v148 row_shl:2 row_mask:0xf bank_mask:0xf bound_ctrl:1
  v_mov_b32_dpp v151, v148 row_shl:3 row_mask:0xf bank_mask:0xf bound_ctrl:1
  s_waitcnt lgkmcnt(2)
  v_mfma_f32_16x16x32_bf16 v[48:51], v[180:183], v[144:147], v[48:51]
  ds_read_b128 v[204:207], v14 offset:18064
  v_mov_b32_dpp v153, v152 row_shl:1 row_mask:0xf bank_mask:0xf bound_ctrl:1
  v_mov_b32_dpp v154, v152 row_shl:2 row_mask:0xf bank_mask:0xf bound_ctrl:1
  v_mov_b32_dpp v155, v152 row_shl:3 row_mask:0xf bank_mask:0xf bound_ctrl:1
  s_waitcnt lgkmcnt(2)
  v_mfma_f32_16x16x32_bf16 v[52:55], v[188:191], v[148:151], v[52:55]
  v_mov_b32_dpp v157, v156 row_shl:1 row_mask:0xf bank_mask:0xf bound_ctrl:1
  v_mov_b32_dpp v158, v156 row_shl:2 row_mask:0xf bank_mask:0xf bound_ctrl:1
  v_mov_b32_dpp v159, v156 row_shl:3 row_mask:0xf bank_mask:0xf bound_ctrl:1
  s_waitcnt lgkmcnt(1)
  v_mfma_f32_16x16x32_bf16 v[56:59], v[196:199], v[152:155], v[56:59]
  s_nop 1
  s_waitcnt lgkmcnt(0)
  v_mfma_f32_16x16x32_bf16 v[60:63], v[204:207], v[156:159], v[60:63]
  s_waitcnt vmcnt(3)
  s_waitcnt lgkmcnt(0)
  s_barrier
  s_sub_u32 s31, s32, 3
  s_mul_i32 s31, s31, 384
  s_add_u32 s31, s31, s45
  s_sub_u32 s31, s31, 3
  s_mul_i32 s31, s31, 384
  s_add_u32 s31, s31, 256
  v_add_u32 v30, 0, v9
  v_add_u32 v31, 0, v10
  ds_read_b128 v[160:163], v30 offset:0
  ds_read_b128 v[164:167], v30 offset:1920
  ds_read_b128 v[180:183], v11 offset:0
  ds_read_b128 v[188:191], v11 offset:240
  ds_read_b128 v[196:199], v11 offset:480
  ds_read_b128 v[168:171], v30 offset:15360
  ds_read_b128 v[172:175], v30 offset:17280
  s_setprio 3
  s_waitcnt lgkmcnt(5)
  v_perm_b32 v128, v164, v160, s26
  v_perm_b32 v132, v164, v160, s27
  v_perm_b32 v136, v165, v161, s26
  v_perm_b32 v140, v165, v161, s27
  v_perm_b32 v144, v166, v162, s26
  v_perm_b32 v148, v166, v162, s27
  v_perm_b32 v152, v167, v163, s26
  v_perm_b32 v156, v167, v163, s27
  ds_read_b128 v[160:163], v30 offset:30720
  ds_read_b128 v[164:167], v30 offset:32640
  v_mov_b32_dpp v129, v128 row_shl:1 row_mask:0xf bank_mask:0xf bound_ctrl:1
  v_mov_b32_dpp v130, v128 row_shl:2 row_mask:0xf bank_mask:0xf bound_ctrl:1
  v_mov_b32_dpp v131, v128 row_shl:3 row_mask:0xf bank_mask:0xf bound_ctrl:1
  v_mov_b32_dpp v133, v132 row_shl:1 row_mask:0xf bank_mask:0xf bound_ctrl:1
  v_mov_b32_dpp v134, v132 row_shl:2 row_mask:0xf bank_mask:0xf bound_ctrl:1
  v_mov_b32_dpp v135, v132 row_shl:3 row_mask:0xf bank_mask:0xf bound_ctrl:1
  s_waitcnt lgkmcnt(6)
  v_mfma_f32_16x16x32_bf16 v[64:67], v[180:183], v[128:131], 0
  ds_read_b128 v[204:207], v11 offset:720
  s_cmp_lg_u32 s56, 0
  s_cbranch_scc1 standalone__convnext_block__vision_kernel_nosig
  s_cmp_eq_u32 s3, 0
  s_cselect_b32 s86, s86, 0
  v_mov_b32 v246, 0
  v_mov_b32 v247, 1
  s_mov_b64 s[62:63], exec
  s_mov_b64 exec, 1
  buffer_atomic_add v247, v246, s[84:87], 0 offen sc1
  s_mov_b64 exec, s[62:63]
standalone__convnext_block__vision_kernel_nosig:
  v_mov_b32_dpp v137, v136 row_shl:1 row_mask:0xf bank_mask:0xf bound_ctrl:1
  v_mov_b32_dpp v138, v136 row_shl:2 row_mask:0xf bank_mask:0xf bound_ctrl:1
  v_mov_b32_dpp v139, v136 row_shl:3 row_mask:0xf bank_mask:0xf bound_ctrl:1
  s_waitcnt lgkmcnt(6)
  v_mfma_f32_16x16x32_bf16 v[68:71], v[188:191], v[132:135], 0
  ds_read_b128 v[180:183], v11 offset:960
  s_add_u32 m0, s58, 98304
  v_add_u32 v244, s31, v2
  buffer_load_dwordx4 v244, s[4:7], 0 offen lds
  v_mov_b32_dpp v141, v140 row_shl:1 row_mask:0xf bank_mask:0xf bound_ctrl:1
  v_mov_b32_dpp v142, v140 row_shl:2 row_mask:0xf bank_mask:0xf bound_ctrl:1
  v_mov_b32_dpp v143, v140 row_shl:3 row_mask:0xf bank_mask:0xf bound_ctrl:1
  s_waitcnt lgkmcnt(6)
  v_mfma_f32_16x16x32_bf16 v[72:75], v[196:199], v[136:139], 0
  ds_read_b128 v[188:191], v11 offset:1200
  s_add_u32 m0, s58, 99328
  v_add_u32 v245, s31, v3
  buffer_load_dwordx4 v245, s[4:7], 0 offen lds
  v_mov_b32_dpp v145, v144 row_shl:1 row_mask:0xf bank_mask:0xf bound_ctrl:1
  v_mov_b32_dpp v146, v144 row_shl:2 row_mask:0xf bank_mask:0xf bound_ctrl:1
  v_mov_b32_dpp v147, v144 row_shl:3 row_mask:0xf bank_mask:0xf bound_ctrl:1
  s_waitcnt lgkmcnt(2)
  v_mfma_f32_16x16x32_bf16 v[76:79], v[204:207], v[140:143], 0
  ds_read_b128 v[196:199], v11 offset:1440
  s_add_u32 m0, s58, 100352
  v_add_u32 v244, s31, v4
  buffer_load_dwordx4 v244, s[4:7], 0 offen lds
  v_mov_b32_dpp v149, v148 row_shl:1 row_mask:0xf bank_mask:0xf bound_ctrl:1
  v_mov_b32_dpp v150, v148 row_shl:2 row_mask:0xf bank_mask:0xf bound_ctrl:1
  v_mov_b32_dpp v151, v148 row_shl:3 row_mask:0xf bank_mask:0xf bound_ctrl:1
  s_waitcnt lgkmcnt(2)
  v_mfma_f32_16x16x32_bf16 v[80:83], v[180:183], v[144:147], 0
  ds_read_b128 v[204:207], v11 offset:1680
  s_add_u32 m0, s58, 101376
  v_add_u32 v245, s31, v5
  buffer_load_dwordx4 v245, s[4:7], 0 offen lds
  v_mov_b32_dpp v153, v152 row_shl:1 row_mask:0xf bank_mask:0xf bound_ctrl:1
  v_mov_b32_dpp v154, v152 row_shl:2 row_mask:0xf bank_mask:0xf bound_ctrl:1
  v_mov_b32_dpp v155, v152 row_shl:3 row_mask:0xf bank_mask:0xf bound_ctrl:1
  s_waitcnt lgkmcnt(2)
  v_mfma_f32_16x16x32_bf16 v[84:87], v[188:191], v[148:151], 0
  ds_read_b128 v[180:183], v12 offset:0
  s_add_u32 m0, s58, 102400
  v_add_u32 v244, s31, v6
  buffer_load_dwordx4 v244, s[4:7], 0 offen lds
  v_mov_b32_dpp v157, v156 row_shl:1 row_mask:0xf bank_mask:0xf bound_ctrl:1
  v_mov_b32_dpp v158, v156 row_shl:2 row_mask:0xf bank_mask:0xf bound_ctrl:1
  v_mov_b32_dpp v159, v156 row_shl:3 row_mask:0xf bank_mask:0xf bound_ctrl:1
  s_waitcnt lgkmcnt(2)
  v_mfma_f32_16x16x32_bf16 v[88:91], v[196:199], v[152:155], 0
  ds_read_b128 v[188:191], v12 offset:240
  s_nop 1
  s_waitcnt lgkmcnt(2)
  v_mfma_f32_16x16x32_bf16 v[92:95], v[204:207], v[156:159], 0
  ds_read_b128 v[196:199], v12 offset:480
  s_add_u32 m0, s58, 103424
  v_add_u32 v245, s31, v7
  buffer_load_dwordx4 v245, s[4:7], 0 offen lds
  s_setprio 2
  v_perm_b32 v128, v172, v168, s26
  v_perm_b32 v132, v172, v168, s27
  v_perm_b32 v136, v173, v169, s26
  v_perm_b32 v140, v173, v169, s27
  v_perm_b32 v144, v174, v170, s26
  v_perm_b32 v148, v174, v170, s27
  v_perm_b32 v152, v175, v171, s26
  v_perm_b32 v156, v175, v171, s27
  ds_read_b128 v[168:171], v31 offset:0
  ds_read_b128 v[172:175], v31 offset:1920
  v_mov_b32_dpp v129, v128 row_shl:1 row_mask:0xf bank_mask:0xf bound_ctrl:1
  v_mov_b32_dpp v130, v128 row_shl:2 row_mask:0xf bank_mask:0xf bound_ctrl:1
  v_mov_b32_dpp v131, v128 row_shl:3 row_mask:0xf bank_mask:0xf bound_ctrl:1
  v_mov_b32_dpp v133, v132 row_shl:1 row_mask:0xf bank_mask:0xf bound_ctrl:1
  v_mov_b32_dpp v134, v132 row_shl:2 row_mask:0xf bank_mask:0xf bound_ctrl:1
  v_mov_b32_dpp v135, v132 row_shl:3 row_mask:0xf bank_mask:0xf bound_ctrl:1
  s_waitcnt lgkmcnt(4)
  v_mfma_f32_16x16x32_bf16 v[64:67], v[180:183], v[128:131], v[64:67]
  ds_read_b128 v[204:207], v12 offset:720
  s_add_u32 m0, s58, 104448
  v_add_u32 v244, s31, v8
  buffer_load_dwordx4 v244, s[4:7], 0 offen lds
  v_mov_b32_dpp v137, v136 row_shl:1 row_mask:0xf bank_mask:0xf bound_ctrl:1
  v_mov_b32_dpp v138, v136 row_shl:2 row_mask:0xf bank_mask:0xf bound_ctrl:1
  v_mov_b32_dpp v139, v136 row_shl:3 row_mask:0xf bank_mask:0xf bound_ctrl:1
  s_waitcnt lgkmcnt(4)
  v_mfma_f32_16x16x32_bf16 v[68:71], v[188:191], v[132:135], v[68:71]
  ds_read_b128 v[180:183], v12 offset:960
  v_lshl_or_b32 v228, v249, 16, v248
  v_lshl_or_b32 v229, v251, 16, v250
  v_lshl_or_b32 v230, v253, 16, v252
  v_mov_b32 v231, v254
  v_lshlrev_b32 v236, 16, v248
  v_lshl_or_b32 v237, v250, 16, v249
  v_lshl_or_b32 v238, v252, 16, v251
  v_lshl_or_b32 v239, v254, 16, v253
  v_mul_u32_u24 v246, 15, v1
  s_lshl_b32 s24, s3, 5
  s_add_u32 s24, s24, 73728
  v_add_u32 v246, s24, v246
  s_cmp_eq_u32 s3, 7
  s_cselect_b32 s24, 0, 16
  v_add_u32 v247, s24, v246
  ds_write_b128 v246, v[228:231]
  ds_write_b128 v247, v[236:239]
  v_mov_b32_dpp v141, v140 row_shl:1 row_mask:0xf bank_mask:0xf bound_ctrl:1
  v_mov_b32_dpp v142, v140 row_shl:2 row_mask:0xf bank_mask:0xf bound_ctrl:1
  v_mov_b32_dpp v143, v140 row_shl:3 row_mask:0xf bank_mask:0xf bound_ctrl:1
  s_waitcnt lgkmcnt(6)
  v_mfma_f32_16x16x32_bf16 v[72:75], v[196:199], v[136:139], v[72:75]
  ds_read_b128 v[188:191], v12 offset:1200
  buffer_store_dwordx4 v[200:203], v21, s[20:23], s54 offen offset:64 sc1
  v_mov_b32_dpp v145, v144 row_shl:1 row_mask:0xf bank_mask:0xf bound_ctrl:1
  v_mov_b32_dpp v146, v144 row_shl:2 row_mask:0xf bank_mask:0xf bound_ctrl:1
  v_mov_b32_dpp v147, v144 row_shl:3 row_mask:0xf bank_mask:0xf bound_ctrl:1
  s_waitcnt lgkmcnt(4)
  v_mfma_f32_16x16x32_bf16 v[76:79], v[204:207], v[140:143], v[76:79]
  ds_read_b128 v[196:199], v12 offset:1440
  buffer_store_dwordx4 v[208:211], v22, s[20:23], s54 offen offset:64 sc1
  v_mov_b32_dpp v149, v148 row_shl:1 row_mask:0xf bank_mask:0xf bound_ctrl:1
  v_mov_b32_dpp v150, v148 row_shl:2 row_mask:0xf bank_mask:0xf bound_ctrl:1
  v_mov_b32_dpp v151, v148 row_shl:3 row_mask:0xf bank_mask:0xf bound_ctrl:1
  s_waitcnt lgkmcnt(4)
  v_mfma_f32_16x16x32_bf16 v[80:83], v[180:183], v[144:147], v[80:83]
  ds_read_b128 v[204:207], v12 offset:1680
  buffer_store_dwordx4 v[216:219], v23, s[20:23], s54 offen offset:64 sc1
  v_mov_b32_dpp v153, v152 row_shl:1 row_mask:0xf bank_mask:0xf bound_ctrl:1
  v_mov_b32_dpp v154, v152 row_shl:2 row_mask:0xf bank_mask:0xf bound_ctrl:1
  v_mov_b32_dpp v155, v152 row_shl:3 row_mask:0xf bank_mask:0xf bound_ctrl:1
  s_waitcnt lgkmcnt(2)
  v_mfma_f32_16x16x32_bf16 v[84:87], v[188:191], v[148:151], v[84:87]
  ds_read_b128 v[180:183], v13 offset:0
  v_mov_b32_dpp v157, v156 row_shl:1 row_mask:0xf bank_mask:0xf bound_ctrl:1
  v_mov_b32_dpp v158, v156 row_shl:2 row_mask:0xf bank_mask:0xf bound_ctrl:1
  v_mov_b32_dpp v159, v156 row_shl:3 row_mask:0xf bank_mask:0xf bound_ctrl:1
  s_waitcnt lgkmcnt(2)
  v_mfma_f32_16x16x32_bf16 v[88:91], v[196:199], v[152:155], v[88:91]
  ds_read_b128 v[188:191], v13 offset:240
  s_nop 1
  s_waitcnt lgkmcnt(2)
  v_mfma_f32_16x16x32_bf16 v[92:95], v[204:207], v[156:159], v[92:95]
  ds_read_b128 v[196:199], v13 offset:480
  s_setprio 1
  v_perm_b32 v128, v164, v160, s26
  v_perm_b32 v132, v164, v160, s27
  v_perm_b32 v136, v165, v161, s26
  v_perm_b32 v140, v165, v161, s27
  v_perm_b32 v144, v166, v162, s26
  v_perm_b32 v148, v166, v162, s27
  v_perm_b32 v152, v167, v163, s26
  v_perm_b32 v156, v167, v163, s27
  v_mov_b32_dpp v129, v128 row_shl:1 row_mask:0xf bank_mask:0xf bound_ctrl:1
  v_mov_b32_dpp v130, v128 row_shl:2 row_mask:0xf bank_mask:0xf bound_ctrl:1
  v_mov_b32_dpp v131, v128 row_shl:3 row_mask:0xf bank_mask:0xf bound_ctrl:1
  v_mov_b32_dpp v133, v132 row_shl:1 row_mask:0xf bank_mask:0xf bound_ctrl:1
  v_mov_b32_dpp v134, v132 row_shl:2 row_mask:0xf bank_mask:0xf bound_ctrl:1
  v_mov_b32_dpp v135, v132 row_shl:3 row_mask:0xf bank_mask:0xf bound_ctrl:1
  s_waitcnt lgkmcnt(2)
  v_mfma_f32_16x16x32_bf16 v[64:67], v[180:183], v[128:131], v[64:67]
  ds_read_b128 v[204:207], v13 offset:720
  v_mov_b32_dpp v137, v136 row_shl:1 row_mask:0xf bank_mask:0xf bound_ctrl:1
  v_mov_b32_dpp v138, v136 row_shl:2 row_mask:0xf bank_mask:0xf bound_ctrl:1
  v_mov_b32_dpp v139, v136 row_shl:3 row_mask:0xf bank_mask:0xf bound_ctrl:1
  s_waitcnt lgkmcnt(2)
  v_mfma_f32_16x16x32_bf16 v[68:71], v[188:191], v[132:135], v[68:71]
  ds_read_b128 v[180:183], v13 offset:960
  v_mov_b32_dpp v141, v140 row_shl:1 row_mask:0xf bank_mask:0xf bound_ctrl:1
  v_mov_b32_dpp v142, v140 row_shl:2 row_mask:0xf bank_mask:0xf bound_ctrl:1
  v_mov_b32_dpp v143, v140 row_shl:3 row_mask:0xf bank_mask:0xf bound_ctrl:1
  s_waitcnt lgkmcnt(2)
  v_mfma_f32_16x16x32_bf16 v[72:75], v[196:199], v[136:139], v[72:75]
  ds_read_b128 v[188:191], v13 offset:1200
  v_mov_b32_dpp v145, v144 row_shl:1 row_mask:0xf bank_mask:0xf bound_ctrl:1
  v_mov_b32_dpp v146, v144 row_shl:2 row_mask:0xf bank_mask:0xf bound_ctrl:1
  v_mov_b32_dpp v147, v144 row_shl:3 row_mask:0xf bank_mask:0xf bound_ctrl:1
  s_waitcnt lgkmcnt(2)
  v_mfma_f32_16x16x32_bf16 v[76:79], v[204:207], v[140:143], v[76:79]
  ds_read_b128 v[196:199], v13 offset:1440
  v_mov_b32_dpp v149, v148 row_shl:1 row_mask:0xf bank_mask:0xf bound_ctrl:1
  v_mov_b32_dpp v150, v148 row_shl:2 row_mask:0xf bank_mask:0xf bound_ctrl:1
  v_mov_b32_dpp v151, v148 row_shl:3 row_mask:0xf bank_mask:0xf bound_ctrl:1
  s_waitcnt lgkmcnt(2)
  v_mfma_f32_16x16x32_bf16 v[80:83], v[180:183], v[144:147], v[80:83]
  ds_read_b128 v[204:207], v13 offset:1680
  v_mov_b32_dpp v153, v152 row_shl:1 row_mask:0xf bank_mask:0xf bound_ctrl:1
  v_mov_b32_dpp v154, v152 row_shl:2 row_mask:0xf bank_mask:0xf bound_ctrl:1
  v_mov_b32_dpp v155, v152 row_shl:3 row_mask:0xf bank_mask:0xf bound_ctrl:1
  s_waitcnt lgkmcnt(2)
  v_mfma_f32_16x16x32_bf16 v[84:87], v[188:191], v[148:151], v[84:87]
  ds_read_b128 v[180:183], v14 offset:0
  v_mov_b32_dpp v157, v156 row_shl:1 row_mask:0xf bank_mask:0xf bound_ctrl:1
  v_mov_b32_dpp v158, v156 row_shl:2 row_mask:0xf bank_mask:0xf bound_ctrl:1
  v_mov_b32_dpp v159, v156 row_shl:3 row_mask:0xf bank_mask:0xf bound_ctrl:1
  s_waitcnt lgkmcnt(2)
  v_mfma_f32_16x16x32_bf16 v[88:91], v[196:199], v[152:155], v[88:91]
  ds_read_b128 v[188:191], v14 offset:240
  s_nop 1
  s_waitcnt lgkmcnt(2)
  v_mfma_f32_16x16x32_bf16 v[92:95], v[204:207], v[156:159], v[92:95]
  ds_read_b128 v[196:199], v14 offset:480
  s_setprio 0
  v_perm_b32 v128, v172, v168, s26
  v_perm_b32 v132, v172, v168, s27
  v_perm_b32 v136, v173, v169, s26
  v_perm_b32 v140, v173, v169, s27
  v_perm_b32 v144, v174, v170, s26
  v_perm_b32 v148, v174, v170, s27
  v_perm_b32 v152, v175, v171, s26
  v_perm_b32 v156, v175, v171, s27
  v_mov_b32_dpp v129, v128 row_shl:1 row_mask:0xf bank_mask:0xf bound_ctrl:1
  v_mov_b32_dpp v130, v128 row_shl:2 row_mask:0xf bank_mask:0xf bound_ctrl:1
  v_mov_b32_dpp v131, v128 row_shl:3 row_mask:0xf bank_mask:0xf bound_ctrl:1
  v_mov_b32_dpp v133, v132 row_shl:1 row_mask:0xf bank_mask:0xf bound_ctrl:1
  v_mov_b32_dpp v134, v132 row_shl:2 row_mask:0xf bank_mask:0xf bound_ctrl:1
  v_mov_b32_dpp v135, v132 row_shl:3 row_mask:0xf bank_mask:0xf bound_ctrl:1
  s_waitcnt lgkmcnt(2)
  v_mfma_f32_16x16x32_bf16 v[64:67], v[180:183], v[128:131], v[64:67]
  ds_read_b128 v[204:207], v14 offset:720
  v_mov_b32_dpp v137, v136 row_shl:1 row_mask:0xf bank_mask:0xf bound_ctrl:1
  v_mov_b32_dpp v138, v136 row_shl:2 row_mask:0xf bank_mask:0xf bound_ctrl:1
  v_mov_b32_dpp v139, v136 row_shl:3 row_mask:0xf bank_mask:0xf bound_ctrl:1
  s_waitcnt lgkmcnt(2)
  v_mfma_f32_16x16x32_bf16 v[68:71], v[188:191], v[132:135], v[68:71]
  ds_read_b128 v[180:183], v14 offset:960
  v_mov_b32_dpp v141, v140 row_shl:1 row_mask:0xf bank_mask:0xf bound_ctrl:1
  v_mov_b32_dpp v142, v140 row_shl:2 row_mask:0xf bank_mask:0xf bound_ctrl:1
  v_mov_b32_dpp v143, v140 row_shl:3 row_mask:0xf bank_mask:0xf bound_ctrl:1
  s_waitcnt lgkmcnt(2)
  v_mfma_f32_16x16x32_bf16 v[72:75], v[196:199], v[136:139], v[72:75]
  ds_read_b128 v[188:191], v14 offset:1200
  v_mov_b32_dpp v145, v144 row_shl:1 row_mask:0xf bank_mask:0xf bound_ctrl:1
  v_mov_b32_dpp v146, v144 row_shl:2 row_mask:0xf bank_mask:0xf bound_ctrl:1
  v_mov_b32_dpp v147, v144 row_shl:3 row_mask:0xf bank_mask:0xf bound_ctrl:1
  s_waitcnt lgkmcnt(2)
  v_mfma_f32_16x16x32_bf16 v[76:79], v[204:207], v[140:143], v[76:79]
  ds_read_b128 v[196:199], v14 offset:1440
  v_mov_b32_dpp v149, v148 row_shl:1 row_mask:0xf bank_mask:0xf bound_ctrl:1
  v_mov_b32_dpp v150, v148 row_shl:2 row_mask:0xf bank_mask:0xf bound_ctrl:1
  v_mov_b32_dpp v151, v148 row_shl:3 row_mask:0xf bank_mask:0xf bound_ctrl:1
  s_waitcnt lgkmcnt(2)
  v_mfma_f32_16x16x32_bf16 v[80:83], v[180:183], v[144:147], v[80:83]
  ds_read_b128 v[204:207], v14 offset:1680
  v_mov_b32_dpp v153, v152 row_shl:1 row_mask:0xf bank_mask:0xf bound_ctrl:1
  v_mov_b32_dpp v154, v152 row_shl:2 row_mask:0xf bank_mask:0xf bound_ctrl:1
  v_mov_b32_dpp v155, v152 row_shl:3 row_mask:0xf bank_mask:0xf bound_ctrl:1
  s_waitcnt lgkmcnt(2)
  v_mfma_f32_16x16x32_bf16 v[84:87], v[188:191], v[148:151], v[84:87]
  v_mov_b32_dpp v157, v156 row_shl:1 row_mask:0xf bank_mask:0xf bound_ctrl:1
  v_mov_b32_dpp v158, v156 row_shl:2 row_mask:0xf bank_mask:0xf bound_ctrl:1
  v_mov_b32_dpp v159, v156 row_shl:3 row_mask:0xf bank_mask:0xf bound_ctrl:1
  s_waitcnt lgkmcnt(1)
  v_mfma_f32_16x16x32_bf16 v[88:91], v[196:199], v[152:155], v[88:91]
  s_nop 1
  s_waitcnt lgkmcnt(0)
  v_mfma_f32_16x16x32_bf16 v[92:95], v[204:207], v[156:159], v[92:95]
  s_waitcnt vmcnt(3)
  s_waitcnt lgkmcnt(0)
  s_barrier
  v_add_u32 v30, 98304, v9
  v_add_u32 v31, 98304, v10
  ds_read_b128 v[160:163], v30 offset:0
  ds_read_b128 v[164:167], v30 offset:1920
  ds_read_b128 v[180:183], v11 offset:16384
  ds_read_b128 v[188:191], v11 offset:16624
  ds_read_b128 v[196:199], v11 offset:16864
  ds_read_b128 v[168:171], v30 offset:15360
  ds_read_b128 v[172:175], v30 offset:17280
  s_setprio 3
  s_waitcnt lgkmcnt(5)
  v_perm_b32 v128, v164, v160, s26
  v_perm_b32 v132, v164, v160, s27
  v_perm_b32 v136, v165, v161, s26
  v_perm_b32 v140, v165, v161, s27
  v_perm_b32 v144, v166, v162, s26
  v_perm_b32 v148, v166, v162, s27
  v_perm_b32 v152, v167, v163, s26
  v_perm_b32 v156, v167, v163, s27
  ds_read_b128 v[160:163], v30 offset:30720
  ds_read_b128 v[164:167], v30 offset:32640
  v_mov_b32_dpp v129, v128 row_shl:1 row_mask:0xf bank_mask:0xf bound_ctrl:1
  v_mov_b32_dpp v130, v128 row_shl:2 row_mask:0xf bank_mask:0xf bound_ctrl:1
  v_mov_b32_dpp v131, v128 row_shl:3 row_mask:0xf bank_mask:0xf bound_ctrl:1
  v_mov_b32_dpp v133, v132 row_shl:1 row_mask:0xf bank_mask:0xf bound_ctrl:1
  v_mov_b32_dpp v134, v132 row_shl:2 row_mask:0xf bank_mask:0xf bound_ctrl:1
  v_mov_b32_dpp v135, v132 row_shl:3 row_mask:0xf bank_mask:0xf bound_ctrl:1
  s_waitcnt lgkmcnt(6)
  v_mfma_f32_16x16x32_bf16 v[96:99], v[180:183], v[128:131], 0
  ds_read_b128 v[204:207], v11 offset:17104
  buffer_store_dwordx4 v[224:227], v21, s[20:23], s54 offen offset:128 sc1
  v_mov_b32_dpp v137, v136 row_shl:1 row_mask:0xf bank_mask:0xf bound_ctrl:1
  v_mov_b32_dpp v138, v136 row_shl:2 row_mask:0xf bank_mask:0xf bound_ctrl:1
  v_mov_b32_dpp v139, v136 row_shl:3 row_mask:0xf bank_mask:0xf bound_ctrl:1
  s_waitcnt lgkmcnt(6)
  v_mfma_f32_16x16x32_bf16 v[100:103], v[188:191], v[132:135], 0
  ds_read_b128 v[180:183], v11 offset:17344
  v_mov_b32_dpp v141, v140 row_shl:1 row_mask:0xf bank_mask:0xf bound_ctrl:1
  v_mov_b32_dpp v142, v140 row_shl:2 row_mask:0xf bank_mask:0xf bound_ctrl:1
  v_mov_b32_dpp v143, v140 row_shl:3 row_mask:0xf bank_mask:0xf bound_ctrl:1
  s_waitcnt lgkmcnt(6)
  v_mfma_f32_16x16x32_bf16 v[104:107], v[196:199], v[136:139], 0
  ds_read_b128 v[188:191], v11 offset:17584
  v_mov_b32_dpp v145, v144 row_shl:1 row_mask:0xf bank_mask:0xf bound_ctrl:1
  v_mov_b32_dpp v146, v144 row_shl:2 row_mask:0xf bank_mask:0xf bound_ctrl:1
  v_mov_b32_dpp v147, v144 row_shl:3 row_mask:0xf bank_mask:0xf bound_ctrl:1
  s_waitcnt lgkmcnt(2)
  v_mfma_f32_16x16x32_bf16 v[108:111], v[204:207], v[140:143], 0
  ds_read_b128 v[196:199], v11 offset:17824
  buffer_store_dwordx4 v[232:235], v22, s[20:23], s54 offen offset:128 sc1
  v_mov_b32_dpp v149, v148 row_shl:1 row_mask:0xf bank_mask:0xf bound_ctrl:1
  v_mov_b32_dpp v150, v148 row_shl:2 row_mask:0xf bank_mask:0xf bound_ctrl:1
  v_mov_b32_dpp v151, v148 row_shl:3 row_mask:0xf bank_mask:0xf bound_ctrl:1
  s_waitcnt lgkmcnt(2)
  v_mfma_f32_16x16x32_bf16 v[112:115], v[180:183], v[144:147], 0
  ds_read_b128 v[204:207], v11 offset:18064
  v_mov_b32_dpp v153, v152 row_shl:1 row_mask:0xf bank_mask:0xf bound_ctrl:1
  v_mov_b32_dpp v154, v152 row_shl:2 row_mask:0xf bank_mask:0xf bound_ctrl:1
  v_mov_b32_dpp v155, v152 row_shl:3 row_mask:0xf bank_mask:0xf bound_ctrl:1
  s_waitcnt lgkmcnt(2)
  v_mfma_f32_16x16x32_bf16 v[116:119], v[188:191], v[148:151], 0
  ds_read_b128 v[180:183], v12 offset:16384
  v_mov_b32_dpp v157, v156 row_shl:1 row_mask:0xf bank_mask:0xf bound_ctrl:1
  v_mov_b32_dpp v158, v156 row_shl:2 row_mask:0xf bank_mask:0xf bound_ctrl:1
  v_mov_b32_dpp v159, v156 row_shl:3 row_mask:0xf bank_mask:0xf bound_ctrl:1
  s_waitcnt lgkmcnt(2)
  v_mfma_f32_16x16x32_bf16 v[120:123], v[196:199], v[152:155], 0
  ds_read_b128 v[188:191], v12 offset:16624
  s_nop 1
  s_waitcnt lgkmcnt(2)
  v_mfma_f32_16x16x32_bf16 v[124:127], v[204:207], v[156:159], 0
  ds_read_b128 v[196:199], v12 offset:16864
  s_setprio 2
  v_perm_b32 v128, v172, v168, s26
  v_perm_b32 v132, v172, v168, s27
  v_perm_b32 v136, v173, v169, s26
  v_perm_b32 v140, v173, v169, s27
  v_perm_b32 v144, v174, v170, s26
  v_perm_b32 v148, v174, v170, s27
  v_perm_b32 v152, v175, v171, s26
  v_perm_b32 v156, v175, v171, s27
  ds_read_b128 v[168:171], v31 offset:0
  ds_read_b128 v[172:175], v31 offset:1920
  v_mov_b32_dpp v129, v128 row_shl:1 row_mask:0xf bank_mask:0xf bound_ctrl:1
  v_mov_b32_dpp v130, v128 row_shl:2 row_mask:0xf bank_mask:0xf bound_ctrl:1
  v_mov_b32_dpp v131, v128 row_shl:3 row_mask:0xf bank_mask:0xf bound_ctrl:1
  v_mov_b32_dpp v133, v132 row_shl:1 row_mask:0xf bank_mask:0xf bound_ctrl:1
  v_mov_b32_dpp v134, v132 row_shl:2 row_mask:0xf bank_mask:0xf bound_ctrl:1
  v_mov_b32_dpp v135, v132 row_shl:3 row_mask:0xf bank_mask:0xf bound_ctrl:1
  s_waitcnt lgkmcnt(4)
  v_mfma_f32_16x16x32_bf16 v[96:99], v[180:183], v[128:131], v[96:99]
  ds_read_b128 v[204:207], v12 offset:17104
  v_mov_b32_dpp v137, v136 row_shl:1 row_mask:0xf bank_mask:0xf bound_ctrl:1
  v_mov_b32_dpp v138, v136 row_shl:2 row_mask:0xf bank_mask:0xf bound_ctrl:1
  v_mov_b32_dpp v139, v136 row_shl:3 row_mask:0xf bank_mask:0xf bound_ctrl:1
  s_waitcnt lgkmcnt(4)
  v_mfma_f32_16x16x32_bf16 v[100:103], v[188:191], v[132:135], v[100:103]
  ds_read_b128 v[180:183], v12 offset:17344
  buffer_store_dwordx4 v[240:243], v23, s[20:23], s54 offen offset:128 sc1
  v_mov_b32_dpp v141, v140 row_shl:1 row_mask:0xf bank_mask:0xf bound_ctrl:1
  v_mov_b32_dpp v142, v140 row_shl:2 row_mask:0xf bank_mask:0xf bound_ctrl:1
  v_mov_b32_dpp v143, v140 row_shl:3 row_mask:0xf bank_mask:0xf bound_ctrl:1
  s_waitcnt lgkmcnt(4)
  v_mfma_f32_16x16x32_bf16 v[104:107], v[196:199], v[136:139], v[104:107]
  ds_read_b128 v[188:191], v12 offset:17584
  v_mov_b32_dpp v145, v144 row_shl:1 row_mask:0xf bank_mask:0xf bound_ctrl:1
  v_mov_b32_dpp v146, v144 row_shl:2 row_mask:0xf bank_mask:0xf bound_ctrl:1
  v_mov_b32_dpp v147, v144 row_shl:3 row_mask:0xf bank_mask:0xf bound_ctrl:1
  s_waitcnt lgkmcnt(2)
  v_mfma_f32_16x16x32_bf16 v[108:111], v[204:207], v[140:143], v[108:111]
  ds_read_b128 v[196:199], v12 offset:17824
  v_mov_b32_dpp v149, v148 row_shl:1 row_mask:0xf bank_mask:0xf bound_ctrl:1
  v_mov_b32_dpp v150, v148 row_shl:2 row_mask:0xf bank_mask:0xf bound_ctrl:1
  v_mov_b32_dpp v151, v148 row_shl:3 row_mask:0xf bank_mask:0xf bound_ctrl:1
  s_waitcnt lgkmcnt(2)
  v_mfma_f32_16x16x32_bf16 v[112:115], v[180:183], v[144:147], v[112:115]
  ds_read_b128 v[204:207], v12 offset:18064
  v_mov_b32_dpp v153, v152 row_shl:1 row_mask:0xf bank_mask:0xf bound_ctrl:1
  v_mov_b32_dpp v154, v152 row_shl:2 row_mask:0xf bank_mask:0xf bound_ctrl:1
  v_mov_b32_dpp v155, v152 row_shl:3 row_mask:0xf bank_mask:0xf bound_ctrl:1
  s_waitcnt lgkmcnt(2)
  v_mfma_f32_16x16x32_bf16 v[116:119], v[188:191], v[148:151], v[116:119]
  ds_read_b128 v[180:183], v13 offset:16384
  v_mov_b32_dpp v157, v156 row_shl:1 row_mask:0xf bank_mask:0xf bound_ctrl:1
  v_mov_b32_dpp v158, v156 row_shl:2 row_mask:0xf bank_mask:0xf bound_ctrl:1
  v_mov_b32_dpp v159, v156 row_shl:3 row_mask:0xf bank_mask:0xf bound_ctrl:1
  s_waitcnt lgkmcnt(2)
  v_mfma_f32_16x16x32_bf16 v[120:123], v[196:199], v[152:155], v[120:123]
  ds_read_b128 v[188:191], v13 offset:16624
  s_nop 1
  s_waitcnt lgkmcnt(2)
  v_mfma_f32_16x16x32_bf16 v[124:127], v[204:207], v[156:159], v[124:127]
  ds_read_b128 v[196:199], v13 offset:16864
  s_setprio 1
  v_perm_b32 v128, v164, v160, s26
  v_perm_b32 v132, v164, v160, s27
  v_perm_b32 v136, v165, v161, s26
  v_perm_b32 v140, v165, v161, s27
  v_perm_b32 v144, v166, v162, s26
  v_perm_b32 v148, v166, v162, s27
  v_perm_b32 v152, v167, v163, s26
  v_perm_b32 v156, v167, v163, s27
  v_mov_b32_dpp v129, v128 row_shl:1 row_mask:0xf bank_mask:0xf bound_ctrl:1
  v_mov_b32_dpp v130, v128 row_shl:2 row_mask:0xf bank_mask:0xf bound_ctrl:1
  v_mov_b32_dpp v131, v128 row_shl:3 row_mask:0xf bank_mask:0xf bound_ctrl:1
  v_mov_b32_dpp v133, v132 row_shl:1 row_mask:0xf bank_mask:0xf bound_ctrl:1
  v_mov_b32_dpp v134, v132 row_shl:2 row_mask:0xf bank_mask:0xf bound_ctrl:1
  v_mov_b32_dpp v135, v132 row_shl:3 row_mask:0xf bank_mask:0xf bound_ctrl:1
  s_waitcnt lgkmcnt(2)
  v_mfma_f32_16x16x32_bf16 v[96:99], v[180:183], v[128:131], v[96:99]
  ds_read_b128 v[204:207], v13 offset:17104
  v_mov_b32_dpp v137, v136 row_shl:1 row_mask:0xf bank_mask:0xf bound_ctrl:1
  v_mov_b32_dpp v138, v136 row_shl:2 row_mask:0xf bank_mask:0xf bound_ctrl:1
  v_mov_b32_dpp v139, v136 row_shl:3 row_mask:0xf bank_mask:0xf bound_ctrl:1
  s_waitcnt lgkmcnt(2)
  v_mfma_f32_16x16x32_bf16 v[100:103], v[188:191], v[132:135], v[100:103]
  ds_read_b128 v[180:183], v13 offset:17344
  v_mov_b32_dpp v141, v140 row_shl:1 row_mask:0xf bank_mask:0xf bound_ctrl:1
  v_mov_b32_dpp v142, v140 row_shl:2 row_mask:0xf bank_mask:0xf bound_ctrl:1
  v_mov_b32_dpp v143, v140 row_shl:3 row_mask:0xf bank_mask:0xf bound_ctrl:1
  s_waitcnt lgkmcnt(2)
  v_mfma_f32_16x16x32_bf16 v[104:107], v[196:199], v[136:139], v[104:107]
  ds_read_b128 v[188:191], v13 offset:17584
  v_mov_b32_dpp v145, v144 row_shl:1 row_mask:0xf bank_mask:0xf bound_ctrl:1
  v_mov_b32_dpp v146, v144 row_shl:2 row_mask:0xf bank_mask:0xf bound_ctrl:1
  v_mov_b32_dpp v147, v144 row_shl:3 row_mask:0xf bank_mask:0xf bound_ctrl:1
  s_waitcnt lgkmcnt(2)
  v_mfma_f32_16x16x32_bf16 v[108:111], v[204:207], v[140:143], v[108:111]
  ds_read_b128 v[196:199], v13 offset:17824
  v_mov_b32_dpp v149, v148 row_shl:1 row_mask:0xf bank_mask:0xf bound_ctrl:1
  v_mov_b32_dpp v150, v148 row_shl:2 row_mask:0xf bank_mask:0xf bound_ctrl:1
  v_mov_b32_dpp v151, v148 row_shl:3 row_mask:0xf bank_mask:0xf bound_ctrl:1
  s_waitcnt lgkmcnt(2)
  v_mfma_f32_16x16x32_bf16 v[112:115], v[180:183], v[144:147], v[112:115]
  ds_read_b128 v[204:207], v13 offset:18064
  v_mov_b32_dpp v153, v152 row_shl:1 row_mask:0xf bank_mask:0xf bound_ctrl:1
  v_mov_b32_dpp v154, v152 row_shl:2 row_mask:0xf bank_mask:0xf bound_ctrl:1
  v_mov_b32_dpp v155, v152 row_shl:3 row_mask:0xf bank_mask:0xf bound_ctrl:1
  s_waitcnt lgkmcnt(2)
  v_mfma_f32_16x16x32_bf16 v[116:119], v[188:191], v[148:151], v[116:119]
  ds_read_b128 v[180:183], v14 offset:16384
  v_mov_b32_dpp v157, v156 row_shl:1 row_mask:0xf bank_mask:0xf bound_ctrl:1
  v_mov_b32_dpp v158, v156 row_shl:2 row_mask:0xf bank_mask:0xf bound_ctrl:1
  v_mov_b32_dpp v159, v156 row_shl:3 row_mask:0xf bank_mask:0xf bound_ctrl:1
  s_waitcnt lgkmcnt(2)
  v_mfma_f32_16x16x32_bf16 v[120:123], v[196:199], v[152:155], v[120:123]
  ds_read_b128 v[188:191], v14 offset:16624
  s_nop 1
  s_waitcnt lgkmcnt(2)
  v_mfma_f32_16x16x32_bf16 v[124:127], v[204:207], v[156:159], v[124:127]
  ds_read_b128 v[196:199], v14 offset:16864
  s_setprio 0
  v_perm_b32 v128, v172, v168, s26
  v_perm_b32 v132, v172, v168, s27
  v_perm_b32 v136, v173, v169, s26
  v_perm_b32 v140, v173, v169, s27
  v_perm_b32 v144, v174, v170, s26
  v_perm_b32 v148, v174, v170, s27
  v_perm_b32 v152, v175, v171, s26
  v_perm_b32 v156, v175, v171, s27
  v_mov_b32_dpp v129, v128 row_shl:1 row_mask:0xf bank_mask:0xf bound_ctrl:1
  v_mov_b32_dpp v130, v128 row_shl:2 row_mask:0xf bank_mask:0xf bound_ctrl:1
  v_mov_b32_dpp v131, v128 row_shl:3 row_mask:0xf bank_mask:0xf bound_ctrl:1
  v_mov_b32_dpp v133, v132 row_shl:1 row_mask:0xf bank_mask:0xf bound_ctrl:1
  v_mov_b32_dpp v134, v132 row_shl:2 row_mask:0xf bank_mask:0xf bound_ctrl:1
  v_mov_b32_dpp v135, v132 row_shl:3 row_mask:0xf bank_mask:0xf bound_ctrl:1
  s_waitcnt lgkmcnt(2)
  v_mfma_f32_16x16x32_bf16 v[96:99], v[180:183], v[128:131], v[96:99]
  ds_read_b128 v[204:207], v14 offset:17104
  v_mov_b32_dpp v137, v136 row_shl:1 row_mask:0xf bank_mask:0xf bound_ctrl:1
  v_mov_b32_dpp v138, v136 row_shl:2 row_mask:0xf bank_mask:0xf bound_ctrl:1
  v_mov_b32_dpp v139, v136 row_shl:3 row_mask:0xf bank_mask:0xf bound_ctrl:1
  s_waitcnt lgkmcnt(2)
  v_mfma_f32_16x16x32_bf16 v[100:103], v[188:191], v[132:135], v[100:103]
  ds_read_b128 v[180:183], v14 offset:17344
  v_mov_b32_dpp v141, v140 row_shl:1 row_mask:0xf bank_mask:0xf bound_ctrl:1
  v_mov_b32_dpp v142, v140 row_shl:2 row_mask:0xf bank_mask:0xf bound_ctrl:1
  v_mov_b32_dpp v143, v140 row_shl:3 row_mask:0xf bank_mask:0xf bound_ctrl:1
  s_waitcnt lgkmcnt(2)
  v_mfma_f32_16x16x32_bf16 v[104:107], v[196:199], v[136:139], v[104:107]
  ds_read_b128 v[188:191], v14 offset:17584
  v_mov_b32_dpp v145, v144 row_shl:1 row_mask:0xf bank_mask:0xf bound_ctrl:1
  v_mov_b32_dpp v146, v144 row_shl:2 row_mask:0xf bank_mask:0xf bound_ctrl:1
  v_mov_b32_dpp v147, v144 row_shl:3 row_mask:0xf bank_mask:0xf bound_ctrl:1
  s_waitcnt lgkmcnt(2)
  v_mfma_f32_16x16x32_bf16 v[108:111], v[204:207], v[140:143], v[108:111]
  ds_read_b128 v[196:199], v14 offset:17824
  v_mov_b32_dpp v149, v148 row_shl:1 row_mask:0xf bank_mask:0xf bound_ctrl:1
  v_mov_b32_dpp v150, v148 row_shl:2 row_mask:0xf bank_mask:0xf bound_ctrl:1
  v_mov_b32_dpp v151, v148 row_shl:3 row_mask:0xf bank_mask:0xf bound_ctrl:1
  s_waitcnt lgkmcnt(2)
  v_mfma_f32_16x16x32_bf16 v[112:115], v[180:183], v[144:147], v[112:115]
  ds_read_b128 v[204:207], v14 offset:18064
  v_mov_b32_dpp v153, v152 row_shl:1 row_mask:0xf bank_mask:0xf bound_ctrl:1
  v_mov_b32_dpp v154, v152 row_shl:2 row_mask:0xf bank_mask:0xf bound_ctrl:1
  v_mov_b32_dpp v155, v152 row_shl:3 row_mask:0xf bank_mask:0xf bound_ctrl:1
  s_waitcnt lgkmcnt(2)
  v_mfma_f32_16x16x32_bf16 v[116:119], v[188:191], v[148:151], v[116:119]
  v_mov_b32_dpp v157, v156 row_shl:1 row_mask:0xf bank_mask:0xf bound_ctrl:1
  v_mov_b32_dpp v158, v156 row_shl:2 row_mask:0xf bank_mask:0xf bound_ctrl:1
  v_mov_b32_dpp v159, v156 row_shl:3 row_mask:0xf bank_mask:0xf bound_ctrl:1
  s_waitcnt lgkmcnt(1)
  v_mfma_f32_16x16x32_bf16 v[120:123], v[196:199], v[152:155], v[120:123]
  s_nop 1
  s_waitcnt lgkmcnt(0)
  v_mfma_f32_16x16x32_bf16 v[124:127], v[204:207], v[156:159], v[124:127]
  s_cmp_lg_u32 s56, 0
  s_cbranch_scc1 standalone__convnext_block__vision_kernel_poll_done
  s_cmp_lg_u32 s3, 0
  s_cbranch_scc1 standalone__convnext_block__vision_kernel_poll_bar
  s_mov_b32 s25, 0
  v_mov_b32 v30, 0
standalone__convnext_block__vision_kernel_poll:
  buffer_load_dword v31, v30, s[80:83], 0 offen sc1
  s_waitcnt vmcnt(0)
  v_readfirstlane_b32 s24, v31
  s_add_u32 s25, s25, 1
  s_cmp_ge_u32 s25, 0x40000
  s_cbranch_scc1 standalone__convnext_block__vision_kernel_poll_acq
  s_cmp_lt_u32 s24, 72
  s_cbranch_scc1 standalone__convnext_block__vision_kernel_poll
standalone__convnext_block__vision_kernel_poll_acq:
standalone__convnext_block__vision_kernel_poll_bar:
  s_barrier
  s_lshr_b32 s24, s2, 3
  s_and_b32 s24, s24, 31
  s_lshl_b32 s24, s24, 3
  s_add_u32 s24, s24, s3
  s_mul_i32 s24, s24, 2304
  v_lshlrev_b32 v30, 3, v1
  v_cmp_gt_u32 vcc, 2304, v30
  v_mov_b32 v31, 0x40000000
  s_nop 0
  v_cndmask_b32 v30, v31, v30, vcc
  buffer_load_dword v248, v30, s[8:11], s24 offen
standalone__convnext_block__vision_kernel_poll_done:
  s_nop 7
  v_pk_add_f32 v[212:213], v[32:33], v[36:37]
  v_pk_mul_f32 v[220:221], v[32:33], v[32:33]
  v_pk_add_f32 v[214:215], v[34:35], v[38:39]
  v_pk_mul_f32 v[222:223], v[34:35], v[34:35]
  v_pk_fma_f32 v[220:221], v[36:37], v[36:37], v[220:221]
  v_pk_fma_f32 v[222:223], v[38:39], v[38:39], v[222:223]
  v_pk_add_f32 v[212:213], v[212:213], v[40:41]
  v_pk_fma_f32 v[220:221], v[40:41], v[40:41], v[220:221]
  v_pk_add_f32 v[214:215], v[214:215], v[42:43]
  v_pk_fma_f32 v[222:223], v[42:43], v[42:43], v[222:223]
  s_mov_b32 m0, s78
  s_nop 0
  buffer_load_dwordx4 v1, s[8:11], s79 offen offset:0 lds
  v_pk_add_f32 v[212:213], v[212:213], v[44:45]
  v_pk_fma_f32 v[220:221], v[44:45], v[44:45], v[220:221]
  v_pk_add_f32 v[214:215], v[214:215], v[46:47]
  v_pk_fma_f32 v[222:223], v[46:47], v[46:47], v[222:223]
  v_pk_add_f32 v[212:213], v[212:213], v[48:49]
  v_pk_fma_f32 v[220:221], v[48:49], v[48:49], v[220:221]
  v_pk_add_f32 v[214:215], v[214:215], v[50:51]
  v_pk_fma_f32 v[222:223], v[50:51], v[50:51], v[222:223]
  buffer_load_dwordx4 v1, s[8:11], s79 offen offset:1024 lds
  v_pk_add_f32 v[212:213], v[212:213], v[52:53]
  v_pk_fma_f32 v[220:221], v[52:53], v[52:53], v[220:221]
  v_pk_add_f32 v[214:215], v[214:215], v[54:55]
  v_pk_fma_f32 v[222:223], v[54:55], v[54:55], v[222:223]
  v_pk_add_f32 v[212:213], v[212:213], v[56:57]
  v_pk_fma_f32 v[220:221], v[56:57], v[56:57], v[220:221]
  v_pk_add_f32 v[214:215], v[214:215], v[58:59]
  v_pk_fma_f32 v[222:223], v[58:59], v[58:59], v[222:223]
  buffer_load_dwordx4 v1, s[8:11], s79 offen offset:2048 lds
  v_pk_add_f32 v[212:213], v[212:213], v[60:61]
  v_pk_fma_f32 v[220:221], v[60:61], v[60:61], v[220:221]
  v_pk_add_f32 v[214:215], v[214:215], v[62:63]
  v_pk_fma_f32 v[222:223], v[62:63], v[62:63], v[222:223]
  v_pk_add_f32 v[212:213], v[212:213], v[64:65]
  v_pk_fma_f32 v[220:221], v[64:65], v[64:65], v[220:221]
  v_pk_add_f32 v[214:215], v[214:215], v[66:67]
  v_pk_fma_f32 v[222:223], v[66:67], v[66:67], v[222:223]
  v_pk_add_f32 v[212:213], v[212:213], v[68:69]
  v_pk_fma_f32 v[220:221], v[68:69], v[68:69], v[220:221]
  v_pk_add_f32 v[214:215], v[214:215], v[70:71]
  v_pk_fma_f32 v[222:223], v[70:71], v[70:71], v[222:223]
  v_pk_add_f32 v[212:213], v[212:213], v[72:73]
  v_pk_fma_f32 v[220:221], v[72:73], v[72:73], v[220:221]
  v_pk_add_f32 v[214:215], v[214:215], v[74:75]
  v_pk_fma_f32 v[222:223], v[74:75], v[74:75], v[222:223]
  v_pk_add_f32 v[212:213], v[212:213], v[76:77]
  v_pk_fma_f32 v[220:221], v[76:77], v[76:77], v[220:221]
  v_pk_add_f32 v[214:215], v[214:215], v[78:79]
  v_pk_fma_f32 v[222:223], v[78:79], v[78:79], v[222:223]
  v_pk_add_f32 v[212:213], v[212:213], v[80:81]
  v_pk_fma_f32 v[220:221], v[80:81], v[80:81], v[220:221]
  v_pk_add_f32 v[214:215], v[214:215], v[82:83]
  v_pk_fma_f32 v[222:223], v[82:83], v[82:83], v[222:223]
  v_pk_add_f32 v[212:213], v[212:213], v[84:85]
  v_pk_fma_f32 v[220:221], v[84:85], v[84:85], v[220:221]
  v_pk_add_f32 v[214:215], v[214:215], v[86:87]
  v_pk_fma_f32 v[222:223], v[86:87], v[86:87], v[222:223]
  v_pk_add_f32 v[212:213], v[212:213], v[88:89]
  v_pk_fma_f32 v[220:221], v[88:89], v[88:89], v[220:221]
  v_pk_add_f32 v[214:215], v[214:215], v[90:91]
  v_pk_fma_f32 v[222:223], v[90:91], v[90:91], v[222:223]
  v_pk_add_f32 v[212:213], v[212:213], v[92:93]
  v_pk_fma_f32 v[220:221], v[92:93], v[92:93], v[220:221]
  v_pk_add_f32 v[214:215], v[214:215], v[94:95]
  v_pk_fma_f32 v[222:223], v[94:95], v[94:95], v[222:223]
  v_pk_add_f32 v[212:213], v[212:213], v[96:97]
  v_pk_fma_f32 v[220:221], v[96:97], v[96:97], v[220:221]
  v_pk_add_f32 v[214:215], v[214:215], v[98:99]
  v_pk_fma_f32 v[222:223], v[98:99], v[98:99], v[222:223]
  v_pk_add_f32 v[212:213], v[212:213], v[100:101]
  v_pk_fma_f32 v[220:221], v[100:101], v[100:101], v[220:221]
  v_pk_add_f32 v[214:215], v[214:215], v[102:103]
  v_pk_fma_f32 v[222:223], v[102:103], v[102:103], v[222:223]
  v_pk_add_f32 v[212:213], v[212:213], v[104:105]
  v_pk_fma_f32 v[220:221], v[104:105], v[104:105], v[220:221]
  v_pk_add_f32 v[214:215], v[214:215], v[106:107]
  v_pk_fma_f32 v[222:223], v[106:107], v[106:107], v[222:223]
  v_pk_add_f32 v[212:213], v[212:213], v[108:109]
  v_pk_fma_f32 v[220:221], v[108:109], v[108:109], v[220:221]
  v_pk_add_f32 v[214:215], v[214:215], v[110:111]
  v_pk_fma_f32 v[222:223], v[110:111], v[110:111], v[222:223]
  v_pk_add_f32 v[212:213], v[212:213], v[112:113]
  v_pk_fma_f32 v[220:221], v[112:113], v[112:113], v[220:221]
  v_pk_add_f32 v[214:215], v[214:215], v[114:115]
  v_pk_fma_f32 v[222:223], v[114:115], v[114:115], v[222:223]
  v_pk_add_f32 v[212:213], v[212:213], v[116:117]
  v_pk_fma_f32 v[220:221], v[116:117], v[116:117], v[220:221]
  v_pk_add_f32 v[214:215], v[214:215], v[118:119]
  v_pk_fma_f32 v[222:223], v[118:119], v[118:119], v[222:223]
  v_pk_add_f32 v[212:213], v[212:213], v[120:121]
  v_pk_fma_f32 v[220:221], v[120:121], v[120:121], v[220:221]
  v_pk_add_f32 v[214:215], v[214:215], v[122:123]
  v_pk_fma_f32 v[222:223], v[122:123], v[122:123], v[222:223]
  v_pk_add_f32 v[212:213], v[212:213], v[124:125]
  v_pk_fma_f32 v[220:221], v[124:125], v[124:125], v[220:221]
  v_pk_add_f32 v[214:215], v[214:215], v[126:127]
  v_pk_fma_f32 v[222:223], v[126:127], v[126:127], v[222:223]
  v_add_u32 v30, 12288, v1
  s_lshl_b32 s24, s3, 10
  v_add_u32 v31, s24, v30
  ds_write_b128 v31, v[212:215]
  ds_write_b128 v31, v[220:223] offset:49152
  s_waitcnt lgkmcnt(0)
  s_barrier
  ds_read_b128 v[128:131], v30 offset:0
  ds_read_b128 v[132:135], v30 offset:49152
  ds_read_b128 v[136:139], v30 offset:1024
  ds_read_b128 v[140:143], v30 offset:50176
  ds_read_b128 v[144:147], v30 offset:2048
  ds_read_b128 v[148:151], v30 offset:51200
  ds_read_b128 v[152:155], v30 offset:3072
  ds_read_b128 v[156:159], v30 offset:52224
  ds_read_b128 v[160:163], v30 offset:4096
  ds_read_b128 v[164:167], v30 offset:53248
  ds_read_b128 v[168:171], v30 offset:5120
  ds_read_b128 v[172:175], v30 offset:54272
  ds_read_b128 v[180:183], v30 offset:6144
  ds_read_b128 v[188:191], v30 offset:55296
  ds_read_b128 v[196:199], v30 offset:7168
  ds_read_b128 v[204:207], v30 offset:56320
  s_waitcnt lgkmcnt(12)
  v_pk_add_f32 v[212:213], v[128:129], v[136:137]
  v_pk_add_f32 v[220:221], v[132:133], v[140:141]
  v_pk_add_f32 v[214:215], v[130:131], v[138:139]
  v_pk_add_f32 v[222:223], v[134:135], v[142:143]
  s_waitcnt lgkmcnt(10)
  v_pk_add_f32 v[212:213], v[212:213], v[144:145]
  v_pk_add_f32 v[220:221], v[220:221], v[148:149]
  v_pk_add_f32 v[214:215], v[214:215], v[146:147]
  v_pk_add_f32 v[222:223], v[222:223], v[150:151]
  s_waitcnt lgkmcnt(8)
  v_pk_add_f32 v[212:213], v[212:213], v[152:153]
  v_pk_add_f32 v[220:221], v[220:221], v[156:157]
  v_pk_add_f32 v[214:215], v[214:215], v[154:155]
  v_pk_add_f32 v[222:223], v[222:223], v[158:159]
  s_waitcnt lgkmcnt(6)
  v_pk_add_f32 v[212:213], v[212:213], v[160:161]
  v_pk_add_f32 v[220:221], v[220:221], v[164:165]
  v_pk_add_f32 v[214:215], v[214:215], v[162:163]
  v_pk_add_f32 v[222:223], v[222:223], v[166:167]
  s_waitcnt lgkmcnt(4)
  v_pk_add_f32 v[212:213], v[212:213], v[168:169]
  v_pk_add_f32 v[220:221], v[220:221], v[172:173]
  v_pk_add_f32 v[214:215], v[214:215], v[170:171]
  v_pk_add_f32 v[222:223], v[222:223], v[174:175]
  s_waitcnt lgkmcnt(2)
  v_pk_add_f32 v[212:213], v[212:213], v[180:181]
  v_pk_add_f32 v[220:221], v[220:221], v[188:189]
  v_pk_add_f32 v[214:215], v[214:215], v[182:183]
  v_pk_add_f32 v[222:223], v[222:223], v[190:191]
  s_waitcnt lgkmcnt(0)
  v_pk_add_f32 v[212:213], v[212:213], v[196:197]
  v_pk_add_f32 v[220:221], v[220:221], v[204:205]
  v_pk_add_f32 v[214:215], v[214:215], v[198:199]
  v_pk_add_f32 v[222:223], v[222:223], v[206:207]
  v_mov_b32 v228, 0x3baaaaab
  v_mov_b32 v229, 0x3baaaaab
  v_mov_b32 v230, 0x3727c5ac
  v_pk_mul_f32 v[212:213], v[212:213], v[228:229]
  v_pk_mul_f32 v[220:221], v[220:221], v[228:229]
  v_pk_mul_f32 v[214:215], v[214:215], v[228:229]
  v_pk_mul_f32 v[222:223], v[222:223], v[228:229]
  v_pk_fma_f32 v[220:221], v[212:213], v[212:213], v[220:221] neg_lo:[1,0,0] neg_hi:[1,0,0]
  v_pk_fma_f32 v[222:223], v[214:215], v[214:215], v[222:223] neg_lo:[1,0,0] neg_hi:[1,0,0]
  v_max_f32 v220, 0, v220
  v_max_f32 v221, 0, v221
  v_max_f32 v222, 0, v222
  v_max_f32 v223, 0, v223
  v_add_f32 v220, v230, v220
  v_add_f32 v221, v230, v221
  v_add_f32 v222, v230, v222
  v_add_f32 v223, v230, v223
  v_rsq_f32 v228, v220
  v_rsq_f32 v229, v221
  v_rsq_f32 v230, v222
  v_rsq_f32 v231, v223
  s_nop 0
  v_mul_f32 v228, s30, v228
  v_mul_f32 v229, s30, v229
  v_mul_f32 v230, s30, v230
  v_mul_f32 v231, s30, v231
  v_pk_mul_f32 v[236:237], v[212:213], v[228:229]
  v_pk_mul_f32 v[238:239], v[214:215], v[230:231]
  v_add_u32 v30, 32768, v15
  s_mov_b64 s[62:63], exec
  s_mov_b64 exec, s[60:61]
  v_pk_fma_f32 v[32:33], v[32:33], v[228:229], v[236:237] neg_lo:[0,0,1] neg_hi:[0,0,1]
  v_pk_fma_f32 v[34:35], v[34:35], v[230:231], v[238:239] neg_lo:[0,0,1] neg_hi:[0,0,1]
  v_pk_fma_f32 v[36:37], v[36:37], v[228:229], v[236:237] neg_lo:[0,0,1] neg_hi:[0,0,1]
  v_pk_fma_f32 v[38:39], v[38:39], v[230:231], v[238:239] neg_lo:[0,0,1] neg_hi:[0,0,1]
  v_pk_fma_f32 v[40:41], v[40:41], v[228:229], v[236:237] neg_lo:[0,0,1] neg_hi:[0,0,1]
  v_pk_fma_f32 v[42:43], v[42:43], v[230:231], v[238:239] neg_lo:[0,0,1] neg_hi:[0,0,1]
  v_pk_fma_f32 v[44:45], v[44:45], v[228:229], v[236:237] neg_lo:[0,0,1] neg_hi:[0,0,1]
  v_pk_fma_f32 v[46:47], v[46:47], v[230:231], v[238:239] neg_lo:[0,0,1] neg_hi:[0,0,1]
  v_pk_fma_f32 v[48:49], v[48:49], v[228:229], v[236:237] neg_lo:[0,0,1] neg_hi:[0,0,1]
  v_pk_fma_f32 v[50:51], v[50:51], v[230:231], v[238:239] neg_lo:[0,0,1] neg_hi:[0,0,1]
  v_pk_fma_f32 v[52:53], v[52:53], v[228:229], v[236:237] neg_lo:[0,0,1] neg_hi:[0,0,1]
  v_pk_fma_f32 v[54:55], v[54:55], v[230:231], v[238:239] neg_lo:[0,0,1] neg_hi:[0,0,1]
  v_pk_fma_f32 v[56:57], v[56:57], v[228:229], v[236:237] neg_lo:[0,0,1] neg_hi:[0,0,1]
  v_pk_fma_f32 v[58:59], v[58:59], v[230:231], v[238:239] neg_lo:[0,0,1] neg_hi:[0,0,1]
  v_pk_fma_f32 v[60:61], v[60:61], v[228:229], v[236:237] neg_lo:[0,0,1] neg_hi:[0,0,1]
  v_pk_fma_f32 v[62:63], v[62:63], v[230:231], v[238:239] neg_lo:[0,0,1] neg_hi:[0,0,1]
  v_pk_fma_f32 v[64:65], v[64:65], v[228:229], v[236:237] neg_lo:[0,0,1] neg_hi:[0,0,1]
  v_pk_fma_f32 v[66:67], v[66:67], v[230:231], v[238:239] neg_lo:[0,0,1] neg_hi:[0,0,1]
  v_pk_fma_f32 v[68:69], v[68:69], v[228:229], v[236:237] neg_lo:[0,0,1] neg_hi:[0,0,1]
  v_pk_fma_f32 v[70:71], v[70:71], v[230:231], v[238:239] neg_lo:[0,0,1] neg_hi:[0,0,1]
  v_pk_fma_f32 v[72:73], v[72:73], v[228:229], v[236:237] neg_lo:[0,0,1] neg_hi:[0,0,1]
  v_pk_fma_f32 v[74:75], v[74:75], v[230:231], v[238:239] neg_lo:[0,0,1] neg_hi:[0,0,1]
  v_pk_fma_f32 v[76:77], v[76:77], v[228:229], v[236:237] neg_lo:[0,0,1] neg_hi:[0,0,1]
  v_pk_fma_f32 v[78:79], v[78:79], v[230:231], v[238:239] neg_lo:[0,0,1] neg_hi:[0,0,1]
  v_pk_fma_f32 v[80:81], v[80:81], v[228:229], v[236:237] neg_lo:[0,0,1] neg_hi:[0,0,1]
  v_pk_fma_f32 v[82:83], v[82:83], v[230:231], v[238:239] neg_lo:[0,0,1] neg_hi:[0,0,1]
  v_pk_fma_f32 v[84:85], v[84:85], v[228:229], v[236:237] neg_lo:[0,0,1] neg_hi:[0,0,1]
  v_pk_fma_f32 v[86:87], v[86:87], v[230:231], v[238:239] neg_lo:[0,0,1] neg_hi:[0,0,1]
  v_pk_fma_f32 v[88:89], v[88:89], v[228:229], v[236:237] neg_lo:[0,0,1] neg_hi:[0,0,1]
  v_pk_fma_f32 v[90:91], v[90:91], v[230:231], v[238:239] neg_lo:[0,0,1] neg_hi:[0,0,1]
  v_pk_fma_f32 v[92:93], v[92:93], v[228:229], v[236:237] neg_lo:[0,0,1] neg_hi:[0,0,1]
  v_pk_fma_f32 v[94:95], v[94:95], v[230:231], v[238:239] neg_lo:[0,0,1] neg_hi:[0,0,1]
  v_pk_fma_f32 v[96:97], v[96:97], v[228:229], v[236:237] neg_lo:[0,0,1] neg_hi:[0,0,1]
  v_pk_fma_f32 v[98:99], v[98:99], v[230:231], v[238:239] neg_lo:[0,0,1] neg_hi:[0,0,1]
  v_pk_fma_f32 v[100:101], v[100:101], v[228:229], v[236:237] neg_lo:[0,0,1] neg_hi:[0,0,1]
  v_pk_fma_f32 v[102:103], v[102:103], v[230:231], v[238:239] neg_lo:[0,0,1] neg_hi:[0,0,1]
  v_pk_fma_f32 v[104:105], v[104:105], v[228:229], v[236:237] neg_lo:[0,0,1] neg_hi:[0,0,1]
  v_pk_fma_f32 v[106:107], v[106:107], v[230:231], v[238:239] neg_lo:[0,0,1] neg_hi:[0,0,1]
  v_pk_fma_f32 v[108:109], v[108:109], v[228:229], v[236:237] neg_lo:[0,0,1] neg_hi:[0,0,1]
  v_pk_fma_f32 v[110:111], v[110:111], v[230:231], v[238:239] neg_lo:[0,0,1] neg_hi:[0,0,1]
  v_pk_fma_f32 v[112:113], v[112:113], v[228:229], v[236:237] neg_lo:[0,0,1] neg_hi:[0,0,1]
  v_pk_fma_f32 v[114:115], v[114:115], v[230:231], v[238:239] neg_lo:[0,0,1] neg_hi:[0,0,1]
  v_pk_fma_f32 v[116:117], v[116:117], v[228:229], v[236:237] neg_lo:[0,0,1] neg_hi:[0,0,1]
  v_pk_fma_f32 v[118:119], v[118:119], v[230:231], v[238:239] neg_lo:[0,0,1] neg_hi:[0,0,1]
  v_pk_fma_f32 v[120:121], v[120:121], v[228:229], v[236:237] neg_lo:[0,0,1] neg_hi:[0,0,1]
  v_pk_fma_f32 v[122:123], v[122:123], v[230:231], v[238:239] neg_lo:[0,0,1] neg_hi:[0,0,1]
  v_pk_fma_f32 v[124:125], v[124:125], v[228:229], v[236:237] neg_lo:[0,0,1] neg_hi:[0,0,1]
  v_pk_fma_f32 v[126:127], v[126:127], v[230:231], v[238:239] neg_lo:[0,0,1] neg_hi:[0,0,1]
  v_cvt_pk_bf16_f32 v128, v32, v36
  v_cvt_pk_bf16_f32 v129, v40, v44
  v_cvt_pk_bf16_f32 v130, v48, v52
  v_cvt_pk_bf16_f32 v131, v56, v60
  ds_write_b128 v15, v[128:131] offset:0
  v_cvt_pk_bf16_f32 v132, v33, v37
  v_cvt_pk_bf16_f32 v133, v41, v45
  v_cvt_pk_bf16_f32 v134, v49, v53
  v_cvt_pk_bf16_f32 v135, v57, v61
  ds_write_b128 v15, v[132:135] offset:18432
  v_cvt_pk_bf16_f32 v136, v34, v38
  v_cvt_pk_bf16_f32 v137, v42, v46
  v_cvt_pk_bf16_f32 v138, v50, v54
  v_cvt_pk_bf16_f32 v139, v58, v62
  ds_write_b128 v30, v[136:139] offset:4096
  v_cvt_pk_bf16_f32 v140, v35, v39
  v_cvt_pk_bf16_f32 v141, v43, v47
  v_cvt_pk_bf16_f32 v142, v51, v55
  v_cvt_pk_bf16_f32 v143, v59, v63
  ds_write_b128 v30, v[140:143] offset:22528
  v_cvt_pk_bf16_f32 v144, v64, v68
  v_cvt_pk_bf16_f32 v145, v72, v76
  v_cvt_pk_bf16_f32 v146, v80, v84
  v_cvt_pk_bf16_f32 v147, v88, v92
  ds_write_b128 v15, v[144:147] offset:6144
  v_cvt_pk_bf16_f32 v148, v65, v69
  v_cvt_pk_bf16_f32 v149, v73, v77
  v_cvt_pk_bf16_f32 v150, v81, v85
  v_cvt_pk_bf16_f32 v151, v89, v93
  ds_write_b128 v15, v[148:151] offset:24576
  v_cvt_pk_bf16_f32 v152, v66, v70
  v_cvt_pk_bf16_f32 v153, v74, v78
  v_cvt_pk_bf16_f32 v154, v82, v86
  v_cvt_pk_bf16_f32 v155, v90, v94
  ds_write_b128 v30, v[152:155] offset:10240
  v_cvt_pk_bf16_f32 v156, v67, v71
  v_cvt_pk_bf16_f32 v157, v75, v79
  v_cvt_pk_bf16_f32 v158, v83, v87
  v_cvt_pk_bf16_f32 v159, v91, v95
  ds_write_b128 v30, v[156:159] offset:28672
  v_cvt_pk_bf16_f32 v128, v96, v100
  v_cvt_pk_bf16_f32 v129, v104, v108
  v_cvt_pk_bf16_f32 v130, v112, v116
  v_cvt_pk_bf16_f32 v131, v120, v124
  ds_write_b128 v15, v[128:131] offset:12288
  v_cvt_pk_bf16_f32 v132, v97, v101
  v_cvt_pk_bf16_f32 v133, v105, v109
  v_cvt_pk_bf16_f32 v134, v113, v117
  v_cvt_pk_bf16_f32 v135, v121, v125
  ds_write_b128 v15, v[132:135] offset:30720
  v_cvt_pk_bf16_f32 v136, v98, v102
  v_cvt_pk_bf16_f32 v137, v106, v110
  v_cvt_pk_bf16_f32 v138, v114, v118
  v_cvt_pk_bf16_f32 v139, v122, v126
  ds_write_b128 v30, v[136:139] offset:16384
  v_cvt_pk_bf16_f32 v140, v99, v103
  v_cvt_pk_bf16_f32 v141, v107, v111
  v_cvt_pk_bf16_f32 v142, v115, v119
  v_cvt_pk_bf16_f32 v143, v123, v127
  ds_write_b128 v30, v[140:143] offset:34816
  s_mov_b64 exec, s[62:63]
  s_waitcnt vmcnt(0)
  s_waitcnt lgkmcnt(0)
  s_barrier
  s_mul_i32 s24, s33, 18432
  s_add_u32 s24, s24, 73728
  v_add_u32 v30, s24, v1
  ds_read_b128 v[52:55], v17 offset:0
  ds_read_b128 v[56:59], v17 offset:1024
  ds_read_b128 v[60:63], v17 offset:2048
  ds_read_b128 v[104:107], v30 offset:0
  ds_read_b128 v[108:111], v30 offset:1024
  ds_read_b128 v[112:115], v30 offset:2048
  ds_read_b128 v[116:119], v30 offset:3072
  ds_read_b128 v[120:123], v30 offset:4096
  ds_read_b128 v[124:127], v30 offset:5120
  ds_read_b128 v[128:131], v30 offset:6144
  ds_read_b128 v[132:135], v30 offset:7168
  ds_read_b128 v[136:139], v30 offset:8192
  ds_read_b128 v[140:143], v30 offset:9216
  ds_read_b128 v[144:147], v30 offset:10240
  ds_read_b128 v[148:151], v30 offset:11264
  ds_read_b128 v[152:155], v30 offset:12288
  ds_read_b128 v[156:159], v30 offset:13312
  ds_read_b128 v[160:163], v30 offset:14336
  ds_read_b128 v[164:167], v30 offset:15360
  ds_read_b128 v[168:171], v30 offset:16384
  ds_read_b128 v[172:175], v30 offset:17408
  s_waitcnt lgkmcnt(15)
  v_mfma_f32_16x16x32_bf16 v[80:83], v[52:55], v[104:107], 0
  ds_read_b128 v[64:67], v17 offset:3072
  v_mfma_f32_16x16x32_bf16 v[84:87], v[52:55], v[108:111], 0
  v_mfma_f32_16x16x32_bf16 v[88:91], v[52:55], v[112:115], 0
  s_add_u32 m0, s57, 24576
  s_mov_b32 s34, 24576
  buffer_load_dwordx4 v20, s[8:11], s34 offen lds
  s_waitcnt lgkmcnt(13)
  v_mfma_f32_16x16x32_bf16 v[80:83], v[56:59], v[116:119], v[80:83]
  ds_read_b128 v[52:55], v17 offset:4096
  v_mfma_f32_16x16x32_bf16 v[84:87], v[56:59], v[120:123], v[84:87]
  v_mfma_f32_16x16x32_bf16 v[88:91], v[56:59], v[124:127], v[88:91]
  s_waitcnt lgkmcnt(1)
  v_mfma_f32_16x16x32_bf16 v[80:83], v[60:63], v[128:131], v[80:83]
  ds_read_b128 v[56:59], v17 offset:5120
  v_mfma_f32_16x16x32_bf16 v[84:87], v[60:63], v[132:135], v[84:87]
  v_mfma_f32_16x16x32_bf16 v[88:91], v[60:63], v[136:139], v[88:91]
  s_add_u32 m0, s57, 25600
  s_mov_b32 s34, 25600
  buffer_load_dwordx4 v20, s[8:11], s34 offen lds
  v_mfma_f32_16x16x32_bf16 v[80:83], v[64:67], v[140:143], v[80:83]
  v_mfma_f32_16x16x32_bf16 v[84:87], v[64:67], v[144:147], v[84:87]
  v_mfma_f32_16x16x32_bf16 v[88:91], v[64:67], v[148:151], v[88:91]
  s_setprio 2
  s_waitcnt lgkmcnt(0)
  v_mfma_f32_16x16x32_bf16 v[80:83], v[52:55], v[152:155], v[80:83]
  v_mfma_f32_16x16x32_bf16 v[84:87], v[52:55], v[156:159], v[84:87]
  v_mfma_f32_16x16x32_bf16 v[88:91], v[52:55], v[160:163], v[88:91]
  s_add_u32 m0, s57, 26624
  s_mov_b32 s34, 26624
  buffer_load_dwordx4 v20, s[8:11], s34 offen lds
  v_mfma_f32_16x16x32_bf16 v[80:83], v[56:59], v[164:167], v[80:83]
  v_mfma_f32_16x16x32_bf16 v[84:87], v[56:59], v[168:171], v[84:87]
  v_mfma_f32_16x16x32_bf16 v[88:91], v[56:59], v[172:175], v[88:91]
  s_setprio 1
  s_setprio 0
  s_nop 7
  v_cvt_pk_f16_f32 v32, v80, v81
  v_pk_fma_f16 v33, v32, v32, s92
  s_nop 0
  v_pk_mul_f16 v33, v33, v32 neg_lo:[1,0] neg_hi:[1,0]
  v_exp_f16_sdwa v32, v33 dst_sel:WORD_0 dst_unused:UNUSED_PAD src0_sel:WORD_0
  s_nop 0
  v_exp_f16_sdwa v32, v33 dst_sel:WORD_1 dst_unused:UNUSED_PRESERVE src0_sel:WORD_1
  s_waitcnt lgkmcnt(0)
  s_barrier
  s_setprio 3
  ds_read_b128 v[52:55], v16 offset:0
  v_pk_fma_f16 v32, v32, s93, s93
  v_rcp_f16_sdwa v33, v32 dst_sel:WORD_0 dst_unused:UNUSED_PAD src0_sel:WORD_0
  s_nop 0
  v_rcp_f16_sdwa v33, v32 dst_sel:WORD_1 dst_unused:UNUSED_PRESERVE src0_sel:WORD_1
  s_nop 0
  v_fma_mix_f32 v32, v80, v33, 0 op_sel_hi:[0,1,0]
  v_fma_mix_f32 v33, v81, v33, 0 op_sel:[0,1,0] op_sel_hi:[0,1,0]
  v_cvt_pk_bf16_f32 v36, v32, v33
  ds_read_b128 v[56:59], v16 offset:1024
  v_cvt_pk_f16_f32 v34, v82, v83
  v_pk_fma_f16 v35, v34, v34, s92
  s_nop 0
  v_pk_mul_f16 v35, v35, v34 neg_lo:[1,0] neg_hi:[1,0]
  v_exp_f16_sdwa v34, v35 dst_sel:WORD_0 dst_unused:UNUSED_PAD src0_sel:WORD_0
  s_nop 0
  v_exp_f16_sdwa v34, v35 dst_sel:WORD_1 dst_unused:UNUSED_PRESERVE src0_sel:WORD_1
  s_add_u32 m0, s57, 49152
  s_mov_b32 s94, 49152
  buffer_load_dwordx4 v20, s[8:11], s94 offen offset:0 lds
  ds_read_b128 v[60:63], v16 offset:2048
  v_pk_fma_f16 v34, v34, s93, s93
  v_rcp_f16_sdwa v35, v34 dst_sel:WORD_0 dst_unused:UNUSED_PAD src0_sel:WORD_0
  s_nop 0
  v_rcp_f16_sdwa v35, v34 dst_sel:WORD_1 dst_unused:UNUSED_PRESERVE src0_sel:WORD_1
  s_nop 0
  v_fma_mix_f32 v34, v82, v35, 0 op_sel_hi:[0,1,0]
  v_fma_mix_f32 v35, v83, v35, 0 op_sel:[0,1,0] op_sel_hi:[0,1,0]
  v_cvt_pk_bf16_f32 v37, v34, v35
  ds_write_b64 v19, v[36:37] offset:0
  s_waitcnt lgkmcnt(2)
  v_mfma_f32_16x16x32_bf16 v[92:95], v[52:55], v[104:107], 0
  ds_read_b128 v[64:67], v16 offset:3072
  v_cvt_pk_f16_f32 v32, v84, v85
  v_pk_fma_f16 v33, v32, v32, s92
  v_mfma_f32_16x16x32_bf16 v[96:99], v[52:55], v[108:111], 0
  v_pk_mul_f16 v33, v33, v32 neg_lo:[1,0] neg_hi:[1,0]
  v_exp_f16_sdwa v32, v33 dst_sel:WORD_0 dst_unused:UNUSED_PAD src0_sel:WORD_0
  v_mfma_f32_16x16x32_bf16 v[100:103], v[52:55], v[112:115], 0
  v_exp_f16_sdwa v32, v33 dst_sel:WORD_1 dst_unused:UNUSED_PRESERVE src0_sel:WORD_1
  buffer_load_dwordx4 v20, s[8:11], s94 offen offset:1024 lds
  v_mfma_f32_16x16x32_bf16 v[92:95], v[56:59], v[116:119], v[92:95]
  ds_read_b128 v[52:55], v16 offset:4096
  v_pk_fma_f16 v32, v32, s93, s93
  v_rcp_f16_sdwa v33, v32 dst_sel:WORD_0 dst_unused:UNUSED_PAD src0_sel:WORD_0
  v_mfma_f32_16x16x32_bf16 v[96:99], v[56:59], v[120:123], v[96:99]
  v_rcp_f16_sdwa v33, v32 dst_sel:WORD_1 dst_unused:UNUSED_PRESERVE src0_sel:WORD_1
  v_mfma_f32_16x16x32_bf16 v[100:103], v[56:59], v[124:127], v[100:103]
  v_fma_mix_f32 v32, v84, v33, 0 op_sel_hi:[0,1,0]
  v_fma_mix_f32 v33, v85, v33, 0 op_sel:[0,1,0] op_sel_hi:[0,1,0]
  v_cvt_pk_bf16_f32 v38, v32, v33
  s_waitcnt lgkmcnt(1)
  v_mfma_f32_16x16x32_bf16 v[92:95], v[60:63], v[128:131], v[92:95]
  ds_read_b128 v[56:59], v16 offset:5120
  v_cvt_pk_f16_f32 v34, v86, v87
  v_pk_fma_f16 v35, v34, v34, s92
  v_mfma_f32_16x16x32_bf16 v[96:99], v[60:63], v[132:135], v[96:99]
  v_pk_mul_f16 v35, v35, v34 neg_lo:[1,0] neg_hi:[1,0]
  v_exp_f16_sdwa v34, v35 dst_sel:WORD_0 dst_unused:UNUSED_PAD src0_sel:WORD_0
  v_mfma_f32_16x16x32_bf16 v[100:103], v[60:63], v[136:139], v[100:103]
  v_exp_f16_sdwa v34, v35 dst_sel:WORD_1 dst_unused:UNUSED_PRESERVE src0_sel:WORD_1
  buffer_load_dwordx4 v20, s[8:11], s94 offen offset:2048 lds
  v_mfma_f32_16x16x32_bf16 v[92:95], v[64:67], v[140:143], v[92:95]
  v_pk_fma_f16 v34, v34, s93, s93
  v_rcp_f16_sdwa v35, v34 dst_sel:WORD_0 dst_unused:UNUSED_PAD src0_sel:WORD_0
  v_mfma_f32_16x16x32_bf16 v[96:99], v[64:67], v[144:147], v[96:99]
  v_rcp_f16_sdwa v35, v34 dst_sel:WORD_1 dst_unused:UNUSED_PRESERVE src0_sel:WORD_1
  v_mfma_f32_16x16x32_bf16 v[100:103], v[64:67], v[148:151], v[100:103]
  v_fma_mix_f32 v34, v86, v35, 0 op_sel_hi:[0,1,0]
  v_fma_mix_f32 v35, v87, v35, 0 op_sel:[0,1,0] op_sel_hi:[0,1,0]
  v_cvt_pk_bf16_f32 v39, v34, v35
  ds_write_b64 v19, v[38:39] offset:1024
  s_setprio 2
  s_waitcnt lgkmcnt(1)
  v_mfma_f32_16x16x32_bf16 v[92:95], v[52:55], v[152:155], v[92:95]
  v_cvt_pk_f16_f32 v32, v88, v89
  v_pk_fma_f16 v33, v32, v32, s92
  v_mfma_f32_16x16x32_bf16 v[96:99], v[52:55], v[156:159], v[96:99]
  v_pk_mul_f16 v33, v33, v32 neg_lo:[1,0] neg_hi:[1,0]
  v_exp_f16_sdwa v32, v33 dst_sel:WORD_0 dst_unused:UNUSED_PAD src0_sel:WORD_0
  v_mfma_f32_16x16x32_bf16 v[100:103], v[52:55], v[160:163], v[100:103]
  v_exp_f16_sdwa v32, v33 dst_sel:WORD_1 dst_unused:UNUSED_PRESERVE src0_sel:WORD_1
  v_mfma_f32_16x16x32_bf16 v[92:95], v[56:59], v[164:167], v[92:95]
  v_pk_fma_f16 v32, v32, s93, s93
  v_rcp_f16_sdwa v33, v32 dst_sel:WORD_0 dst_unused:UNUSED_PAD src0_sel:WORD_0
  v_mfma_f32_16x16x32_bf16 v[96:99], v[56:59], v[168:171], v[96:99]
  v_rcp_f16_sdwa v33, v32 dst_sel:WORD_1 dst_unused:UNUSED_PRESERVE src0_sel:WORD_1
  v_mfma_f32_16x16x32_bf16 v[100:103], v[56:59], v[172:175], v[100:103]
  v_fma_mix_f32 v32, v88, v33, 0 op_sel_hi:[0,1,0]
  v_fma_mix_f32 v33, v89, v33, 0 op_sel:[0,1,0] op_sel_hi:[0,1,0]
  v_cvt_pk_bf16_f32 v36, v32, v33
  v_cvt_pk_f16_f32 v34, v90, v91
  v_pk_fma_f16 v35, v34, v34, s92
  s_nop 0
  v_pk_mul_f16 v35, v35, v34 neg_lo:[1,0] neg_hi:[1,0]
  v_exp_f16_sdwa v34, v35 dst_sel:WORD_0 dst_unused:UNUSED_PAD src0_sel:WORD_0
  s_nop 0
  v_exp_f16_sdwa v34, v35 dst_sel:WORD_1 dst_unused:UNUSED_PRESERVE src0_sel:WORD_1
  s_add_u32 s32, s32, 16
  s_cmp_eq_u32 s56, 2
  s_cselect_b32 s6, 0, s6
  s_mov_b32 s22, 56623104
  s_setprio 1
  v_pk_fma_f16 v34, v34, s93, s93
  v_rcp_f16_sdwa v35, v34 dst_sel:WORD_0 dst_unused:UNUSED_PAD src0_sel:WORD_0
  s_nop 0
  v_rcp_f16_sdwa v35, v34 dst_sel:WORD_1 dst_unused:UNUSED_PRESERVE src0_sel:WORD_1
  s_nop 0
  v_fma_mix_f32 v34, v90, v35, 0 op_sel_hi:[0,1,0]
  v_fma_mix_f32 v35, v91, v35, 0 op_sel:[0,1,0] op_sel_hi:[0,1,0]
  v_cvt_pk_bf16_f32 v37, v34, v35
  ds_write_b64 v19, v[36:37] offset:2048
  s_setprio 0
  v_cvt_pk_f16_f32 v32, v92, v93
  v_pk_fma_f16 v33, v32, v32, s92
  s_nop 0
  v_pk_mul_f16 v33, v33, v32 neg_lo:[1,0] neg_hi:[1,0]
  v_exp_f16_sdwa v32, v33 dst_sel:WORD_0 dst_unused:UNUSED_PAD src0_sel:WORD_0
  s_nop 0
  v_exp_f16_sdwa v32, v33 dst_sel:WORD_1 dst_unused:UNUSED_PRESERVE src0_sel:WORD_1
  s_waitcnt vmcnt(3)
  s_waitcnt lgkmcnt(0)
  s_barrier
  s_setprio 3
  ds_read_b128 v[52:55], v16 offset:24576
  v_pk_fma_f16 v32, v32, s93, s93
  v_rcp_f16_sdwa v33, v32 dst_sel:WORD_0 dst_unused:UNUSED_PAD src0_sel:WORD_0
  s_nop 0
  v_rcp_f16_sdwa v33, v32 dst_sel:WORD_1 dst_unused:UNUSED_PRESERVE src0_sel:WORD_1
  s_nop 0
  v_fma_mix_f32 v32, v92, v33, 0 op_sel_hi:[0,1,0]
  v_fma_mix_f32 v33, v93, v33, 0 op_sel:[0,1,0] op_sel_hi:[0,1,0]
  v_cvt_pk_bf16_f32 v36, v32, v33
  ds_read_b128 v[56:59], v16 offset:25600
  v_cvt_pk_f16_f32 v34, v94, v95
  v_pk_fma_f16 v35, v34, v34, s92
  s_nop 0
  v_pk_mul_f16 v35, v35, v34 neg_lo:[1,0] neg_hi:[1,0]
  v_exp_f16_sdwa v34, v35 dst_sel:WORD_0 dst_unused:UNUSED_PAD src0_sel:WORD_0
  s_nop 0
  v_exp_f16_sdwa v34, v35 dst_sel:WORD_1 dst_unused:UNUSED_PRESERVE src0_sel:WORD_1
  s_add_u32 m0, s57, 0
  s_mov_b32 s94, 73728
  buffer_load_dwordx4 v20, s[8:11], s94 offen offset:0 lds
  ds_read_b128 v[60:63], v16 offset:26624
  v_pk_fma_f16 v34, v34, s93, s93
  v_rcp_f16_sdwa v35, v34 dst_sel:WORD_0 dst_unused:UNUSED_PAD src0_sel:WORD_0
  s_nop 0
  v_rcp_f16_sdwa v35, v34 dst_sel:WORD_1 dst_unused:UNUSED_PRESERVE src0_sel:WORD_1
  s_nop 0
  v_fma_mix_f32 v34, v94, v35, 0 op_sel_hi:[0,1,0]
  v_fma_mix_f32 v35, v95, v35, 0 op_sel:[0,1,0] op_sel_hi:[0,1,0]
  v_cvt_pk_bf16_f32 v37, v34, v35
  ds_write_b64 v19, v[36:37] offset:12288
  s_waitcnt lgkmcnt(2)
  v_mfma_f32_16x16x32_bf16 v[80:83], v[52:55], v[104:107], 0
  ds_read_b128 v[64:67], v16 offset:27648
  ds_read_b128 v[68:71], v18 offset:0
  v_cvt_pk_f16_f32 v32, v96, v97
  v_pk_fma_f16 v33, v32, v32, s92
  v_mfma_f32_16x16x32_bf16 v[84:87], v[52:55], v[108:111], 0
  v_pk_mul_f16 v33, v33, v32 neg_lo:[1,0] neg_hi:[1,0]
  v_exp_f16_sdwa v32, v33 dst_sel:WORD_0 dst_unused:UNUSED_PAD src0_sel:WORD_0
  v_mfma_f32_16x16x32_bf16 v[88:91], v[52:55], v[112:115], 0
  v_exp_f16_sdwa v32, v33 dst_sel:WORD_1 dst_unused:UNUSED_PRESERVE src0_sel:WORD_1
  buffer_load_dwordx4 v20, s[8:11], s94 offen offset:1024 lds
  v_mfma_f32_16x16x32_bf16 v[80:83], v[56:59], v[116:119], v[80:83]
  ds_read_b128 v[52:55], v16 offset:28672
  ds_read_b128 v[72:75], v18 offset:1024
  v_pk_fma_f16 v32, v32, s93, s93
  v_rcp_f16_sdwa v33, v32 dst_sel:WORD_0 dst_unused:UNUSED_PAD src0_sel:WORD_0
  v_mfma_f32_16x16x32_bf16 v[84:87], v[56:59], v[120:123], v[84:87]
  v_rcp_f16_sdwa v33, v32 dst_sel:WORD_1 dst_unused:UNUSED_PRESERVE src0_sel:WORD_1
  v_mfma_f32_16x16x32_bf16 v[88:91], v[56:59], v[124:127], v[88:91]
  v_fma_mix_f32 v32, v96, v33, 0 op_sel_hi:[0,1,0]
  v_fma_mix_f32 v33, v97, v33, 0 op_sel:[0,1,0] op_sel_hi:[0,1,0]
  v_cvt_pk_bf16_f32 v38, v32, v33
  s_waitcnt lgkmcnt(3)
  v_mfma_f32_16x16x32_bf16 v[80:83], v[60:63], v[128:131], v[80:83]
  ds_read_b128 v[56:59], v16 offset:29696
  ds_read_b128 v[76:79], v18 offset:2048
  v_cvt_pk_f16_f32 v34, v98, v99
  v_pk_fma_f16 v35, v34, v34, s92
  v_mfma_f32_16x16x32_bf16 v[84:87], v[60:63], v[132:135], v[84:87]
  v_pk_mul_f16 v35, v35, v34 neg_lo:[1,0] neg_hi:[1,0]
  v_exp_f16_sdwa v34, v35 dst_sel:WORD_0 dst_unused:UNUSED_PAD src0_sel:WORD_0
  v_mfma_f32_16x16x32_bf16 v[88:91], v[60:63], v[136:139], v[88:91]
  v_exp_f16_sdwa v34, v35 dst_sel:WORD_1 dst_unused:UNUSED_PRESERVE src0_sel:WORD_1
  buffer_load_dwordx4 v20, s[8:11], s94 offen offset:2048 lds
  v_mfma_f32_16x16x32_bf16 v[80:83], v[64:67], v[140:143], v[80:83]
  ds_read_b128 v[60:63], v16 offset:36864
  v_pk_fma_f16 v34, v34, s93, s93
  v_rcp_f16_sdwa v35, v34 dst_sel:WORD_0 dst_unused:UNUSED_PAD src0_sel:WORD_0
  v_mfma_f32_16x16x32_bf16 v[84:87], v[64:67], v[144:147], v[84:87]
  v_rcp_f16_sdwa v35, v34 dst_sel:WORD_1 dst_unused:UNUSED_PRESERVE src0_sel:WORD_1
  v_mfma_f32_16x16x32_bf16 v[88:91], v[64:67], v[148:151], v[88:91]
  v_fma_mix_f32 v34, v98, v35, 0 op_sel_hi:[0,1,0]
  v_fma_mix_f32 v35, v99, v35, 0 op_sel:[0,1,0] op_sel_hi:[0,1,0]
  v_cvt_pk_bf16_f32 v39, v34, v35
  ds_write_b64 v19, v[38:39] offset:13312
  s_setprio 2
  s_waitcnt lgkmcnt(3)
  v_mfma_f32_16x16x32_bf16 v[80:83], v[52:55], v[152:155], v[80:83]
  ds_read_b128 v[64:67], v16 offset:37888
  v_cvt_pk_f16_f32 v32, v100, v101
  v_pk_fma_f16 v33, v32, v32, s92
  v_mfma_f32_16x16x32_bf16 v[84:87], v[52:55], v[156:159], v[84:87]
  v_pk_mul_f16 v33, v33, v32 neg_lo:[1,0] neg_hi:[1,0]
  v_exp_f16_sdwa v32, v33 dst_sel:WORD_0 dst_unused:UNUSED_PAD src0_sel:WORD_0
  v_mfma_f32_16x16x32_bf16 v[88:91], v[52:55], v[160:163], v[88:91]
  v_exp_f16_sdwa v32, v33 dst_sel:WORD_1 dst_unused:UNUSED_PRESERVE src0_sel:WORD_1
  v_mfma_f32_16x16x32_bf16 v[80:83], v[56:59], v[164:167], v[80:83]
  ds_read_b128 v[52:55], v16 offset:38912
  v_pk_fma_f16 v32, v32, s93, s93
  v_rcp_f16_sdwa v33, v32 dst_sel:WORD_0 dst_unused:UNUSED_PAD src0_sel:WORD_0
  v_mfma_f32_16x16x32_bf16 v[84:87], v[56:59], v[168:171], v[84:87]
  v_rcp_f16_sdwa v33, v32 dst_sel:WORD_1 dst_unused:UNUSED_PRESERVE src0_sel:WORD_1
  v_mfma_f32_16x16x32_bf16 v[88:91], v[56:59], v[172:175], v[88:91]
  v_fma_mix_f32 v32, v100, v33, 0 op_sel_hi:[0,1,0]
  v_fma_mix_f32 v33, v101, v33, 0 op_sel:[0,1,0] op_sel_hi:[0,1,0]
  v_cvt_pk_bf16_f32 v36, v32, v33
  s_waitcnt lgkmcnt(1)
  v_mfma_f32_16x16x32_bf16 v[176:179], v[60:63], v[68:71], 0
  ds_read_b128 v[56:59], v16 offset:39936
  v_cvt_pk_f16_f32 v34, v102, v103
  v_pk_fma_f16 v35, v34, v34, s92
  v_mfma_f32_16x16x32_bf16 v[184:187], v[60:63], v[72:75], 0
  v_pk_mul_f16 v35, v35, v34 neg_lo:[1,0] neg_hi:[1,0]
  v_exp_f16_sdwa v34, v35 dst_sel:WORD_0 dst_unused:UNUSED_PAD src0_sel:WORD_0
  v_mfma_f32_16x16x32_bf16 v[192:195], v[60:63], v[76:79], 0
  v_exp_f16_sdwa v34, v35 dst_sel:WORD_1 dst_unused:UNUSED_PRESERVE src0_sel:WORD_1
  s_setprio 1
  v_mfma_f32_16x16x32_bf16 v[180:183], v[64:67], v[68:71], 0
  ds_read_b128 v[60:63], v16 offset:40960
  v_pk_fma_f16 v34, v34, s93, s93
  v_rcp_f16_sdwa v35, v34 dst_sel:WORD_0 dst_unused:UNUSED_PAD src0_sel:WORD_0
  v_mfma_f32_16x16x32_bf16 v[188:191], v[64:67], v[72:75], 0
  v_rcp_f16_sdwa v35, v34 dst_sel:WORD_1 dst_unused:UNUSED_PRESERVE src0_sel:WORD_1
  v_mfma_f32_16x16x32_bf16 v[196:199], v[64:67], v[76:79], 0
  v_fma_mix_f32 v34, v102, v35, 0 op_sel_hi:[0,1,0]
  v_fma_mix_f32 v35, v103, v35, 0 op_sel:[0,1,0] op_sel_hi:[0,1,0]
  v_cvt_pk_bf16_f32 v37, v34, v35
  ds_write_b64 v19, v[36:37] offset:14336
  s_setprio 0
  s_waitcnt lgkmcnt(2)
  v_mfma_f32_16x16x32_bf16 v[200:203], v[52:55], v[68:71], 0
  ds_read_b128 v[64:67], v16 offset:41984
  v_cvt_pk_f16_f32 v32, v80, v81
  v_pk_fma_f16 v33, v32, v32, s92
  v_mfma_f32_16x16x32_bf16 v[208:211], v[52:55], v[72:75], 0
  v_pk_mul_f16 v33, v33, v32 neg_lo:[1,0] neg_hi:[1,0]
  v_exp_f16_sdwa v32, v33 dst_sel:WORD_0 dst_unused:UNUSED_PAD src0_sel:WORD_0
  v_mfma_f32_16x16x32_bf16 v[216:219], v[52:55], v[76:79], 0
  v_exp_f16_sdwa v32, v33 dst_sel:WORD_1 dst_unused:UNUSED_PRESERVE src0_sel:WORD_1
  v_mfma_f32_16x16x32_bf16 v[204:207], v[56:59], v[68:71], 0
  s_waitcnt vmcnt(3)
  s_waitcnt lgkmcnt(0)
  s_barrier
  s_setprio 3
  ds_read_b128 v[52:55], v17 offset:0
  v_pk_fma_f16 v32, v32, s93, s93
  v_rcp_f16_sdwa v33, v32 dst_sel:WORD_0 dst_unused:UNUSED_PAD src0_sel:WORD_0
  v_mfma_f32_16x16x32_bf16 v[212:215], v[56:59], v[72:75], 0
  v_rcp_f16_sdwa v33, v32 dst_sel:WORD_1 dst_unused:UNUSED_PRESERVE src0_sel:WORD_1
  v_mfma_f32_16x16x32_bf16 v[220:223], v[56:59], v[76:79], 0
  v_fma_mix_f32 v32, v80, v33, 0 op_sel_hi:[0,1,0]
  v_fma_mix_f32 v33, v81, v33, 0 op_sel:[0,1,0] op_sel_hi:[0,1,0]
  v_cvt_pk_bf16_f32 v36, v32, v33
  v_mfma_f32_16x16x32_bf16 v[224:227], v[60:63], v[68:71], 0
  ds_read_b128 v[56:59], v17 offset:1024
  v_cvt_pk_f16_f32 v34, v82, v83
  v_pk_fma_f16 v35, v34, v34, s92
  v_mfma_f32_16x16x32_bf16 v[232:235], v[60:63], v[72:75], 0
  v_pk_mul_f16 v35, v35, v34 neg_lo:[1,0] neg_hi:[1,0]
  v_exp_f16_sdwa v34, v35 dst_sel:WORD_0 dst_unused:UNUSED_PAD src0_sel:WORD_0
  v_mfma_f32_16x16x32_bf16 v[240:243], v[60:63], v[76:79], 0
  v_exp_f16_sdwa v34, v35 dst_sel:WORD_1 dst_unused:UNUSED_PRESERVE src0_sel:WORD_1
  s_add_u32 m0, s57, 24576
  s_mov_b32 s94, 98304
  buffer_load_dwordx4 v20, s[8:11], s94 offen offset:0 lds
  v_mfma_f32_16x16x32_bf16 v[228:231], v[64:67], v[68:71], 0
  ds_read_b128 v[60:63], v17 offset:2048
  v_pk_fma_f16 v34, v34, s93, s93
  v_rcp_f16_sdwa v35, v34 dst_sel:WORD_0 dst_unused:UNUSED_PAD src0_sel:WORD_0
  v_mfma_f32_16x16x32_bf16 v[236:239], v[64:67], v[72:75], 0
  v_rcp_f16_sdwa v35, v34 dst_sel:WORD_1 dst_unused:UNUSED_PRESERVE src0_sel:WORD_1
  v_mfma_f32_16x16x32_bf16 v[244:247], v[64:67], v[76:79], 0
  v_fma_mix_f32 v34, v82, v35, 0 op_sel_hi:[0,1,0]
  v_fma_mix_f32 v35, v83, v35, 0 op_sel:[0,1,0] op_sel_hi:[0,1,0]
  v_cvt_pk_bf16_f32 v37, v34, v35
  ds_write_b64 v19, v[36:37] offset:0
  s_waitcnt lgkmcnt(2)
  v_mfma_f32_16x16x32_bf16 v[92:95], v[52:55], v[104:107], 0
  ds_read_b128 v[64:67], v17 offset:3072
  ds_read_b128 v[68:71], v18 offset:12288
  v_cvt_pk_f16_f32 v32, v84, v85
  v_pk_fma_f16 v33, v32, v32, s92
  v_mfma_f32_16x16x32_bf16 v[96:99], v[52:55], v[108:111], 0
  v_pk_mul_f16 v33, v33, v32 neg_lo:[1,0] neg_hi:[1,0]
  v_exp_f16_sdwa v32, v33 dst_sel:WORD_0 dst_unused:UNUSED_PAD src0_sel:WORD_0
  v_mfma_f32_16x16x32_bf16 v[100:103], v[52:55], v[112:115], 0
  v_exp_f16_sdwa v32, v33 dst_sel:WORD_1 dst_unused:UNUSED_PRESERVE src0_sel:WORD_1
  buffer_load_dwordx4 v20, s[8:11], s94 offen offset:1024 lds
  v_mfma_f32_16x16x32_bf16 v[92:95], v[56:59], v[116:119], v[92:95]
  ds_read_b128 v[52:55], v17 offset:4096
  ds_read_b128 v[72:75], v18 offset:13312
  v_pk_fma_f16 v32, v32, s93, s93
  v_rcp_f16_sdwa v33, v32 dst_sel:WORD_0 dst_unused:UNUSED_PAD src0_sel:WORD_0
  v_mfma_f32_16x16x32_bf16 v[96:99], v[56:59], v[120:123], v[96:99]
  v_rcp_f16_sdwa v33, v32 dst_sel:WORD_1 dst_unused:UNUSED_PRESERVE src0_sel:WORD_1
  v_mfma_f32_16x16x32_bf16 v[100:103], v[56:59], v[124:127], v[100:103]
  v_fma_mix_f32 v32, v84, v33, 0 op_sel_hi:[0,1,0]
  v_fma_mix_f32 v33, v85, v33, 0 op_sel:[0,1,0] op_sel_hi:[0,1,0]
  v_cvt_pk_bf16_f32 v38, v32, v33
  s_waitcnt lgkmcnt(3)
  v_mfma_f32_16x16x32_bf16 v[92:95], v[60:63], v[128:131], v[92:95]
  ds_read_b128 v[56:59], v17 offset:5120
  ds_read_b128 v[76:79], v18 offset:14336
  v_cvt_pk_f16_f32 v34, v86, v87
  v_pk_fma_f16 v35, v34, v34, s92
  v_mfma_f32_16x16x32_bf16 v[96:99], v[60:63], v[132:135], v[96:99]
  v_pk_mul_f16 v35, v35, v34 neg_lo:[1,0] neg_hi:[1,0]
  v_exp_f16_sdwa v34, v35 dst_sel:WORD_0 dst_unused:UNUSED_PAD src0_sel:WORD_0
  v_mfma_f32_16x16x32_bf16 v[100:103], v[60:63], v[136:139], v[100:103]
  v_exp_f16_sdwa v34, v35 dst_sel:WORD_1 dst_unused:UNUSED_PRESERVE src0_sel:WORD_1
  buffer_load_dwordx4 v20, s[8:11], s94 offen offset:2048 lds
  v_mfma_f32_16x16x32_bf16 v[92:95], v[64:67], v[140:143], v[92:95]
  ds_read_b128 v[60:63], v17 offset:12288
  v_pk_fma_f16 v34, v34, s93, s93
  v_rcp_f16_sdwa v35, v34 dst_sel:WORD_0 dst_unused:UNUSED_PAD src0_sel:WORD_0
  v_mfma_f32_16x16x32_bf16 v[96:99], v[64:67], v[144:147], v[96:99]
  v_rcp_f16_sdwa v35, v34 dst_sel:WORD_1 dst_unused:UNUSED_PRESERVE src0_sel:WORD_1
  v_mfma_f32_16x16x32_bf16 v[100:103], v[64:67], v[148:151], v[100:103]
  v_fma_mix_f32 v34, v86, v35, 0 op_sel_hi:[0,1,0]
  v_fma_mix_f32 v35, v87, v35, 0 op_sel:[0,1,0] op_sel_hi:[0,1,0]
  v_cvt_pk_bf16_f32 v39, v34, v35
  ds_write_b64 v19, v[38:39] offset:1024
  s_setprio 2
  s_waitcnt lgkmcnt(3)
  v_mfma_f32_16x16x32_bf16 v[92:95], v[52:55], v[152:155], v[92:95]
  ds_read_b128 v[64:67], v17 offset:13312
  v_cvt_pk_f16_f32 v32, v88, v89
  v_pk_fma_f16 v33, v32, v32, s92
  v_mfma_f32_16x16x32_bf16 v[96:99], v[52:55], v[156:159], v[96:99]
  v_pk_mul_f16 v33, v33, v32 neg_lo:[1,0] neg_hi:[1,0]
  v_exp_f16_sdwa v32, v33 dst_sel:WORD_0 dst_unused:UNUSED_PAD src0_sel:WORD_0
  v_mfma_f32_16x16x32_bf16 v[100:103], v[52:55], v[160:163], v[100:103]
  v_exp_f16_sdwa v32, v33 dst_sel:WORD_1 dst_unused:UNUSED_PRESERVE src0_sel:WORD_1
  buffer_load_dwordx4 v[40:43], v21, s[16:19], s55 offen offset:0 nt
  v_mfma_f32_16x16x32_bf16 v[92:95], v[56:59], v[164:167], v[92:95]
  ds_read_b128 v[52:55], v17 offset:14336
  v_pk_fma_f16 v32, v32, s93, s93
  v_rcp_f16_sdwa v33, v32 dst_sel:WORD_0 dst_unused:UNUSED_PAD src0_sel:WORD_0
  v_mfma_f32_16x16x32_bf16 v[96:99], v[56:59], v[168:171], v[96:99]
  v_rcp_f16_sdwa v33, v32 dst_sel:WORD_1 dst_unused:UNUSED_PRESERVE src0_sel:WORD_1
  v_mfma_f32_16x16x32_bf16 v[100:103], v[56:59], v[172:175], v[100:103]
  v_fma_mix_f32 v32, v88, v33, 0 op_sel_hi:[0,1,0]
  v_fma_mix_f32 v33, v89, v33, 0 op_sel:[0,1,0] op_sel_hi:[0,1,0]
  v_cvt_pk_bf16_f32 v36, v32, v33
  s_waitcnt lgkmcnt(1)
  v_mfma_f32_16x16x32_bf16 v[176:179], v[60:63], v[68:71], v[176:179]
  ds_read_b128 v[56:59], v17 offset:15360
  v_cvt_pk_f16_f32 v34, v90, v91
  v_pk_fma_f16 v35, v34, v34, s92
  v_mfma_f32_16x16x32_bf16 v[184:187], v[60:63], v[72:75], v[184:187]
  v_pk_mul_f16 v35, v35, v34 neg_lo:[1,0] neg_hi:[1,0]
  v_exp_f16_sdwa v34, v35 dst_sel:WORD_0 dst_unused:UNUSED_PAD src0_sel:WORD_0
  v_mfma_f32_16x16x32_bf16 v[192:195], v[60:63], v[76:79], v[192:195]
  v_exp_f16_sdwa v34, v35 dst_sel:WORD_1 dst_unused:UNUSED_PRESERVE src0_sel:WORD_1
  s_setprio 1
  v_mfma_f32_16x16x32_bf16 v[180:183], v[64:67], v[68:71], v[180:183]
  ds_read_b128 v[60:63], v17 offset:16384
  v_pk_fma_f16 v34, v34, s93, s93
  v_rcp_f16_sdwa v35, v34 dst_sel:WORD_0 dst_unused:UNUSED_PAD src0_sel:WORD_0
  v_mfma_f32_16x16x32_bf16 v[188:191], v[64:67], v[72:75], v[188:191]
  v_rcp_f16_sdwa v35, v34 dst_sel:WORD_1 dst_unused:UNUSED_PRESERVE src0_sel:WORD_1
  v_mfma_f32_16x16x32_bf16 v[196:199], v[64:67], v[76:79], v[196:199]
  v_fma_mix_f32 v34, v90, v35, 0 op_sel_hi:[0,1,0]
  v_fma_mix_f32 v35, v91, v35, 0 op_sel:[0,1,0] op_sel_hi:[0,1,0]
  v_cvt_pk_bf16_f32 v37, v34, v35
  ds_write_b64 v19, v[36:37] offset:2048
  s_setprio 0
  s_waitcnt lgkmcnt(2)
  v_mfma_f32_16x16x32_bf16 v[200:203], v[52:55], v[68:71], v[200:203]
  ds_read_b128 v[64:67], v17 offset:17408
  v_cvt_pk_f16_f32 v32, v92, v93
  v_pk_fma_f16 v33, v32, v32, s92
  v_mfma_f32_16x16x32_bf16 v[208:211], v[52:55], v[72:75], v[208:211]
  v_pk_mul_f16 v33, v33, v32 neg_lo:[1,0] neg_hi:[1,0]
  v_exp_f16_sdwa v32, v33 dst_sel:WORD_0 dst_unused:UNUSED_PAD src0_sel:WORD_0
  v_mfma_f32_16x16x32_bf16 v[216:219], v[52:55], v[76:79], v[216:219]
  v_exp_f16_sdwa v32, v33 dst_sel:WORD_1 dst_unused:UNUSED_PRESERVE src0_sel:WORD_1
  v_mfma_f32_16x16x32_bf16 v[204:207], v[56:59], v[68:71], v[204:207]
  s_waitcnt vmcnt(4)
  s_waitcnt lgkmcnt(0)
  s_barrier
  s_setprio 3
  ds_read_b128 v[52:55], v16 offset:0
  v_pk_fma_f16 v32, v32, s93, s93
  v_rcp_f16_sdwa v33, v32 dst_sel:WORD_0 dst_unused:UNUSED_PAD src0_sel:WORD_0
  v_mfma_f32_16x16x32_bf16 v[212:215], v[56:59], v[72:75], v[212:215]
  v_rcp_f16_sdwa v33, v32 dst_sel:WORD_1 dst_unused:UNUSED_PRESERVE src0_sel:WORD_1
  v_mfma_f32_16x16x32_bf16 v[220:223], v[56:59], v[76:79], v[220:223]
  v_fma_mix_f32 v32, v92, v33, 0 op_sel_hi:[0,1,0]
  v_fma_mix_f32 v33, v93, v33, 0 op_sel:[0,1,0] op_sel_hi:[0,1,0]
  v_cvt_pk_bf16_f32 v36, v32, v33
  v_mfma_f32_16x16x32_bf16 v[224:227], v[60:63], v[68:71], v[224:227]
  ds_read_b128 v[56:59], v16 offset:1024
  v_cvt_pk_f16_f32 v34, v94, v95
  v_pk_fma_f16 v35, v34, v34, s92
  v_mfma_f32_16x16x32_bf16 v[232:235], v[60:63], v[72:75], v[232:235]
  v_pk_mul_f16 v35, v35, v34 neg_lo:[1,0] neg_hi:[1,0]
  v_exp_f16_sdwa v34, v35 dst_sel:WORD_0 dst_unused:UNUSED_PAD src0_sel:WORD_0
  v_mfma_f32_16x16x32_bf16 v[240:243], v[60:63], v[76:79], v[240:243]
  v_exp_f16_sdwa v34, v35 dst_sel:WORD_1 dst_unused:UNUSED_PRESERVE src0_sel:WORD_1
  s_add_u32 m0, s57, 49152
  s_mov_b32 s94, 122880
  buffer_load_dwordx4 v20, s[8:11], s94 offen offset:0 lds
  v_mfma_f32_16x16x32_bf16 v[228:231], v[64:67], v[68:71], v[228:231]
  ds_read_b128 v[60:63], v16 offset:2048
  v_pk_fma_f16 v34, v34, s93, s93
  v_rcp_f16_sdwa v35, v34 dst_sel:WORD_0 dst_unused:UNUSED_PAD src0_sel:WORD_0
  v_mfma_f32_16x16x32_bf16 v[236:239], v[64:67], v[72:75], v[236:239]
  v_rcp_f16_sdwa v35, v34 dst_sel:WORD_1 dst_unused:UNUSED_PRESERVE src0_sel:WORD_1
  v_mfma_f32_16x16x32_bf16 v[244:247], v[64:67], v[76:79], v[244:247]
  v_fma_mix_f32 v34, v94, v35, 0 op_sel_hi:[0,1,0]
  v_fma_mix_f32 v35, v95, v35, 0 op_sel:[0,1,0] op_sel_hi:[0,1,0]
  v_cvt_pk_bf16_f32 v37, v34, v35
  ds_write_b64 v19, v[36:37] offset:12288
  s_waitcnt lgkmcnt(2)
  v_mfma_f32_16x16x32_bf16 v[80:83], v[52:55], v[104:107], 0
  ds_read_b128 v[64:67], v16 offset:3072
  ds_read_b128 v[68:71], v18 offset:0
  v_cvt_pk_f16_f32 v32, v96, v97
  v_pk_fma_f16 v33, v32, v32, s92
  v_mfma_f32_16x16x32_bf16 v[84:87], v[52:55], v[108:111], 0
  v_pk_mul_f16 v33, v33, v32 neg_lo:[1,0] neg_hi:[1,0]
  v_exp_f16_sdwa v32, v33 dst_sel:WORD_0 dst_unused:UNUSED_PAD src0_sel:WORD_0
  v_mfma_f32_16x16x32_bf16 v[88:91], v[52:55], v[112:115], 0
  v_exp_f16_sdwa v32, v33 dst_sel:WORD_1 dst_unused:UNUSED_PRESERVE src0_sel:WORD_1
  buffer_load_dwordx4 v20, s[8:11], s94 offen offset:1024 lds
  v_mfma_f32_16x16x32_bf16 v[80:83], v[56:59], v[116:119], v[80:83]
  ds_read_b128 v[52:55], v16 offset:4096
  ds_read_b128 v[72:75], v18 offset:1024
  v_pk_fma_f16 v32, v32, s93, s93
  v_rcp_f16_sdwa v33, v32 dst_sel:WORD_0 dst_unused:UNUSED_PAD src0_sel:WORD_0
  v_mfma_f32_16x16x32_bf16 v[84:87], v[56:59], v[120:123], v[84:87]
  v_rcp_f16_sdwa v33, v32 dst_sel:WORD_1 dst_unused:UNUSED_PRESERVE src0_sel:WORD_1
  v_mfma_f32_16x16x32_bf16 v[88:91], v[56:59], v[124:127], v[88:91]
  v_fma_mix_f32 v32, v96, v33, 0 op_sel_hi:[0,1,0]
  v_fma_mix_f32 v33, v97, v33, 0 op_sel:[0,1,0] op_sel_hi:[0,1,0]
  v_cvt_pk_bf16_f32 v38, v32, v33
  s_waitcnt lgkmcnt(3)
  v_mfma_f32_16x16x32_bf16 v[80:83], v[60:63], v[128:131], v[80:83]
  ds_read_b128 v[56:59], v16 offset:5120
  ds_read_b128 v[76:79], v18 offset:2048
  v_cvt_pk_f16_f32 v34, v98, v99
  v_pk_fma_f16 v35, v34, v34, s92
  v_mfma_f32_16x16x32_bf16 v[84:87], v[60:63], v[132:135], v[84:87]
  v_pk_mul_f16 v35, v35, v34 neg_lo:[1,0] neg_hi:[1,0]
  v_exp_f16_sdwa v34, v35 dst_sel:WORD_0 dst_unused:UNUSED_PAD src0_sel:WORD_0
  v_mfma_f32_16x16x32_bf16 v[88:91], v[60:63], v[136:139], v[88:91]
  v_exp_f16_sdwa v34, v35 dst_sel:WORD_1 dst_unused:UNUSED_PRESERVE src0_sel:WORD_1
  buffer_load_dwordx4 v20, s[8:11], s94 offen offset:2048 lds
  v_mfma_f32_16x16x32_bf16 v[80:83], v[64:67], v[140:143], v[80:83]
  ds_read_b128 v[60:63], v16 offset:12288
  v_pk_fma_f16 v34, v34, s93, s93
  v_rcp_f16_sdwa v35, v34 dst_sel:WORD_0 dst_unused:UNUSED_PAD src0_sel:WORD_0
  v_mfma_f32_16x16x32_bf16 v[84:87], v[64:67], v[144:147], v[84:87]
  v_rcp_f16_sdwa v35, v34 dst_sel:WORD_1 dst_unused:UNUSED_PRESERVE src0_sel:WORD_1
  v_mfma_f32_16x16x32_bf16 v[88:91], v[64:67], v[148:151], v[88:91]
  v_fma_mix_f32 v34, v98, v35, 0 op_sel_hi:[0,1,0]
  v_fma_mix_f32 v35, v99, v35, 0 op_sel:[0,1,0] op_sel_hi:[0,1,0]
  v_cvt_pk_bf16_f32 v39, v34, v35
  ds_write_b64 v19, v[38:39] offset:13312
  s_sub_u32 s31, s32, 3
  s_mul_i32 s31, s31, 384
  s_add_u32 s31, s31, s45
  s_sub_u32 s31, s31, 3
  s_mul_i32 s31, s31, 384
  s_add_u32 m0, s58, 98304
  v_add_u32 v30, s31, v2
  buffer_load_dwordx4 v30, s[4:7], 0 offen lds
  s_setprio 2
  s_waitcnt lgkmcnt(3)
  v_mfma_f32_16x16x32_bf16 v[80:83], v[52:55], v[152:155], v[80:83]
  ds_read_b128 v[64:67], v16 offset:13312
  v_cvt_pk_f16_f32 v32, v100, v101
  v_pk_fma_f16 v33, v32, v32, s92
  v_mfma_f32_16x16x32_bf16 v[84:87], v[52:55], v[156:159], v[84:87]
  v_pk_mul_f16 v33, v33, v32 neg_lo:[1,0] neg_hi:[1,0]
  v_exp_f16_sdwa v32, v33 dst_sel:WORD_0 dst_unused:UNUSED_PAD src0_sel:WORD_0
  v_mfma_f32_16x16x32_bf16 v[88:91], v[52:55], v[160:163], v[88:91]
  v_exp_f16_sdwa v32, v33 dst_sel:WORD_1 dst_unused:UNUSED_PRESERVE src0_sel:WORD_1
  buffer_load_dwordx4 v[44:47], v22, s[16:19], s55 offen offset:0 nt
  v_mfma_f32_16x16x32_bf16 v[80:83], v[56:59], v[164:167], v[80:83]
  ds_read_b128 v[52:55], v16 offset:14336
  v_pk_fma_f16 v32, v32, s93, s93
  v_rcp_f16_sdwa v33, v32 dst_sel:WORD_0 dst_unused:UNUSED_PAD src0_sel:WORD_0
  v_mfma_f32_16x16x32_bf16 v[84:87], v[56:59], v[168:171], v[84:87]
  v_rcp_f16_sdwa v33, v32 dst_sel:WORD_1 dst_unused:UNUSED_PRESERVE src0_sel:WORD_1
  v_mfma_f32_16x16x32_bf16 v[88:91], v[56:59], v[172:175], v[88:91]
  v_fma_mix_f32 v32, v100, v33, 0 op_sel_hi:[0,1,0]
  v_fma_mix_f32 v33, v101, v33, 0 op_sel:[0,1,0] op_sel_hi:[0,1,0]
  v_cvt_pk_bf16_f32 v36, v32, v33
  s_waitcnt lgkmcnt(1)
  v_mfma_f32_16x16x32_bf16 v[176:179], v[60:63], v[68:71], v[176:179]
  ds_read_b128 v[56:59], v16 offset:15360
  v_cvt_pk_f16_f32 v34, v102, v103
  v_pk_fma_f16 v35, v34, v34, s92
  v_mfma_f32_16x16x32_bf16 v[184:187], v[60:63], v[72:75], v[184:187]
  v_pk_mul_f16 v35, v35, v34 neg_lo:[1,0] neg_hi:[1,0]
  v_exp_f16_sdwa v34, v35 dst_sel:WORD_0 dst_unused:UNUSED_PAD src0_sel:WORD_0
  v_mfma_f32_16x16x32_bf16 v[192:195], v[60:63], v[76:79], v[192:195]
  v_exp_f16_sdwa v34, v35 dst_sel:WORD_1 dst_unused:UNUSED_PRESERVE src0_sel:WORD_1
  s_setprio 1
  v_mfma_f32_16x16x32_bf16 v[180:183], v[64:67], v[68:71], v[180:183]
  ds_read_b128 v[60:63], v16 offset:16384
  v_pk_fma_f16 v34, v34, s93, s93
  v_rcp_f16_sdwa v35, v34 dst_sel:WORD_0 dst_unused:UNUSED_PAD src0_sel:WORD_0
  v_mfma_f32_16x16x32_bf16 v[188:191], v[64:67], v[72:75], v[188:191]
  v_rcp_f16_sdwa v35, v34 dst_sel:WORD_1 dst_unused:UNUSED_PRESERVE src0_sel:WORD_1
  v_mfma_f32_16x16x32_bf16 v[196:199], v[64:67], v[76:79], v[196:199]
  v_fma_mix_f32 v34, v102, v35, 0 op_sel_hi:[0,1,0]
  v_fma_mix_f32 v35, v103, v35, 0 op_sel:[0,1,0] op_sel_hi:[0,1,0]
  v_cvt_pk_bf16_f32 v37, v34, v35
  ds_write_b64 v19, v[36:37] offset:14336
  s_setprio 0
  s_waitcnt lgkmcnt(2)
  v_mfma_f32_16x16x32_bf16 v[200:203], v[52:55], v[68:71], v[200:203]
  ds_read_b128 v[64:67], v16 offset:17408
  v_cvt_pk_f16_f32 v32, v80, v81
  v_pk_fma_f16 v33, v32, v32, s92
  v_mfma_f32_16x16x32_bf16 v[208:211], v[52:55], v[72:75], v[208:211]
  v_pk_mul_f16 v33, v33, v32 neg_lo:[1,0] neg_hi:[1,0]
  v_exp_f16_sdwa v32, v33 dst_sel:WORD_0 dst_unused:UNUSED_PAD src0_sel:WORD_0
  v_mfma_f32_16x16x32_bf16 v[216:219], v[52:55], v[76:79], v[216:219]
  v_exp_f16_sdwa v32, v33 dst_sel:WORD_1 dst_unused:UNUSED_PRESERVE src0_sel:WORD_1
  v_mfma_f32_16x16x32_bf16 v[204:207], v[56:59], v[68:71], v[204:207]
  s_waitcnt vmcnt(6)
  s_waitcnt lgkmcnt(0)
  s_barrier
  s_setprio 3
  ds_read_b128 v[52:55], v16 offset:24576
  v_pk_fma_f16 v32, v32, s93, s93
  v_rcp_f16_sdwa v33, v32 dst_sel:WORD_0 dst_unused:UNUSED_PAD src0_sel:WORD_0
  v_mfma_f32_16x16x32_bf16 v[212:215], v[56:59], v[72:75], v[212:215]
  v_rcp_f16_sdwa v33, v32 dst_sel:WORD_1 dst_unused:UNUSED_PRESERVE src0_sel:WORD_1
  v_mfma_f32_16x16x32_bf16 v[220:223], v[56:59], v[76:79], v[220:223]
  v_fma_mix_f32 v32, v80, v33, 0 op_sel_hi:[0,1,0]
  v_fma_mix_f32 v33, v81, v33, 0 op_sel:[0,1,0] op_sel_hi:[0,1,0]
  v_cvt_pk_bf16_f32 v36, v32, v33
  v_mfma_f32_16x16x32_bf16 v[224:227], v[60:63], v[68:71], v[224:227]
  ds_read_b128 v[56:59], v16 offset:25600
  v_cvt_pk_f16_f32 v34, v82, v83
  v_pk_fma_f16 v35, v34, v34, s92
  v_mfma_f32_16x16x32_bf16 v[232:235], v[60:63], v[72:75], v[232:235]
  v_pk_mul_f16 v35, v35, v34 neg_lo:[1,0] neg_hi:[1,0]
  v_exp_f16_sdwa v34, v35 dst_sel:WORD_0 dst_unused:UNUSED_PAD src0_sel:WORD_0
  v_mfma_f32_16x16x32_bf16 v[240:243], v[60:63], v[76:79], v[240:243]
  v_exp_f16_sdwa v34, v35 dst_sel:WORD_1 dst_unused:UNUSED_PRESERVE src0_sel:WORD_1
  s_add_u32 m0, s57, 0
  s_mov_b32 s94, 147456
  buffer_load_dwordx4 v20, s[8:11], s94 offen offset:0 lds
  v_mfma_f32_16x16x32_bf16 v[228:231], v[64:67], v[68:71], v[228:231]
  ds_read_b128 v[60:63], v16 offset:26624
  v_pk_fma_f16 v34, v34, s93, s93
  v_rcp_f16_sdwa v35, v34 dst_sel:WORD_0 dst_unused:UNUSED_PAD src0_sel:WORD_0
  v_mfma_f32_16x16x32_bf16 v[236:239], v[64:67], v[72:75], v[236:239]
  v_rcp_f16_sdwa v35, v34 dst_sel:WORD_1 dst_unused:UNUSED_PRESERVE src0_sel:WORD_1
  v_mfma_f32_16x16x32_bf16 v[244:247], v[64:67], v[76:79], v[244:247]
  v_fma_mix_f32 v34, v82, v35, 0 op_sel_hi:[0,1,0]
  v_fma_mix_f32 v35, v83, v35, 0 op_sel:[0,1,0] op_sel_hi:[0,1,0]
  v_cvt_pk_bf16_f32 v37, v34, v35
  ds_write_b64 v19, v[36:37] offset:0
  s_waitcnt lgkmcnt(2)
  v_mfma_f32_16x16x32_bf16 v[92:95], v[52:55], v[104:107], 0
  ds_read_b128 v[64:67], v16 offset:27648
  ds_read_b128 v[68:71], v18 offset:12288
  v_cvt_pk_f16_f32 v32, v84, v85
  v_pk_fma_f16 v33, v32, v32, s92
  v_mfma_f32_16x16x32_bf16 v[96:99], v[52:55], v[108:111], 0
  v_pk_mul_f16 v33, v33, v32 neg_lo:[1,0] neg_hi:[1,0]
  v_exp_f16_sdwa v32, v33 dst_sel:WORD_0 dst_unused:UNUSED_PAD src0_sel:WORD_0
  v_mfma_f32_16x16x32_bf16 v[100:103], v[52:55], v[112:115], 0
  v_exp_f16_sdwa v32, v33 dst_sel:WORD_1 dst_unused:UNUSED_PRESERVE src0_sel:WORD_1
  buffer_load_dwordx4 v20, s[8:11], s94 offen offset:1024 lds
  v_mfma_f32_16x16x32_bf16 v[92:95], v[56:59], v[116:119], v[92:95]
  ds_read_b128 v[52:55], v16 offset:28672
  ds_read_b128 v[72:75], v18 offset:13312
  v_pk_fma_f16 v32, v32, s93, s93
  v_rcp_f16_sdwa v33, v32 dst_sel:WORD_0 dst_unused:UNUSED_PAD src0_sel:WORD_0
  v_mfma_f32_16x16x32_bf16 v[96:99], v[56:59], v[120:123], v[96:99]
  v_rcp_f16_sdwa v33, v32 dst_sel:WORD_1 dst_unused:UNUSED_PRESERVE src0_sel:WORD_1
  v_mfma_f32_16x16x32_bf16 v[100:103], v[56:59], v[124:127], v[100:103]
  v_fma_mix_f32 v32, v84, v33, 0 op_sel_hi:[0,1,0]
  v_fma_mix_f32 v33, v85, v33, 0 op_sel:[0,1,0] op_sel_hi:[0,1,0]
  v_cvt_pk_bf16_f32 v38, v32, v33
  s_waitcnt lgkmcnt(3)
  v_mfma_f32_16x16x32_bf16 v[92:95], v[60:63], v[128:131], v[92:95]
  ds_read_b128 v[56:59], v16 offset:29696
  ds_read_b128 v[76:79], v18 offset:14336
  v_cvt_pk_f16_f32 v34, v86, v87
  v_pk_fma_f16 v35, v34, v34, s92
  v_mfma_f32_16x16x32_bf16 v[96:99], v[60:63], v[132:135], v[96:99]
  v_pk_mul_f16 v35, v35, v34 neg_lo:[1,0] neg_hi:[1,0]
  v_exp_f16_sdwa v34, v35 dst_sel:WORD_0 dst_unused:UNUSED_PAD src0_sel:WORD_0
  v_mfma_f32_16x16x32_bf16 v[100:103], v[60:63], v[136:139], v[100:103]
  v_exp_f16_sdwa v34, v35 dst_sel:WORD_1 dst_unused:UNUSED_PRESERVE src0_sel:WORD_1
  buffer_load_dwordx4 v20, s[8:11], s94 offen offset:2048 lds
  v_mfma_f32_16x16x32_bf16 v[92:95], v[64:67], v[140:143], v[92:95]
  ds_read_b128 v[60:63], v16 offset:36864
  v_pk_fma_f16 v34, v34, s93, s93
  v_rcp_f16_sdwa v35, v34 dst_sel:WORD_0 dst_unused:UNUSED_PAD src0_sel:WORD_0
  v_mfma_f32_16x16x32_bf16 v[96:99], v[64:67], v[144:147], v[96:99]
  v_rcp_f16_sdwa v35, v34 dst_sel:WORD_1 dst_unused:UNUSED_PRESERVE src0_sel:WORD_1
  v_mfma_f32_16x16x32_bf16 v[100:103], v[64:67], v[148:151], v[100:103]
  v_fma_mix_f32 v34, v86, v35, 0 op_sel_hi:[0,1,0]
  v_fma_mix_f32 v35, v87, v35, 0 op_sel:[0,1,0] op_sel_hi:[0,1,0]
  v_cvt_pk_bf16_f32 v39, v34, v35
  ds_write_b64 v19, v[38:39] offset:1024
  s_add_u32 m0, s58, 99328
  v_add_u32 v31, s31, v3
  buffer_load_dwordx4 v31, s[4:7], 0 offen lds
  s_setprio 2
  s_waitcnt lgkmcnt(3)
  v_mfma_f32_16x16x32_bf16 v[92:95], v[52:55], v[152:155], v[92:95]
  ds_read_b128 v[64:67], v16 offset:37888
  v_cvt_pk_f16_f32 v32, v88, v89
  v_pk_fma_f16 v33, v32, v32, s92
  v_mfma_f32_16x16x32_bf16 v[96:99], v[52:55], v[156:159], v[96:99]
  v_pk_mul_f16 v33, v33, v32 neg_lo:[1,0] neg_hi:[1,0]
  v_exp_f16_sdwa v32, v33 dst_sel:WORD_0 dst_unused:UNUSED_PAD src0_sel:WORD_0
  v_mfma_f32_16x16x32_bf16 v[100:103], v[52:55], v[160:163], v[100:103]
  v_exp_f16_sdwa v32, v33 dst_sel:WORD_1 dst_unused:UNUSED_PRESERVE src0_sel:WORD_1
  buffer_load_dwordx4 v[48:51], v23, s[16:19], s55 offen offset:0 nt
  v_mfma_f32_16x16x32_bf16 v[92:95], v[56:59], v[164:167], v[92:95]
  ds_read_b128 v[52:55], v16 offset:38912
  v_pk_fma_f16 v32, v32, s93, s93
  v_rcp_f16_sdwa v33, v32 dst_sel:WORD_0 dst_unused:UNUSED_PAD src0_sel:WORD_0
  v_mfma_f32_16x16x32_bf16 v[96:99], v[56:59], v[168:171], v[96:99]
  v_rcp_f16_sdwa v33, v32 dst_sel:WORD_1 dst_unused:UNUSED_PRESERVE src0_sel:WORD_1
  v_mfma_f32_16x16x32_bf16 v[100:103], v[56:59], v[172:175], v[100:103]
  v_fma_mix_f32 v32, v88, v33, 0 op_sel_hi:[0,1,0]
  v_fma_mix_f32 v33, v89, v33, 0 op_sel:[0,1,0] op_sel_hi:[0,1,0]
  v_cvt_pk_bf16_f32 v36, v32, v33
  s_waitcnt lgkmcnt(1)
  v_mfma_f32_16x16x32_bf16 v[176:179], v[60:63], v[68:71], v[176:179]
  ds_read_b128 v[56:59], v16 offset:39936
  v_cvt_pk_f16_f32 v34, v90, v91
  v_pk_fma_f16 v35, v34, v34, s92
  v_mfma_f32_16x16x32_bf16 v[184:187], v[60:63], v[72:75], v[184:187]
  v_pk_mul_f16 v35, v35, v34 neg_lo:[1,0] neg_hi:[1,0]
  v_exp_f16_sdwa v34, v35 dst_sel:WORD_0 dst_unused:UNUSED_PAD src0_sel:WORD_0
  v_mfma_f32_16x16x32_bf16 v[192:195], v[60:63], v[76:79], v[192:195]
  v_exp_f16_sdwa v34, v35 dst_sel:WORD_1 dst_unused:UNUSED_PRESERVE src0_sel:WORD_1
  s_setprio 1
  v_mfma_f32_16x16x32_bf16 v[180:183], v[64:67], v[68:71], v[180:183]
  ds_read_b128 v[60:63], v16 offset:40960
  v_pk_fma_f16 v34, v34, s93, s93
  v_rcp_f16_sdwa v35, v34 dst_sel:WORD_0 dst_unused:UNUSED_PAD src0_sel:WORD_0
  v_mfma_f32_16x16x32_bf16 v[188:191], v[64:67], v[72:75], v[188:191]
  v_rcp_f16_sdwa v35, v34 dst_sel:WORD_1 dst_unused:UNUSED_PRESERVE src0_sel:WORD_1
  v_mfma_f32_16x16x32_bf16 v[196:199], v[64:67], v[76:79], v[196:199]
  v_fma_mix_f32 v34, v90, v35, 0 op_sel_hi:[0,1,0]
  v_fma_mix_f32 v35, v91, v35, 0 op_sel:[0,1,0] op_sel_hi:[0,1,0]
  v_cvt_pk_bf16_f32 v37, v34, v35
  ds_write_b64 v19, v[36:37] offset:2048
  s_setprio 0
  s_waitcnt lgkmcnt(2)
  v_mfma_f32_16x16x32_bf16 v[200:203], v[52:55], v[68:71], v[200:203]
  ds_read_b128 v[64:67], v16 offset:41984
  v_cvt_pk_f16_f32 v32, v92, v93
  v_pk_fma_f16 v33, v32, v32, s92
  v_mfma_f32_16x16x32_bf16 v[208:211], v[52:55], v[72:75], v[208:211]
  v_pk_mul_f16 v33, v33, v32 neg_lo:[1,0] neg_hi:[1,0]
  v_exp_f16_sdwa v32, v33 dst_sel:WORD_0 dst_unused:UNUSED_PAD src0_sel:WORD_0
  v_mfma_f32_16x16x32_bf16 v[216:219], v[52:55], v[76:79], v[216:219]
  v_exp_f16_sdwa v32, v33 dst_sel:WORD_1 dst_unused:UNUSED_PRESERVE src0_sel:WORD_1
  v_mfma_f32_16x16x32_bf16 v[204:207], v[56:59], v[68:71], v[204:207]
  s_waitcnt vmcnt(7)
  s_waitcnt lgkmcnt(0)
  s_barrier
  s_setprio 3
  ds_read_b128 v[52:55], v17 offset:0
  v_pk_fma_f16 v32, v32, s93, s93
  v_rcp_f16_sdwa v33, v32 dst_sel:WORD_0 dst_unused:UNUSED_PAD src0_sel:WORD_0
  v_mfma_f32_16x16x32_bf16 v[212:215], v[56:59], v[72:75], v[212:215]
  v_rcp_f16_sdwa v33, v32 dst_sel:WORD_1 dst_unused:UNUSED_PRESERVE src0_sel:WORD_1
  v_mfma_f32_16x16x32_bf16 v[220:223], v[56:59], v[76:79], v[220:223]
  v_fma_mix_f32 v32, v92, v33, 0 op_sel_hi:[0,1,0]
  v_fma_mix_f32 v33, v93, v33, 0 op_sel:[0,1,0] op_sel_hi:[0,1,0]
  v_cvt_pk_bf16_f32 v36, v32, v33
  v_mfma_f32_16x16x32_bf16 v[224:227], v[60:63], v[68:71], v[224:227]
  ds_read_b128 v[56:59], v17 offset:1024
  v_cvt_pk_f16_f32 v34, v94, v95
  v_pk_fma_f16 v35, v34, v34, s92
  v_mfma_f32_16x16x32_bf16 v[232:235], v[60:63], v[72:75], v[232:235]
  v_pk_mul_f16 v35, v35, v34 neg_lo:[1,0] neg_hi:[1,0]
  v_exp_f16_sdwa v34, v35 dst_sel:WORD_0 dst_unused:UNUSED_PAD src0_sel:WORD_0
  v_mfma_f32_16x16x32_bf16 v[240:243], v[60:63], v[76:79], v[240:243]
  v_exp_f16_sdwa v34, v35 dst_sel:WORD_1 dst_unused:UNUSED_PRESERVE src0_sel:WORD_1
  s_add_u32 m0, s57, 24576
  s_mov_b32 s94, 172032
  buffer_load_dwordx4 v20, s[8:11], s94 offen offset:0 lds
  v_mfma_f32_16x16x32_bf16 v[228:231], v[64:67], v[68:71], v[228:231]
  ds_read_b128 v[60:63], v17 offset:2048
  v_pk_fma_f16 v34, v34, s93, s93
  v_rcp_f16_sdwa v35, v34 dst_sel:WORD_0 dst_unused:UNUSED_PAD src0_sel:WORD_0
  v_mfma_f32_16x16x32_bf16 v[236:239], v[64:67], v[72:75], v[236:239]
  v_rcp_f16_sdwa v35, v34 dst_sel:WORD_1 dst_unused:UNUSED_PRESERVE src0_sel:WORD_1
  v_mfma_f32_16x16x32_bf16 v[244:247], v[64:67], v[76:79], v[244:247]
  v_fma_mix_f32 v34, v94, v35, 0 op_sel_hi:[0,1,0]
  v_fma_mix_f32 v35, v95, v35, 0 op_sel:[0,1,0] op_sel_hi:[0,1,0]
  v_cvt_pk_bf16_f32 v37, v34, v35
  ds_write_b64 v19, v[36:37] offset:12288
  s_waitcnt lgkmcnt(2)
  v_mfma_f32_16x16x32_bf16 v[80:83], v[52:55], v[104:107], 0
  ds_read_b128 v[64:67], v17 offset:3072
  ds_read_b128 v[68:71], v18 offset:0
  v_cvt_pk_f16_f32 v32, v96, v97
  v_pk_fma_f16 v33, v32, v32, s92
  v_mfma_f32_16x16x32_bf16 v[84:87], v[52:55], v[108:111], 0
  v_pk_mul_f16 v33, v33, v32 neg_lo:[1,0] neg_hi:[1,0]
  v_exp_f16_sdwa v32, v33 dst_sel:WORD_0 dst_unused:UNUSED_PAD src0_sel:WORD_0
  v_mfma_f32_16x16x32_bf16 v[88:91], v[52:55], v[112:115], 0
  v_exp_f16_sdwa v32, v33 dst_sel:WORD_1 dst_unused:UNUSED_PRESERVE src0_sel:WORD_1
  buffer_load_dwordx4 v20, s[8:11], s94 offen offset:1024 lds
  v_mfma_f32_16x16x32_bf16 v[80:83], v[56:59], v[116:119], v[80:83]
  ds_read_b128 v[52:55], v17 offset:4096
  ds_read_b128 v[72:75], v18 offset:1024
  v_pk_fma_f16 v32, v32, s93, s93
  v_rcp_f16_sdwa v33, v32 dst_sel:WORD_0 dst_unused:UNUSED_PAD src0_sel:WORD_0
  v_mfma_f32_16x16x32_bf16 v[84:87], v[56:59], v[120:123], v[84:87]
  v_rcp_f16_sdwa v33, v32 dst_sel:WORD_1 dst_unused:UNUSED_PRESERVE src0_sel:WORD_1
  v_mfma_f32_16x16x32_bf16 v[88:91], v[56:59], v[124:127], v[88:91]
  v_fma_mix_f32 v32, v96, v33, 0 op_sel_hi:[0,1,0]
  v_fma_mix_f32 v33, v97, v33, 0 op_sel:[0,1,0] op_sel_hi:[0,1,0]
  v_cvt_pk_bf16_f32 v38, v32, v33
  s_waitcnt lgkmcnt(3)
  v_mfma_f32_16x16x32_bf16 v[80:83], v[60:63], v[128:131], v[80:83]
  ds_read_b128 v[56:59], v17 offset:5120
  ds_read_b128 v[76:79], v18 offset:2048
  v_cvt_pk_f16_f32 v34, v98, v99
  v_pk_fma_f16 v35, v34, v34, s92
  v_mfma_f32_16x16x32_bf16 v[84:87], v[60:63], v[132:135], v[84:87]
  v_pk_mul_f16 v35, v35, v34 neg_lo:[1,0] neg_hi:[1,0]
  v_exp_f16_sdwa v34, v35 dst_sel:WORD_0 dst_unused:UNUSED_PAD src0_sel:WORD_0
  v_mfma_f32_16x16x32_bf16 v[88:91], v[60:63], v[136:139], v[88:91]
  v_exp_f16_sdwa v34, v35 dst_sel:WORD_1 dst_unused:UNUSED_PRESERVE src0_sel:WORD_1
  buffer_load_dwordx4 v20, s[8:11], s94 offen offset:2048 lds
  v_mfma_f32_16x16x32_bf16 v[80:83], v[64:67], v[140:143], v[80:83]
  ds_read_b128 v[60:63], v17 offset:12288
  v_pk_fma_f16 v34, v34, s93, s93
  v_rcp_f16_sdwa v35, v34 dst_sel:WORD_0 dst_unused:UNUSED_PAD src0_sel:WORD_0
  v_mfma_f32_16x16x32_bf16 v[84:87], v[64:67], v[144:147], v[84:87]
  v_rcp_f16_sdwa v35, v34 dst_sel:WORD_1 dst_unused:UNUSED_PRESERVE src0_sel:WORD_1
  v_mfma_f32_16x16x32_bf16 v[88:91], v[64:67], v[148:151], v[88:91]
  v_fma_mix_f32 v34, v98, v35, 0 op_sel_hi:[0,1,0]
  v_fma_mix_f32 v35, v99, v35, 0 op_sel:[0,1,0] op_sel_hi:[0,1,0]
  v_cvt_pk_bf16_f32 v39, v34, v35
  ds_write_b64 v19, v[38:39] offset:13312
  s_add_u32 m0, s58, 100352
  v_add_u32 v30, s31, v4
  buffer_load_dwordx4 v30, s[4:7], 0 offen lds
  v_mfma_f32_16x16x32_bf16 v[176:179], v[26:29], v[40:43], v[176:179]
  v_mfma_f32_16x16x32_bf16 v[180:183], v[24:27], v[40:43], v[180:183]
  s_setprio 2
  s_waitcnt lgkmcnt(3)
  v_mfma_f32_16x16x32_bf16 v[80:83], v[52:55], v[152:155], v[80:83]
  ds_read_b128 v[64:67], v17 offset:13312
  v_cvt_pk_f16_f32 v32, v100, v101
  v_pk_fma_f16 v33, v32, v32, s92
  v_mfma_f32_16x16x32_bf16 v[84:87], v[52:55], v[156:159], v[84:87]
  v_pk_mul_f16 v33, v33, v32 neg_lo:[1,0] neg_hi:[1,0]
  v_exp_f16_sdwa v32, v33 dst_sel:WORD_0 dst_unused:UNUSED_PAD src0_sel:WORD_0
  v_mfma_f32_16x16x32_bf16 v[88:91], v[52:55], v[160:163], v[88:91]
  v_exp_f16_sdwa v32, v33 dst_sel:WORD_1 dst_unused:UNUSED_PRESERVE src0_sel:WORD_1
  buffer_load_dwordx4 v[40:43], v21, s[16:19], s55 offen offset:64 nt
  v_mfma_f32_16x16x32_bf16 v[80:83], v[56:59], v[164:167], v[80:83]
  ds_read_b128 v[52:55], v17 offset:14336
  v_pk_fma_f16 v32, v32, s93, s93
  v_rcp_f16_sdwa v33, v32 dst_sel:WORD_0 dst_unused:UNUSED_PAD src0_sel:WORD_0
  v_mfma_f32_16x16x32_bf16 v[84:87], v[56:59], v[168:171], v[84:87]
  v_rcp_f16_sdwa v33, v32 dst_sel:WORD_1 dst_unused:UNUSED_PRESERVE src0_sel:WORD_1
  v_mfma_f32_16x16x32_bf16 v[88:91], v[56:59], v[172:175], v[88:91]
  v_fma_mix_f32 v32, v100, v33, 0 op_sel_hi:[0,1,0]
  v_fma_mix_f32 v33, v101, v33, 0 op_sel:[0,1,0] op_sel_hi:[0,1,0]
  v_cvt_pk_bf16_f32 v36, v32, v33
  s_waitcnt lgkmcnt(1)
  v_mfma_f32_16x16x32_bf16 v[176:179], v[60:63], v[68:71], v[176:179]
  ds_read_b128 v[56:59], v17 offset:15360
  v_cvt_pk_f16_f32 v34, v102, v103
  v_pk_fma_f16 v35, v34, v34, s92
  v_mfma_f32_16x16x32_bf16 v[184:187], v[60:63], v[72:75], v[184:187]
  v_pk_mul_f16 v35, v35, v34 neg_lo:[1,0] neg_hi:[1,0]
  v_exp_f16_sdwa v34, v35 dst_sel:WORD_0 dst_unused:UNUSED_PAD src0_sel:WORD_0
  v_mfma_f32_16x16x32_bf16 v[192:195], v[60:63], v[76:79], v[192:195]
  v_exp_f16_sdwa v34, v35 dst_sel:WORD_1 dst_unused:UNUSED_PRESERVE src0_sel:WORD_1
  s_setprio 1
  v_mfma_f32_16x16x32_bf16 v[180:183], v[64:67], v[68:71], v[180:183]
  ds_read_b128 v[60:63], v17 offset:16384
  v_pk_fma_f16 v34, v34, s93, s93
  v_rcp_f16_sdwa v35, v34 dst_sel:WORD_0 dst_unused:UNUSED_PAD src0_sel:WORD_0
  v_mfma_f32_16x16x32_bf16 v[188:191], v[64:67], v[72:75], v[188:191]
  v_rcp_f16_sdwa v35, v34 dst_sel:WORD_1 dst_unused:UNUSED_PRESERVE src0_sel:WORD_1
  v_mfma_f32_16x16x32_bf16 v[196:199], v[64:67], v[76:79], v[196:199]
  v_fma_mix_f32 v34, v102, v35, 0 op_sel_hi:[0,1,0]
  v_fma_mix_f32 v35, v103, v35, 0 op_sel:[0,1,0] op_sel_hi:[0,1,0]
  v_cvt_pk_bf16_f32 v37, v34, v35
  ds_write_b64 v19, v[36:37] offset:14336
  s_setprio 0
  s_waitcnt lgkmcnt(2)
  v_mfma_f32_16x16x32_bf16 v[200:203], v[52:55], v[68:71], v[200:203]
  ds_read_b128 v[64:67], v17 offset:17408
  v_cvt_pk_f16_f32 v32, v80, v81
  v_pk_fma_f16 v33, v32, v32, s92
  v_mfma_f32_16x16x32_bf16 v[208:211], v[52:55], v[72:75], v[208:211]
  v_pk_mul_f16 v33, v33, v32 neg_lo:[1,0] neg_hi:[1,0]
  v_exp_f16_sdwa v32, v33 dst_sel:WORD_0 dst_unused:UNUSED_PAD src0_sel:WORD_0
  v_mfma_f32_16x16x32_bf16 v[216:219], v[52:55], v[76:79], v[216:219]
  v_exp_f16_sdwa v32, v33 dst_sel:WORD_1 dst_unused:UNUSED_PRESERVE src0_sel:WORD_1
  v_mfma_f32_16x16x32_bf16 v[204:207], v[56:59], v[68:71], v[204:207]
  s_waitcnt vmcnt(7)
  s_waitcnt lgkmcnt(0)
  s_barrier
  s_setprio 3
  ds_read_b128 v[52:55], v16 offset:0
  v_pk_fma_f16 v32, v32, s93, s93
  v_rcp_f16_sdwa v33, v32 dst_sel:WORD_0 dst_unused:UNUSED_PAD src0_sel:WORD_0
  v_mfma_f32_16x16x32_bf16 v[212:215], v[56:59], v[72:75], v[212:215]
  v_rcp_f16_sdwa v33, v32 dst_sel:WORD_1 dst_unused:UNUSED_PRESERVE src0_sel:WORD_1
  v_mfma_f32_16x16x32_bf16 v[220:223], v[56:59], v[76:79], v[220:223]
  v_fma_mix_f32 v32, v80, v33, 0 op_sel_hi:[0,1,0]
  v_fma_mix_f32 v33, v81, v33, 0 op_sel:[0,1,0] op_sel_hi:[0,1,0]
  v_cvt_pk_bf16_f32 v36, v32, v33
  v_mfma_f32_16x16x32_bf16 v[224:227], v[60:63], v[68:71], v[224:227]
  ds_read_b128 v[56:59], v16 offset:1024
  v_cvt_pk_f16_f32 v34, v82, v83
  v_pk_fma_f16 v35, v34, v34, s92
  v_mfma_f32_16x16x32_bf16 v[232:235], v[60:63], v[72:75], v[232:235]
  v_pk_mul_f16 v35, v35, v34 neg_lo:[1,0] neg_hi:[1,0]
  v_exp_f16_sdwa v34, v35 dst_sel:WORD_0 dst_unused:UNUSED_PAD src0_sel:WORD_0
  v_mfma_f32_16x16x32_bf16 v[240:243], v[60:63], v[76:79], v[240:243]
  v_exp_f16_sdwa v34, v35 dst_sel:WORD_1 dst_unused:UNUSED_PRESERVE src0_sel:WORD_1
  s_add_u32 m0, s57, 49152
  s_mov_b32 s94, 196608
  buffer_load_dwordx4 v20, s[8:11], s94 offen offset:0 lds
  v_mfma_f32_16x16x32_bf16 v[228:231], v[64:67], v[68:71], v[228:231]
  ds_read_b128 v[60:63], v16 offset:2048
  v_pk_fma_f16 v34, v34, s93, s93
  v_rcp_f16_sdwa v35, v34 dst_sel:WORD_0 dst_unused:UNUSED_PAD src0_sel:WORD_0
  v_mfma_f32_16x16x32_bf16 v[236:239], v[64:67], v[72:75], v[236:239]
  v_rcp_f16_sdwa v35, v34 dst_sel:WORD_1 dst_unused:UNUSED_PRESERVE src0_sel:WORD_1
  v_mfma_f32_16x16x32_bf16 v[244:247], v[64:67], v[76:79], v[244:247]
  v_fma_mix_f32 v34, v82, v35, 0 op_sel_hi:[0,1,0]
  v_fma_mix_f32 v35, v83, v35, 0 op_sel:[0,1,0] op_sel_hi:[0,1,0]
  v_cvt_pk_bf16_f32 v37, v34, v35
  ds_write_b64 v19, v[36:37] offset:0
  s_waitcnt lgkmcnt(2)
  v_mfma_f32_16x16x32_bf16 v[92:95], v[52:55], v[104:107], 0
  ds_read_b128 v[64:67], v16 offset:3072
  ds_read_b128 v[68:71], v18 offset:12288
  v_cvt_pk_f16_f32 v32, v84, v85
  v_pk_fma_f16 v33, v32, v32, s92
  v_mfma_f32_16x16x32_bf16 v[96:99], v[52:55], v[108:111], 0
  v_pk_mul_f16 v33, v33, v32 neg_lo:[1,0] neg_hi:[1,0]
  v_exp_f16_sdwa v32, v33 dst_sel:WORD_0 dst_unused:UNUSED_PAD src0_sel:WORD_0
  v_mfma_f32_16x16x32_bf16 v[100:103], v[52:55], v[112:115], 0
  v_exp_f16_sdwa v32, v33 dst_sel:WORD_1 dst_unused:UNUSED_PRESERVE src0_sel:WORD_1
  buffer_load_dwordx4 v20, s[8:11], s94 offen offset:1024 lds
  v_mfma_f32_16x16x32_bf16 v[92:95], v[56:59], v[116:119], v[92:95]
  ds_read_b128 v[52:55], v16 offset:4096
  ds_read_b128 v[72:75], v18 offset:13312
  v_pk_fma_f16 v32, v32, s93, s93
  v_rcp_f16_sdwa v33, v32 dst_sel:WORD_0 dst_unused:UNUSED_PAD src0_sel:WORD_0
  v_mfma_f32_16x16x32_bf16 v[96:99], v[56:59], v[120:123], v[96:99]
  v_rcp_f16_sdwa v33, v32 dst_sel:WORD_1 dst_unused:UNUSED_PRESERVE src0_sel:WORD_1
  v_mfma_f32_16x16x32_bf16 v[100:103], v[56:59], v[124:127], v[100:103]
  v_fma_mix_f32 v32, v84, v33, 0 op_sel_hi:[0,1,0]
  v_fma_mix_f32 v33, v85, v33, 0 op_sel:[0,1,0] op_sel_hi:[0,1,0]
  v_cvt_pk_bf16_f32 v38, v32, v33
  s_waitcnt lgkmcnt(3)
  v_mfma_f32_16x16x32_bf16 v[92:95], v[60:63], v[128:131], v[92:95]
  ds_read_b128 v[56:59], v16 offset:5120
  ds_read_b128 v[76:79], v18 offset:14336
  v_cvt_pk_f16_f32 v34, v86, v87
  v_pk_fma_f16 v35, v34, v34, s92
  v_mfma_f32_16x16x32_bf16 v[96:99], v[60:63], v[132:135], v[96:99]
  v_pk_mul_f16 v35, v35, v34 neg_lo:[1,0] neg_hi:[1,0]
  v_exp_f16_sdwa v34, v35 dst_sel:WORD_0 dst_unused:UNUSED_PAD src0_sel:WORD_0
  v_mfma_f32_16x16x32_bf16 v[100:103], v[60:63], v[136:139], v[100:103]
  v_exp_f16_sdwa v34, v35 dst_sel:WORD_1 dst_unused:UNUSED_PRESERVE src0_sel:WORD_1
  buffer_load_dwordx4 v20, s[8:11], s94 offen offset:2048 lds
  v_mfma_f32_16x16x32_bf16 v[92:95], v[64:67], v[140:143], v[92:95]
  ds_read_b128 v[60:63], v16 offset:12288
  v_pk_fma_f16 v34, v34, s93, s93
  v_rcp_f16_sdwa v35, v34 dst_sel:WORD_0 dst_unused:UNUSED_PAD src0_sel:WORD_0
  v_mfma_f32_16x16x32_bf16 v[96:99], v[64:67], v[144:147], v[96:99]
  v_rcp_f16_sdwa v35, v34 dst_sel:WORD_1 dst_unused:UNUSED_PRESERVE src0_sel:WORD_1
  v_mfma_f32_16x16x32_bf16 v[100:103], v[64:67], v[148:151], v[100:103]
  v_fma_mix_f32 v34, v86, v35, 0 op_sel_hi:[0,1,0]
  v_fma_mix_f32 v35, v87, v35, 0 op_sel:[0,1,0] op_sel_hi:[0,1,0]
  v_cvt_pk_bf16_f32 v39, v34, v35
  ds_write_b64 v19, v[38:39] offset:1024
  s_add_u32 m0, s58, 101376
  v_add_u32 v31, s31, v5
  buffer_load_dwordx4 v31, s[4:7], 0 offen lds
  v_mfma_f32_16x16x32_bf16 v[184:187], v[26:29], v[44:47], v[184:187]
  v_mfma_f32_16x16x32_bf16 v[188:191], v[24:27], v[44:47], v[188:191]
  s_setprio 2
  s_waitcnt lgkmcnt(3)
  v_mfma_f32_16x16x32_bf16 v[92:95], v[52:55], v[152:155], v[92:95]
  ds_read_b128 v[64:67], v16 offset:13312
  v_cvt_pk_f16_f32 v32, v88, v89
  v_pk_fma_f16 v33, v32, v32, s92
  v_mfma_f32_16x16x32_bf16 v[96:99], v[52:55], v[156:159], v[96:99]
  v_pk_mul_f16 v33, v33, v32 neg_lo:[1,0] neg_hi:[1,0]
  v_exp_f16_sdwa v32, v33 dst_sel:WORD_0 dst_unused:UNUSED_PAD src0_sel:WORD_0
  v_mfma_f32_16x16x32_bf16 v[100:103], v[52:55], v[160:163], v[100:103]
  v_exp_f16_sdwa v32, v33 dst_sel:WORD_1 dst_unused:UNUSED_PRESERVE src0_sel:WORD_1
  buffer_load_dwordx4 v[44:47], v22, s[16:19], s55 offen offset:64 nt
  v_mfma_f32_16x16x32_bf16 v[92:95], v[56:59], v[164:167], v[92:95]
  ds_read_b128 v[52:55], v16 offset:14336
  v_pk_fma_f16 v32, v32, s93, s93
  v_rcp_f16_sdwa v33, v32 dst_sel:WORD_0 dst_unused:UNUSED_PAD src0_sel:WORD_0
  v_mfma_f32_16x16x32_bf16 v[96:99], v[56:59], v[168:171], v[96:99]
  v_rcp_f16_sdwa v33, v32 dst_sel:WORD_1 dst_unused:UNUSED_PRESERVE src0_sel:WORD_1
  v_mfma_f32_16x16x32_bf16 v[100:103], v[56:59], v[172:175], v[100:103]
  v_fma_mix_f32 v32, v88, v33, 0 op_sel_hi:[0,1,0]
  v_fma_mix_f32 v33, v89, v33, 0 op_sel:[0,1,0] op_sel_hi:[0,1,0]
  v_cvt_pk_bf16_f32 v36, v32, v33
  s_waitcnt lgkmcnt(1)
  v_mfma_f32_16x16x32_bf16 v[176:179], v[60:63], v[68:71], v[176:179]
  ds_read_b128 v[56:59], v16 offset:15360
  v_cvt_pk_f16_f32 v34, v90, v91
  v_pk_fma_f16 v35, v34, v34, s92
  v_mfma_f32_16x16x32_bf16 v[184:187], v[60:63], v[72:75], v[184:187]
  v_pk_mul_f16 v35, v35, v34 neg_lo:[1,0] neg_hi:[1,0]
  v_exp_f16_sdwa v34, v35 dst_sel:WORD_0 dst_unused:UNUSED_PAD src0_sel:WORD_0
  v_mfma_f32_16x16x32_bf16 v[192:195], v[60:63], v[76:79], v[192:195]
  v_exp_f16_sdwa v34, v35 dst_sel:WORD_1 dst_unused:UNUSED_PRESERVE src0_sel:WORD_1
  s_setprio 1
  v_mfma_f32_16x16x32_bf16 v[180:183], v[64:67], v[68:71], v[180:183]
  ds_read_b128 v[60:63], v16 offset:16384
  v_pk_fma_f16 v34, v34, s93, s93
  v_rcp_f16_sdwa v35, v34 dst_sel:WORD_0 dst_unused:UNUSED_PAD src0_sel:WORD_0
  v_mfma_f32_16x16x32_bf16 v[188:191], v[64:67], v[72:75], v[188:191]
  v_rcp_f16_sdwa v35, v34 dst_sel:WORD_1 dst_unused:UNUSED_PRESERVE src0_sel:WORD_1
  v_mfma_f32_16x16x32_bf16 v[196:199], v[64:67], v[76:79], v[196:199]
  v_fma_mix_f32 v34, v90, v35, 0 op_sel_hi:[0,1,0]
  v_fma_mix_f32 v35, v91, v35, 0 op_sel:[0,1,0] op_sel_hi:[0,1,0]
  v_cvt_pk_bf16_f32 v37, v34, v35
  ds_write_b64 v19, v[36:37] offset:2048
  s_setprio 0
  s_waitcnt lgkmcnt(2)
  v_mfma_f32_16x16x32_bf16 v[200:203], v[52:55], v[68:71], v[200:203]
  ds_read_b128 v[64:67], v16 offset:17408
  v_cvt_pk_f16_f32 v32, v92, v93
  v_pk_fma_f16 v33, v32, v32, s92
  v_mfma_f32_16x16x32_bf16 v[208:211], v[52:55], v[72:75], v[208:211]
  v_pk_mul_f16 v33, v33, v32 neg_lo:[1,0] neg_hi:[1,0]
  v_exp_f16_sdwa v32, v33 dst_sel:WORD_0 dst_unused:UNUSED_PAD src0_sel:WORD_0
  v_mfma_f32_16x16x32_bf16 v[216:219], v[52:55], v[76:79], v[216:219]
  v_exp_f16_sdwa v32, v33 dst_sel:WORD_1 dst_unused:UNUSED_PRESERVE src0_sel:WORD_1
  v_mfma_f32_16x16x32_bf16 v[204:207], v[56:59], v[68:71], v[204:207]
  s_waitcnt vmcnt(7)
  s_waitcnt lgkmcnt(0)
  s_barrier
  s_setprio 3
  ds_read_b128 v[52:55], v16 offset:24576
  v_pk_fma_f16 v32, v32, s93, s93
  v_rcp_f16_sdwa v33, v32 dst_sel:WORD_0 dst_unused:UNUSED_PAD src0_sel:WORD_0
  v_mfma_f32_16x16x32_bf16 v[212:215], v[56:59], v[72:75], v[212:215]
  v_rcp_f16_sdwa v33, v32 dst_sel:WORD_1 dst_unused:UNUSED_PRESERVE src0_sel:WORD_1
  v_mfma_f32_16x16x32_bf16 v[220:223], v[56:59], v[76:79], v[220:223]
  v_fma_mix_f32 v32, v92, v33, 0 op_sel_hi:[0,1,0]
  v_fma_mix_f32 v33, v93, v33, 0 op_sel:[0,1,0] op_sel_hi:[0,1,0]
  v_cvt_pk_bf16_f32 v36, v32, v33
  v_mfma_f32_16x16x32_bf16 v[224:227], v[60:63], v[68:71], v[224:227]
  ds_read_b128 v[56:59], v16 offset:25600
  v_cvt_pk_f16_f32 v34, v94, v95
  v_pk_fma_f16 v35, v34, v34, s92
  v_mfma_f32_16x16x32_bf16 v[232:235], v[60:63], v[72:75], v[232:235]
  v_pk_mul_f16 v35, v35, v34 neg_lo:[1,0] neg_hi:[1,0]
  v_exp_f16_sdwa v34, v35 dst_sel:WORD_0 dst_unused:UNUSED_PAD src0_sel:WORD_0
  v_mfma_f32_16x16x32_bf16 v[240:243], v[60:63], v[76:79], v[240:243]
  v_exp_f16_sdwa v34, v35 dst_sel:WORD_1 dst_unused:UNUSED_PRESERVE src0_sel:WORD_1
  s_add_u32 m0, s57, 0
  s_mov_b32 s94, 221184
  buffer_load_dwordx4 v20, s[8:11], s94 offen offset:0 lds
  v_mfma_f32_16x16x32_bf16 v[228:231], v[64:67], v[68:71], v[228:231]
  ds_read_b128 v[60:63], v16 offset:26624
  v_pk_fma_f16 v34, v34, s93, s93
  v_rcp_f16_sdwa v35, v34 dst_sel:WORD_0 dst_unused:UNUSED_PAD src0_sel:WORD_0
  v_mfma_f32_16x16x32_bf16 v[236:239], v[64:67], v[72:75], v[236:239]
  v_rcp_f16_sdwa v35, v34 dst_sel:WORD_1 dst_unused:UNUSED_PRESERVE src0_sel:WORD_1
  v_mfma_f32_16x16x32_bf16 v[244:247], v[64:67], v[76:79], v[244:247]
  v_fma_mix_f32 v34, v94, v35, 0 op_sel_hi:[0,1,0]
  v_fma_mix_f32 v35, v95, v35, 0 op_sel:[0,1,0] op_sel_hi:[0,1,0]
  v_cvt_pk_bf16_f32 v37, v34, v35
  ds_write_b64 v19, v[36:37] offset:12288
  s_waitcnt lgkmcnt(2)
  v_mfma_f32_16x16x32_bf16 v[80:83], v[52:55], v[104:107], 0
  ds_read_b128 v[64:67], v16 offset:27648
  ds_read_b128 v[68:71], v18 offset:0
  v_cvt_pk_f16_f32 v32, v96, v97
  v_pk_fma_f16 v33, v32, v32, s92
  v_mfma_f32_16x16x32_bf16 v[84:87], v[52:55], v[108:111], 0
  v_pk_mul_f16 v33, v33, v32 neg_lo:[1,0] neg_hi:[1,0]
  v_exp_f16_sdwa v32, v33 dst_sel:WORD_0 dst_unused:UNUSED_PAD src0_sel:WORD_0
  v_mfma_f32_16x16x32_bf16 v[88:91], v[52:55], v[112:115], 0
  v_exp_f16_sdwa v32, v33 dst_sel:WORD_1 dst_unused:UNUSED_PRESERVE src0_sel:WORD_1
  buffer_load_dwordx4 v20, s[8:11], s94 offen offset:1024 lds
  v_mfma_f32_16x16x32_bf16 v[80:83], v[56:59], v[116:119], v[80:83]
  ds_read_b128 v[52:55], v16 offset:28672
  ds_read_b128 v[72:75], v18 offset:1024
  v_pk_fma_f16 v32, v32, s93, s93
  v_rcp_f16_sdwa v33, v32 dst_sel:WORD_0 dst_unused:UNUSED_PAD src0_sel:WORD_0
  v_mfma_f32_16x16x32_bf16 v[84:87], v[56:59], v[120:123], v[84:87]
  v_rcp_f16_sdwa v33, v32 dst_sel:WORD_1 dst_unused:UNUSED_PRESERVE src0_sel:WORD_1
  v_mfma_f32_16x16x32_bf16 v[88:91], v[56:59], v[124:127], v[88:91]
  v_fma_mix_f32 v32, v96, v33, 0 op_sel_hi:[0,1,0]
  v_fma_mix_f32 v33, v97, v33, 0 op_sel:[0,1,0] op_sel_hi:[0,1,0]
  v_cvt_pk_bf16_f32 v38, v32, v33
  s_waitcnt lgkmcnt(3)
  v_mfma_f32_16x16x32_bf16 v[80:83], v[60:63], v[128:131], v[80:83]
  ds_read_b128 v[56:59], v16 offset:29696
  ds_read_b128 v[76:79], v18 offset:2048
  v_cvt_pk_f16_f32 v34, v98, v99
  v_pk_fma_f16 v35, v34, v34, s92
  v_mfma_f32_16x16x32_bf16 v[84:87], v[60:63], v[132:135], v[84:87]
  v_pk_mul_f16 v35, v35, v34 neg_lo:[1,0] neg_hi:[1,0]
  v_exp_f16_sdwa v34, v35 dst_sel:WORD_0 dst_unused:UNUSED_PAD src0_sel:WORD_0
  v_mfma_f32_16x16x32_bf16 v[88:91], v[60:63], v[136:139], v[88:91]
  v_exp_f16_sdwa v34, v35 dst_sel:WORD_1 dst_unused:UNUSED_PRESERVE src0_sel:WORD_1
  buffer_load_dwordx4 v20, s[8:11], s94 offen offset:2048 lds
  v_mfma_f32_16x16x32_bf16 v[80:83], v[64:67], v[140:143], v[80:83]
  ds_read_b128 v[60:63], v16 offset:36864
  v_pk_fma_f16 v34, v34, s93, s93
  v_rcp_f16_sdwa v35, v34 dst_sel:WORD_0 dst_unused:UNUSED_PAD src0_sel:WORD_0
  v_mfma_f32_16x16x32_bf16 v[84:87], v[64:67], v[144:147], v[84:87]
  v_rcp_f16_sdwa v35, v34 dst_sel:WORD_1 dst_unused:UNUSED_PRESERVE src0_sel:WORD_1
  v_mfma_f32_16x16x32_bf16 v[88:91], v[64:67], v[148:151], v[88:91]
  v_fma_mix_f32 v34, v98, v35, 0 op_sel_hi:[0,1,0]
  v_fma_mix_f32 v35, v99, v35, 0 op_sel:[0,1,0] op_sel_hi:[0,1,0]
  v_cvt_pk_bf16_f32 v39, v34, v35
  ds_write_b64 v19, v[38:39] offset:13312
  s_add_u32 m0, s58, 102400
  v_add_u32 v30, s31, v6
  buffer_load_dwordx4 v30, s[4:7], 0 offen lds
  v_mfma_f32_16x16x32_bf16 v[192:195], v[26:29], v[48:51], v[192:195]
  v_mfma_f32_16x16x32_bf16 v[196:199], v[24:27], v[48:51], v[196:199]
  s_setprio 2
  s_waitcnt lgkmcnt(3)
  v_mfma_f32_16x16x32_bf16 v[80:83], v[52:55], v[152:155], v[80:83]
  ds_read_b128 v[64:67], v16 offset:37888
  v_cvt_pk_f16_f32 v32, v100, v101
  v_pk_fma_f16 v33, v32, v32, s92
  v_mfma_f32_16x16x32_bf16 v[84:87], v[52:55], v[156:159], v[84:87]
  v_pk_mul_f16 v33, v33, v32 neg_lo:[1,0] neg_hi:[1,0]
  v_exp_f16_sdwa v32, v33 dst_sel:WORD_0 dst_unused:UNUSED_PAD src0_sel:WORD_0
  v_mfma_f32_16x16x32_bf16 v[88:91], v[52:55], v[160:163], v[88:91]
  v_exp_f16_sdwa v32, v33 dst_sel:WORD_1 dst_unused:UNUSED_PRESERVE src0_sel:WORD_1
  buffer_load_dwordx4 v[48:51], v23, s[16:19], s55 offen offset:64 nt
  v_mfma_f32_16x16x32_bf16 v[80:83], v[56:59], v[164:167], v[80:83]
  ds_read_b128 v[52:55], v16 offset:38912
  v_pk_fma_f16 v32, v32, s93, s93
  v_rcp_f16_sdwa v33, v32 dst_sel:WORD_0 dst_unused:UNUSED_PAD src0_sel:WORD_0
  v_mfma_f32_16x16x32_bf16 v[84:87], v[56:59], v[168:171], v[84:87]
  v_rcp_f16_sdwa v33, v32 dst_sel:WORD_1 dst_unused:UNUSED_PRESERVE src0_sel:WORD_1
  v_mfma_f32_16x16x32_bf16 v[88:91], v[56:59], v[172:175], v[88:91]
  v_fma_mix_f32 v32, v100, v33, 0 op_sel_hi:[0,1,0]
  v_fma_mix_f32 v33, v101, v33, 0 op_sel:[0,1,0] op_sel_hi:[0,1,0]
  v_cvt_pk_bf16_f32 v36, v32, v33
  s_waitcnt lgkmcnt(1)
  v_mfma_f32_16x16x32_bf16 v[176:179], v[60:63], v[68:71], v[176:179]
  ds_read_b128 v[56:59], v16 offset:39936
  v_cvt_pk_f16_f32 v34, v102, v103
  v_pk_fma_f16 v35, v34, v34, s92
  v_mfma_f32_16x16x32_bf16 v[184:187], v[60:63], v[72:75], v[184:187]
  v_pk_mul_f16 v35, v35, v34 neg_lo:[1,0] neg_hi:[1,0]
  v_exp_f16_sdwa v34, v35 dst_sel:WORD_0 dst_unused:UNUSED_PAD src0_sel:WORD_0
  v_mfma_f32_16x16x32_bf16 v[192:195], v[60:63], v[76:79], v[192:195]
  v_exp_f16_sdwa v34, v35 dst_sel:WORD_1 dst_unused:UNUSED_PRESERVE src0_sel:WORD_1
  s_setprio 1
  v_mfma_f32_16x16x32_bf16 v[180:183], v[64:67], v[68:71], v[180:183]
  ds_read_b128 v[60:63], v16 offset:40960
  v_pk_fma_f16 v34, v34, s93, s93
  v_rcp_f16_sdwa v35, v34 dst_sel:WORD_0 dst_unused:UNUSED_PAD src0_sel:WORD_0
  v_mfma_f32_16x16x32_bf16 v[188:191], v[64:67], v[72:75], v[188:191]
  v_rcp_f16_sdwa v35, v34 dst_sel:WORD_1 dst_unused:UNUSED_PRESERVE src0_sel:WORD_1
  v_mfma_f32_16x16x32_bf16 v[196:199], v[64:67], v[76:79], v[196:199]
  v_fma_mix_f32 v34, v102, v35, 0 op_sel_hi:[0,1,0]
  v_fma_mix_f32 v35, v103, v35, 0 op_sel:[0,1,0] op_sel_hi:[0,1,0]
  v_cvt_pk_bf16_f32 v37, v34, v35
  ds_write_b64 v19, v[36:37] offset:14336
  s_setprio 0
  s_waitcnt lgkmcnt(2)
  v_mfma_f32_16x16x32_bf16 v[200:203], v[52:55], v[68:71], v[200:203]
  ds_read_b128 v[64:67], v16 offset:41984
  v_cvt_pk_f16_f32 v32, v80, v81
  v_pk_fma_f16 v33, v32, v32, s92
  v_mfma_f32_16x16x32_bf16 v[208:211], v[52:55], v[72:75], v[208:211]
  v_pk_mul_f16 v33, v33, v32 neg_lo:[1,0] neg_hi:[1,0]
  v_exp_f16_sdwa v32, v33 dst_sel:WORD_0 dst_unused:UNUSED_PAD src0_sel:WORD_0
  v_mfma_f32_16x16x32_bf16 v[216:219], v[52:55], v[76:79], v[216:219]
  v_exp_f16_sdwa v32, v33 dst_sel:WORD_1 dst_unused:UNUSED_PRESERVE src0_sel:WORD_1
  v_mfma_f32_16x16x32_bf16 v[204:207], v[56:59], v[68:71], v[204:207]
  s_waitcnt vmcnt(7)
  s_waitcnt lgkmcnt(0)
  s_barrier
  s_setprio 3
  ds_read_b128 v[52:55], v17 offset:0
  v_pk_fma_f16 v32, v32, s93, s93
  v_rcp_f16_sdwa v33, v32 dst_sel:WORD_0 dst_unused:UNUSED_PAD src0_sel:WORD_0
  v_mfma_f32_16x16x32_bf16 v[212:215], v[56:59], v[72:75], v[212:215]
  v_rcp_f16_sdwa v33, v32 dst_sel:WORD_1 dst_unused:UNUSED_PRESERVE src0_sel:WORD_1
  v_mfma_f32_16x16x32_bf16 v[220:223], v[56:59], v[76:79], v[220:223]
  v_fma_mix_f32 v32, v80, v33, 0 op_sel_hi:[0,1,0]
  v_fma_mix_f32 v33, v81, v33, 0 op_sel:[0,1,0] op_sel_hi:[0,1,0]
  v_cvt_pk_bf16_f32 v36, v32, v33
  v_mfma_f32_16x16x32_bf16 v[224:227], v[60:63], v[68:71], v[224:227]
  ds_read_b128 v[56:59], v17 offset:1024
  v_cvt_pk_f16_f32 v34, v82, v83
  v_pk_fma_f16 v35, v34, v34, s92
  v_mfma_f32_16x16x32_bf16 v[232:235], v[60:63], v[72:75], v[232:235]
  v_pk_mul_f16 v35, v35, v34 neg_lo:[1,0] neg_hi:[1,0]
  v_exp_f16_sdwa v34, v35 dst_sel:WORD_0 dst_unused:UNUSED_PAD src0_sel:WORD_0
  v_mfma_f32_16x16x32_bf16 v[240:243], v[60:63], v[76:79], v[240:243]
  v_exp_f16_sdwa v34, v35 dst_sel:WORD_1 dst_unused:UNUSED_PRESERVE src0_sel:WORD_1
  s_add_u32 m0, s57, 24576
  s_mov_b32 s94, 245760
  buffer_load_dwordx4 v20, s[8:11], s94 offen offset:0 lds
  v_mfma_f32_16x16x32_bf16 v[228:231], v[64:67], v[68:71], v[228:231]
  ds_read_b128 v[60:63], v17 offset:2048
  v_pk_fma_f16 v34, v34, s93, s93
  v_rcp_f16_sdwa v35, v34 dst_sel:WORD_0 dst_unused:UNUSED_PAD src0_sel:WORD_0
  v_mfma_f32_16x16x32_bf16 v[236:239], v[64:67], v[72:75], v[236:239]
  v_rcp_f16_sdwa v35, v34 dst_sel:WORD_1 dst_unused:UNUSED_PRESERVE src0_sel:WORD_1
  v_mfma_f32_16x16x32_bf16 v[244:247], v[64:67], v[76:79], v[244:247]
  v_fma_mix_f32 v34, v82, v35, 0 op_sel_hi:[0,1,0]
  v_fma_mix_f32 v35, v83, v35, 0 op_sel:[0,1,0] op_sel_hi:[0,1,0]
  v_cvt_pk_bf16_f32 v37, v34, v35
  ds_write_b64 v19, v[36:37] offset:0
  s_waitcnt lgkmcnt(2)
  v_mfma_f32_16x16x32_bf16 v[92:95], v[52:55], v[104:107], 0
  ds_read_b128 v[64:67], v17 offset:3072
  ds_read_b128 v[68:71], v18 offset:12288
  v_cvt_pk_f16_f32 v32, v84, v85
  v_pk_fma_f16 v33, v32, v32, s92
  v_mfma_f32_16x16x32_bf16 v[96:99], v[52:55], v[108:111], 0
  v_pk_mul_f16 v33, v33, v32 neg_lo:[1,0] neg_hi:[1,0]
  v_exp_f16_sdwa v32, v33 dst_sel:WORD_0 dst_unused:UNUSED_PAD src0_sel:WORD_0
  v_mfma_f32_16x16x32_bf16 v[100:103], v[52:55], v[112:115], 0
  v_exp_f16_sdwa v32, v33 dst_sel:WORD_1 dst_unused:UNUSED_PRESERVE src0_sel:WORD_1
  buffer_load_dwordx4 v20, s[8:11], s94 offen offset:1024 lds
  v_mfma_f32_16x16x32_bf16 v[92:95], v[56:59], v[116:119], v[92:95]
  ds_read_b128 v[52:55], v17 offset:4096
  ds_read_b128 v[72:75], v18 offset:13312
  v_pk_fma_f16 v32, v32, s93, s93
  v_rcp_f16_sdwa v33, v32 dst_sel:WORD_0 dst_unused:UNUSED_PAD src0_sel:WORD_0
  v_mfma_f32_16x16x32_bf16 v[96:99], v[56:59], v[120:123], v[96:99]
  v_rcp_f16_sdwa v33, v32 dst_sel:WORD_1 dst_unused:UNUSED_PRESERVE src0_sel:WORD_1
  v_mfma_f32_16x16x32_bf16 v[100:103], v[56:59], v[124:127], v[100:103]
  v_fma_mix_f32 v32, v84, v33, 0 op_sel_hi:[0,1,0]
  v_fma_mix_f32 v33, v85, v33, 0 op_sel:[0,1,0] op_sel_hi:[0,1,0]
  v_cvt_pk_bf16_f32 v38, v32, v33
  s_waitcnt lgkmcnt(3)
  v_mfma_f32_16x16x32_bf16 v[92:95], v[60:63], v[128:131], v[92:95]
  ds_read_b128 v[56:59], v17 offset:5120
  ds_read_b128 v[76:79], v18 offset:14336
  v_cvt_pk_f16_f32 v34, v86, v87
  v_pk_fma_f16 v35, v34, v34, s92
  v_mfma_f32_16x16x32_bf16 v[96:99], v[60:63], v[132:135], v[96:99]
  v_pk_mul_f16 v35, v35, v34 neg_lo:[1,0] neg_hi:[1,0]
  v_exp_f16_sdwa v34, v35 dst_sel:WORD_0 dst_unused:UNUSED_PAD src0_sel:WORD_0
  v_mfma_f32_16x16x32_bf16 v[100:103], v[60:63], v[136:139], v[100:103]
  v_exp_f16_sdwa v34, v35 dst_sel:WORD_1 dst_unused:UNUSED_PRESERVE src0_sel:WORD_1
  buffer_load_dwordx4 v20, s[8:11], s94 offen offset:2048 lds
  v_mfma_f32_16x16x32_bf16 v[92:95], v[64:67], v[140:143], v[92:95]
  ds_read_b128 v[60:63], v17 offset:12288
  v_pk_fma_f16 v34, v34, s93, s93
  v_rcp_f16_sdwa v35, v34 dst_sel:WORD_0 dst_unused:UNUSED_PAD src0_sel:WORD_0
  v_mfma_f32_16x16x32_bf16 v[96:99], v[64:67], v[144:147], v[96:99]
  v_rcp_f16_sdwa v35, v34 dst_sel:WORD_1 dst_unused:UNUSED_PRESERVE src0_sel:WORD_1
  v_mfma_f32_16x16x32_bf16 v[100:103], v[64:67], v[148:151], v[100:103]
  v_fma_mix_f32 v34, v86, v35, 0 op_sel_hi:[0,1,0]
  v_fma_mix_f32 v35, v87, v35, 0 op_sel:[0,1,0] op_sel_hi:[0,1,0]
  v_cvt_pk_bf16_f32 v39, v34, v35
  ds_write_b64 v19, v[38:39] offset:1024
  s_add_u32 m0, s58, 103424
  v_add_u32 v31, s31, v7
  buffer_load_dwordx4 v31, s[4:7], 0 offen lds
  v_mfma_f32_16x16x32_bf16 v[200:203], v[26:29], v[40:43], v[200:203]
  v_mfma_f32_16x16x32_bf16 v[204:207], v[24:27], v[40:43], v[204:207]
  s_setprio 2
  s_waitcnt lgkmcnt(3)
  v_mfma_f32_16x16x32_bf16 v[92:95], v[52:55], v[152:155], v[92:95]
  ds_read_b128 v[64:67], v17 offset:13312
  v_cvt_pk_f16_f32 v32, v88, v89
  v_pk_fma_f16 v33, v32, v32, s92
  v_mfma_f32_16x16x32_bf16 v[96:99], v[52:55], v[156:159], v[96:99]
  v_pk_mul_f16 v33, v33, v32 neg_lo:[1,0] neg_hi:[1,0]
  v_exp_f16_sdwa v32, v33 dst_sel:WORD_0 dst_unused:UNUSED_PAD src0_sel:WORD_0
  v_mfma_f32_16x16x32_bf16 v[100:103], v[52:55], v[160:163], v[100:103]
  v_exp_f16_sdwa v32, v33 dst_sel:WORD_1 dst_unused:UNUSED_PRESERVE src0_sel:WORD_1
  buffer_load_dwordx4 v[40:43], v21, s[16:19], s55 offen offset:128 nt
  v_mfma_f32_16x16x32_bf16 v[92:95], v[56:59], v[164:167], v[92:95]
  ds_read_b128 v[52:55], v17 offset:14336
  v_pk_fma_f16 v32, v32, s93, s93
  v_rcp_f16_sdwa v33, v32 dst_sel:WORD_0 dst_unused:UNUSED_PAD src0_sel:WORD_0
  v_mfma_f32_16x16x32_bf16 v[96:99], v[56:59], v[168:171], v[96:99]
  v_rcp_f16_sdwa v33, v32 dst_sel:WORD_1 dst_unused:UNUSED_PRESERVE src0_sel:WORD_1
  v_mfma_f32_16x16x32_bf16 v[100:103], v[56:59], v[172:175], v[100:103]
  v_fma_mix_f32 v32, v88, v33, 0 op_sel_hi:[0,1,0]
  v_fma_mix_f32 v33, v89, v33, 0 op_sel:[0,1,0] op_sel_hi:[0,1,0]
  v_cvt_pk_bf16_f32 v36, v32, v33
  s_waitcnt lgkmcnt(1)
  v_mfma_f32_16x16x32_bf16 v[176:179], v[60:63], v[68:71], v[176:179]
  ds_read_b128 v[56:59], v17 offset:15360
  v_cvt_pk_f16_f32 v34, v90, v91
  v_pk_fma_f16 v35, v34, v34, s92
  v_mfma_f32_16x16x32_bf16 v[184:187], v[60:63], v[72:75], v[184:187]
  v_pk_mul_f16 v35, v35, v34 neg_lo:[1,0] neg_hi:[1,0]
  v_exp_f16_sdwa v34, v35 dst_sel:WORD_0 dst_unused:UNUSED_PAD src0_sel:WORD_0
  v_mfma_f32_16x16x32_bf16 v[192:195], v[60:63], v[76:79], v[192:195]
  v_exp_f16_sdwa v34, v35 dst_sel:WORD_1 dst_unused:UNUSED_PRESERVE src0_sel:WORD_1
  s_setprio 1
  v_mfma_f32_16x16x32_bf16 v[180:183], v[64:67], v[68:71], v[180:183]
  ds_read_b128 v[60:63], v17 offset:16384
  v_pk_fma_f16 v34, v34, s93, s93
  v_rcp_f16_sdwa v35, v34 dst_sel:WORD_0 dst_unused:UNUSED_PAD src0_sel:WORD_0
  v_mfma_f32_16x16x32_bf16 v[188:191], v[64:67], v[72:75], v[188:191]
  v_rcp_f16_sdwa v35, v34 dst_sel:WORD_1 dst_unused:UNUSED_PRESERVE src0_sel:WORD_1
  v_mfma_f32_16x16x32_bf16 v[196:199], v[64:67], v[76:79], v[196:199]
  v_fma_mix_f32 v34, v90, v35, 0 op_sel_hi:[0,1,0]
  v_fma_mix_f32 v35, v91, v35, 0 op_sel:[0,1,0] op_sel_hi:[0,1,0]
  v_cvt_pk_bf16_f32 v37, v34, v35
  ds_write_b64 v19, v[36:37] offset:2048
  s_setprio 0
  s_waitcnt lgkmcnt(2)
  v_mfma_f32_16x16x32_bf16 v[200:203], v[52:55], v[68:71], v[200:203]
  ds_read_b128 v[64:67], v17 offset:17408
  v_cvt_pk_f16_f32 v32, v92, v93
  v_pk_fma_f16 v33, v32, v32, s92
  v_mfma_f32_16x16x32_bf16 v[208:211], v[52:55], v[72:75], v[208:211]
  v_pk_mul_f16 v33, v33, v32 neg_lo:[1,0] neg_hi:[1,0]
  v_exp_f16_sdwa v32, v33 dst_sel:WORD_0 dst_unused:UNUSED_PAD src0_sel:WORD_0
  v_mfma_f32_16x16x32_bf16 v[216:219], v[52:55], v[76:79], v[216:219]
  v_exp_f16_sdwa v32, v33 dst_sel:WORD_1 dst_unused:UNUSED_PRESERVE src0_sel:WORD_1
  v_mfma_f32_16x16x32_bf16 v[204:207], v[56:59], v[68:71], v[204:207]
  s_waitcnt vmcnt(7)
  s_waitcnt lgkmcnt(0)
  s_barrier
  s_setprio 3
  ds_read_b128 v[52:55], v16 offset:0
  v_pk_fma_f16 v32, v32, s93, s93
  v_rcp_f16_sdwa v33, v32 dst_sel:WORD_0 dst_unused:UNUSED_PAD src0_sel:WORD_0
  v_mfma_f32_16x16x32_bf16 v[212:215], v[56:59], v[72:75], v[212:215]
  v_rcp_f16_sdwa v33, v32 dst_sel:WORD_1 dst_unused:UNUSED_PRESERVE src0_sel:WORD_1
  v_mfma_f32_16x16x32_bf16 v[220:223], v[56:59], v[76:79], v[220:223]
  v_fma_mix_f32 v32, v92, v33, 0 op_sel_hi:[0,1,0]
  v_fma_mix_f32 v33, v93, v33, 0 op_sel:[0,1,0] op_sel_hi:[0,1,0]
  v_cvt_pk_bf16_f32 v36, v32, v33
  v_mfma_f32_16x16x32_bf16 v[224:227], v[60:63], v[68:71], v[224:227]
  ds_read_b128 v[56:59], v16 offset:1024
  v_cvt_pk_f16_f32 v34, v94, v95
  v_pk_fma_f16 v35, v34, v34, s92
  v_mfma_f32_16x16x32_bf16 v[232:235], v[60:63], v[72:75], v[232:235]
  v_pk_mul_f16 v35, v35, v34 neg_lo:[1,0] neg_hi:[1,0]
  v_exp_f16_sdwa v34, v35 dst_sel:WORD_0 dst_unused:UNUSED_PAD src0_sel:WORD_0
  v_mfma_f32_16x16x32_bf16 v[240:243], v[60:63], v[76:79], v[240:243]
  v_exp_f16_sdwa v34, v35 dst_sel:WORD_1 dst_unused:UNUSED_PRESERVE src0_sel:WORD_1
  s_add_u32 m0, s57, 49152
  s_mov_b32 s94, 270336
  buffer_load_dwordx4 v20, s[8:11], s94 offen offset:0 lds
  v_mfma_f32_16x16x32_bf16 v[228:231], v[64:67], v[68:71], v[228:231]
  ds_read_b128 v[60:63], v16 offset:2048
  v_pk_fma_f16 v34, v34, s93, s93
  v_rcp_f16_sdwa v35, v34 dst_sel:WORD_0 dst_unused:UNUSED_PAD src0_sel:WORD_0
  v_mfma_f32_16x16x32_bf16 v[236:239], v[64:67], v[72:75], v[236:239]
  v_rcp_f16_sdwa v35, v34 dst_sel:WORD_1 dst_unused:UNUSED_PRESERVE src0_sel:WORD_1
  v_mfma_f32_16x16x32_bf16 v[244:247], v[64:67], v[76:79], v[244:247]
  v_fma_mix_f32 v34, v94, v35, 0 op_sel_hi:[0,1,0]
  v_fma_mix_f32 v35, v95, v35, 0 op_sel:[0,1,0] op_sel_hi:[0,1,0]
  v_cvt_pk_bf16_f32 v37, v34, v35
  ds_write_b64 v19, v[36:37] offset:12288
  s_waitcnt lgkmcnt(2)
  v_mfma_f32_16x16x32_bf16 v[80:83], v[52:55], v[104:107], 0
  ds_read_b128 v[64:67], v16 offset:3072
  ds_read_b128 v[68:71], v18 offset:0
  v_cvt_pk_f16_f32 v32, v96, v97
  v_pk_fma_f16 v33, v32, v32, s92
  v_mfma_f32_16x16x32_bf16 v[84:87], v[52:55], v[108:111], 0
  v_pk_mul_f16 v33, v33, v32 neg_lo:[1,0] neg_hi:[1,0]
  v_exp_f16_sdwa v32, v33 dst_sel:WORD_0 dst_unused:UNUSED_PAD src0_sel:WORD_0
  v_mfma_f32_16x16x32_bf16 v[88:91], v[52:55], v[112:115], 0
  v_exp_f16_sdwa v32, v33 dst_sel:WORD_1 dst_unused:UNUSED_PRESERVE src0_sel:WORD_1
  buffer_load_dwordx4 v20, s[8:11], s94 offen offset:1024 lds
  v_mfma_f32_16x16x32_bf16 v[80:83], v[56:59], v[116:119], v[80:83]
  ds_read_b128 v[52:55], v16 offset:4096
  ds_read_b128 v[72:75], v18 offset:1024
  v_pk_fma_f16 v32, v32, s93, s93
  v_rcp_f16_sdwa v33, v32 dst_sel:WORD_0 dst_unused:UNUSED_PAD src0_sel:WORD_0
  v_mfma_f32_16x16x32_bf16 v[84:87], v[56:59], v[120:123], v[84:87]
  v_rcp_f16_sdwa v33, v32 dst_sel:WORD_1 dst_unused:UNUSED_PRESERVE src0_sel:WORD_1
  v_mfma_f32_16x16x32_bf16 v[88:91], v[56:59], v[124:127], v[88:91]
  v_fma_mix_f32 v32, v96, v33, 0 op_sel_hi:[0,1,0]
  v_fma_mix_f32 v33, v97, v33, 0 op_sel:[0,1,0] op_sel_hi:[0,1,0]
  v_cvt_pk_bf16_f32 v38, v32, v33
  s_waitcnt lgkmcnt(3)
  v_mfma_f32_16x16x32_bf16 v[80:83], v[60:63], v[128:131], v[80:83]
  ds_read_b128 v[56:59], v16 offset:5120
  ds_read_b128 v[76:79], v18 offset:2048
  v_cvt_pk_f16_f32 v34, v98, v99
  v_pk_fma_f16 v35, v34, v34, s92
  v_mfma_f32_16x16x32_bf16 v[84:87], v[60:63], v[132:135], v[84:87]
  v_pk_mul_f16 v35, v35, v34 neg_lo:[1,0] neg_hi:[1,0]
  v_exp_f16_sdwa v34, v35 dst_sel:WORD_0 dst_unused:UNUSED_PAD src0_sel:WORD_0
  v_mfma_f32_16x16x32_bf16 v[88:91], v[60:63], v[136:139], v[88:91]
  v_exp_f16_sdwa v34, v35 dst_sel:WORD_1 dst_unused:UNUSED_PRESERVE src0_sel:WORD_1
  buffer_load_dwordx4 v20, s[8:11], s94 offen offset:2048 lds
  v_mfma_f32_16x16x32_bf16 v[80:83], v[64:67], v[140:143], v[80:83]
  ds_read_b128 v[60:63], v16 offset:12288
  v_pk_fma_f16 v34, v34, s93, s93
  v_rcp_f16_sdwa v35, v34 dst_sel:WORD_0 dst_unused:UNUSED_PAD src0_sel:WORD_0
  v_mfma_f32_16x16x32_bf16 v[84:87], v[64:67], v[144:147], v[84:87]
  v_rcp_f16_sdwa v35, v34 dst_sel:WORD_1 dst_unused:UNUSED_PRESERVE src0_sel:WORD_1
  v_mfma_f32_16x16x32_bf16 v[88:91], v[64:67], v[148:151], v[88:91]
  v_fma_mix_f32 v34, v98, v35, 0 op_sel_hi:[0,1,0]
  v_fma_mix_f32 v35, v99, v35, 0 op_sel:[0,1,0] op_sel_hi:[0,1,0]
  v_cvt_pk_bf16_f32 v39, v34, v35
  ds_write_b64 v19, v[38:39] offset:13312
  s_add_u32 m0, s58, 104448
  v_add_u32 v30, s31, v8
  buffer_load_dwordx4 v30, s[4:7], 0 offen lds
  v_mfma_f32_16x16x32_bf16 v[208:211], v[26:29], v[44:47], v[208:211]
  v_mfma_f32_16x16x32_bf16 v[212:215], v[24:27], v[44:47], v[212:215]
  s_setprio 2
  s_waitcnt lgkmcnt(3)
  v_mfma_f32_16x16x32_bf16 v[80:83], v[52:55], v[152:155], v[80:83]
  ds_read_b128 v[64:67], v16 offset:13312
  v_cvt_pk_f16_f32 v32, v100, v101
  v_pk_fma_f16 v33, v32, v32, s92
  v_mfma_f32_16x16x32_bf16 v[84:87], v[52:55], v[156:159], v[84:87]
  v_pk_mul_f16 v33, v33, v32 neg_lo:[1,0] neg_hi:[1,0]
  v_exp_f16_sdwa v32, v33 dst_sel:WORD_0 dst_unused:UNUSED_PAD src0_sel:WORD_0
  v_mfma_f32_16x16x32_bf16 v[88:91], v[52:55], v[160:163], v[88:91]
  v_exp_f16_sdwa v32, v33 dst_sel:WORD_1 dst_unused:UNUSED_PRESERVE src0_sel:WORD_1
  buffer_load_dwordx4 v[44:47], v22, s[16:19], s55 offen offset:128 nt
  v_mfma_f32_16x16x32_bf16 v[80:83], v[56:59], v[164:167], v[80:83]
  ds_read_b128 v[52:55], v16 offset:14336
  v_pk_fma_f16 v32, v32, s93, s93
  v_rcp_f16_sdwa v33, v32 dst_sel:WORD_0 dst_unused:UNUSED_PAD src0_sel:WORD_0
  v_mfma_f32_16x16x32_bf16 v[84:87], v[56:59], v[168:171], v[84:87]
  v_rcp_f16_sdwa v33, v32 dst_sel:WORD_1 dst_unused:UNUSED_PRESERVE src0_sel:WORD_1
  v_mfma_f32_16x16x32_bf16 v[88:91], v[56:59], v[172:175], v[88:91]
  v_fma_mix_f32 v32, v100, v33, 0 op_sel_hi:[0,1,0]
  v_fma_mix_f32 v33, v101, v33, 0 op_sel:[0,1,0] op_sel_hi:[0,1,0]
  v_cvt_pk_bf16_f32 v36, v32, v33
  s_waitcnt lgkmcnt(1)
  v_mfma_f32_16x16x32_bf16 v[176:179], v[60:63], v[68:71], v[176:179]
  ds_read_b128 v[56:59], v16 offset:15360
  v_cvt_pk_f16_f32 v34, v102, v103
  v_pk_fma_f16 v35, v34, v34, s92
  v_mfma_f32_16x16x32_bf16 v[184:187], v[60:63], v[72:75], v[184:187]
  v_pk_mul_f16 v35, v35, v34 neg_lo:[1,0] neg_hi:[1,0]
  v_exp_f16_sdwa v34, v35 dst_sel:WORD_0 dst_unused:UNUSED_PAD src0_sel:WORD_0
  v_mfma_f32_16x16x32_bf16 v[192:195], v[60:63], v[76:79], v[192:195]
  v_exp_f16_sdwa v34, v35 dst_sel:WORD_1 dst_unused:UNUSED_PRESERVE src0_sel:WORD_1
  s_setprio 1
  v_mfma_f32_16x16x32_bf16 v[180:183], v[64:67], v[68:71], v[180:183]
  ds_read_b128 v[60:63], v16 offset:16384
  v_pk_fma_f16 v34, v34, s93, s93
  v_rcp_f16_sdwa v35, v34 dst_sel:WORD_0 dst_unused:UNUSED_PAD src0_sel:WORD_0
  v_mfma_f32_16x16x32_bf16 v[188:191], v[64:67], v[72:75], v[188:191]
  v_rcp_f16_sdwa v35, v34 dst_sel:WORD_1 dst_unused:UNUSED_PRESERVE src0_sel:WORD_1
  v_mfma_f32_16x16x32_bf16 v[196:199], v[64:67], v[76:79], v[196:199]
  v_fma_mix_f32 v34, v102, v35, 0 op_sel_hi:[0,1,0]
  v_fma_mix_f32 v35, v103, v35, 0 op_sel:[0,1,0] op_sel_hi:[0,1,0]
  v_cvt_pk_bf16_f32 v37, v34, v35
  ds_write_b64 v19, v[36:37] offset:14336
  s_setprio 0
  s_waitcnt lgkmcnt(2)
  v_mfma_f32_16x16x32_bf16 v[200:203], v[52:55], v[68:71], v[200:203]
  ds_read_b128 v[64:67], v16 offset:17408
  v_cvt_pk_f16_f32 v32, v80, v81
  v_pk_fma_f16 v33, v32, v32, s92
  v_mfma_f32_16x16x32_bf16 v[208:211], v[52:55], v[72:75], v[208:211]
  v_pk_mul_f16 v33, v33, v32 neg_lo:[1,0] neg_hi:[1,0]
  v_exp_f16_sdwa v32, v33 dst_sel:WORD_0 dst_unused:UNUSED_PAD src0_sel:WORD_0
  v_mfma_f32_16x16x32_bf16 v[216:219], v[52:55], v[76:79], v[216:219]
  v_exp_f16_sdwa v32, v33 dst_sel:WORD_1 dst_unused:UNUSED_PRESERVE src0_sel:WORD_1
  v_mfma_f32_16x16x32_bf16 v[204:207], v[56:59], v[68:71], v[204:207]
  s_waitcnt vmcnt(7)
  s_waitcnt lgkmcnt(0)
  s_barrier
  s_setprio 3
  ds_read_b128 v[52:55], v16 offset:24576
  v_pk_fma_f16 v32, v32, s93, s93
  v_rcp_f16_sdwa v33, v32 dst_sel:WORD_0 dst_unused:UNUSED_PAD src0_sel:WORD_0
  v_mfma_f32_16x16x32_bf16 v[212:215], v[56:59], v[72:75], v[212:215]
  v_rcp_f16_sdwa v33, v32 dst_sel:WORD_1 dst_unused:UNUSED_PRESERVE src0_sel:WORD_1
  v_mfma_f32_16x16x32_bf16 v[220:223], v[56:59], v[76:79], v[220:223]
  v_fma_mix_f32 v32, v80, v33, 0 op_sel_hi:[0,1,0]
  v_fma_mix_f32 v33, v81, v33, 0 op_sel:[0,1,0] op_sel_hi:[0,1,0]
  v_cvt_pk_bf16_f32 v36, v32, v33
  v_mfma_f32_16x16x32_bf16 v[224:227], v[60:63], v[68:71], v[224:227]
  ds_read_b128 v[56:59], v16 offset:25600
  v_cvt_pk_f16_f32 v34, v82, v83
  v_pk_fma_f16 v35, v34, v34, s92
  v_mfma_f32_16x16x32_bf16 v[232:235], v[60:63], v[72:75], v[232:235]
  v_pk_mul_f16 v35, v35, v34 neg_lo:[1,0] neg_hi:[1,0]
  v_exp_f16_sdwa v34, v35 dst_sel:WORD_0 dst_unused:UNUSED_PAD src0_sel:WORD_0
  v_mfma_f32_16x16x32_bf16 v[240:243], v[60:63], v[76:79], v[240:243]
  v_exp_f16_sdwa v34, v35 dst_sel:WORD_1 dst_unused:UNUSED_PRESERVE src0_sel:WORD_1
  s_add_u32 m0, s57, 0
  s_mov_b32 s94, 294912
  buffer_load_dwordx4 v20, s[8:11], s94 offen offset:0 lds
  v_mfma_f32_16x16x32_bf16 v[228:231], v[64:67], v[68:71], v[228:231]
  ds_read_b128 v[60:63], v16 offset:26624
  v_pk_fma_f16 v34, v34, s93, s93
  v_rcp_f16_sdwa v35, v34 dst_sel:WORD_0 dst_unused:UNUSED_PAD src0_sel:WORD_0
  v_mfma_f32_16x16x32_bf16 v[236:239], v[64:67], v[72:75], v[236:239]
  v_rcp_f16_sdwa v35, v34 dst_sel:WORD_1 dst_unused:UNUSED_PRESERVE src0_sel:WORD_1
  v_mfma_f32_16x16x32_bf16 v[244:247], v[64:67], v[76:79], v[244:247]
  v_fma_mix_f32 v34, v82, v35, 0 op_sel_hi:[0,1,0]
  v_fma_mix_f32 v35, v83, v35, 0 op_sel:[0,1,0] op_sel_hi:[0,1,0]
  v_cvt_pk_bf16_f32 v37, v34, v35
  ds_write_b64 v19, v[36:37] offset:0
  s_waitcnt lgkmcnt(2)
  v_mfma_f32_16x16x32_bf16 v[92:95], v[52:55], v[104:107], 0
  ds_read_b128 v[64:67], v16 offset:27648
  ds_read_b128 v[68:71], v18 offset:12288
  v_cvt_pk_f16_f32 v32, v84, v85
  v_pk_fma_f16 v33, v32, v32, s92
  v_mfma_f32_16x16x32_bf16 v[96:99], v[52:55], v[108:111], 0
  v_pk_mul_f16 v33, v33, v32 neg_lo:[1,0] neg_hi:[1,0]
  v_exp_f16_sdwa v32, v33 dst_sel:WORD_0 dst_unused:UNUSED_PAD src0_sel:WORD_0
  v_mfma_f32_16x16x32_bf16 v[100:103], v[52:55], v[112:115], 0
  v_exp_f16_sdwa v32, v33 dst_sel:WORD_1 dst_unused:UNUSED_PRESERVE src0_sel:WORD_1
  buffer_load_dwordx4 v20, s[8:11], s94 offen offset:1024 lds
  v_mfma_f32_16x16x32_bf16 v[92:95], v[56:59], v[116:119], v[92:95]
  ds_read_b128 v[52:55], v16 offset:28672
  ds_read_b128 v[72:75], v18 offset:13312
  v_pk_fma_f16 v32, v32, s93, s93
  v_rcp_f16_sdwa v33, v32 dst_sel:WORD_0 dst_unused:UNUSED_PAD src0_sel:WORD_0
  v_mfma_f32_16x16x32_bf16 v[96:99], v[56:59], v[120:123], v[96:99]
  v_rcp_f16_sdwa v33, v32 dst_sel:WORD_1 dst_unused:UNUSED_PRESERVE src0_sel:WORD_1
  v_mfma_f32_16x16x32_bf16 v[100:103], v[56:59], v[124:127], v[100:103]
  v_fma_mix_f32 v32, v84, v33, 0 op_sel_hi:[0,1,0]
  v_fma_mix_f32 v33, v85, v33, 0 op_sel:[0,1,0] op_sel_hi:[0,1,0]
  v_cvt_pk_bf16_f32 v38, v32, v33
  s_waitcnt lgkmcnt(3)
  v_mfma_f32_16x16x32_bf16 v[92:95], v[60:63], v[128:131], v[92:95]
  ds_read_b128 v[56:59], v16 offset:29696
  ds_read_b128 v[76:79], v18 offset:14336
  v_cvt_pk_f16_f32 v34, v86, v87
  v_pk_fma_f16 v35, v34, v34, s92
  v_mfma_f32_16x16x32_bf16 v[96:99], v[60:63], v[132:135], v[96:99]
  v_pk_mul_f16 v35, v35, v34 neg_lo:[1,0] neg_hi:[1,0]
  v_exp_f16_sdwa v34, v35 dst_sel:WORD_0 dst_unused:UNUSED_PAD src0_sel:WORD_0
  v_mfma_f32_16x16x32_bf16 v[100:103], v[60:63], v[136:139], v[100:103]
  v_exp_f16_sdwa v34, v35 dst_sel:WORD_1 dst_unused:UNUSED_PRESERVE src0_sel:WORD_1
  buffer_load_dwordx4 v20, s[8:11], s94 offen offset:2048 lds
  v_mfma_f32_16x16x32_bf16 v[92:95], v[64:67], v[140:143], v[92:95]
  ds_read_b128 v[60:63], v16 offset:36864
  v_pk_fma_f16 v34, v34, s93, s93
  v_rcp_f16_sdwa v35, v34 dst_sel:WORD_0 dst_unused:UNUSED_PAD src0_sel:WORD_0
  v_mfma_f32_16x16x32_bf16 v[96:99], v[64:67], v[144:147], v[96:99]
  v_rcp_f16_sdwa v35, v34 dst_sel:WORD_1 dst_unused:UNUSED_PRESERVE src0_sel:WORD_1
  v_mfma_f32_16x16x32_bf16 v[100:103], v[64:67], v[148:151], v[100:103]
  v_fma_mix_f32 v34, v86, v35, 0 op_sel_hi:[0,1,0]
  v_fma_mix_f32 v35, v87, v35, 0 op_sel:[0,1,0] op_sel_hi:[0,1,0]
  v_cvt_pk_bf16_f32 v39, v34, v35
  ds_write_b64 v19, v[38:39] offset:1024
  v_mfma_f32_16x16x32_bf16 v[216:219], v[26:29], v[48:51], v[216:219]
  v_mfma_f32_16x16x32_bf16 v[220:223], v[24:27], v[48:51], v[220:223]
  s_setprio 2
  s_waitcnt lgkmcnt(3)
  v_mfma_f32_16x16x32_bf16 v[92:95], v[52:55], v[152:155], v[92:95]
  ds_read_b128 v[64:67], v16 offset:37888
  v_cvt_pk_f16_f32 v32, v88, v89
  v_pk_fma_f16 v33, v32, v32, s92
  v_mfma_f32_16x16x32_bf16 v[96:99], v[52:55], v[156:159], v[96:99]
  v_pk_mul_f16 v33, v33, v32 neg_lo:[1,0] neg_hi:[1,0]
  v_exp_f16_sdwa v32, v33 dst_sel:WORD_0 dst_unused:UNUSED_PAD src0_sel:WORD_0
  v_mfma_f32_16x16x32_bf16 v[100:103], v[52:55], v[160:163], v[100:103]
  v_exp_f16_sdwa v32, v33 dst_sel:WORD_1 dst_unused:UNUSED_PRESERVE src0_sel:WORD_1
  buffer_load_dwordx4 v[48:51], v23, s[16:19], s55 offen offset:128 nt
  v_mfma_f32_16x16x32_bf16 v[92:95], v[56:59], v[164:167], v[92:95]
  ds_read_b128 v[52:55], v16 offset:38912
  v_pk_fma_f16 v32, v32, s93, s93
  v_rcp_f16_sdwa v33, v32 dst_sel:WORD_0 dst_unused:UNUSED_PAD src0_sel:WORD_0
  v_mfma_f32_16x16x32_bf16 v[96:99], v[56:59], v[168:171], v[96:99]
  v_rcp_f16_sdwa v33, v32 dst_sel:WORD_1 dst_unused:UNUSED_PRESERVE src0_sel:WORD_1
  v_mfma_f32_16x16x32_bf16 v[100:103], v[56:59], v[172:175], v[100:103]
  v_fma_mix_f32 v32, v88, v33, 0 op_sel_hi:[0,1,0]
  v_fma_mix_f32 v33, v89, v33, 0 op_sel:[0,1,0] op_sel_hi:[0,1,0]
  v_cvt_pk_bf16_f32 v36, v32, v33
  s_waitcnt lgkmcnt(1)
  v_mfma_f32_16x16x32_bf16 v[176:179], v[60:63], v[68:71], v[176:179]
  ds_read_b128 v[56:59], v16 offset:39936
  v_cvt_pk_f16_f32 v34, v90, v91
  v_pk_fma_f16 v35, v34, v34, s92
  v_mfma_f32_16x16x32_bf16 v[184:187], v[60:63], v[72:75], v[184:187]
  v_pk_mul_f16 v35, v35, v34 neg_lo:[1,0] neg_hi:[1,0]
  v_exp_f16_sdwa v34, v35 dst_sel:WORD_0 dst_unused:UNUSED_PAD src0_sel:WORD_0
  v_mfma_f32_16x16x32_bf16 v[192:195], v[60:63], v[76:79], v[192:195]
  v_exp_f16_sdwa v34, v35 dst_sel:WORD_1 dst_unused:UNUSED_PRESERVE src0_sel:WORD_1
  s_setprio 1
  v_mfma_f32_16x16x32_bf16 v[180:183], v[64:67], v[68:71], v[180:183]
  ds_read_b128 v[60:63], v16 offset:40960
  v_pk_fma_f16 v34, v34, s93, s93
  v_rcp_f16_sdwa v35, v34 dst_sel:WORD_0 dst_unused:UNUSED_PAD src0_sel:WORD_0
  v_mfma_f32_16x16x32_bf16 v[188:191], v[64:67], v[72:75], v[188:191]
  v_rcp_f16_sdwa v35, v34 dst_sel:WORD_1 dst_unused:UNUSED_PRESERVE src0_sel:WORD_1
  v_mfma_f32_16x16x32_bf16 v[196:199], v[64:67], v[76:79], v[196:199]
  v_fma_mix_f32 v34, v90, v35, 0 op_sel_hi:[0,1,0]
  v_fma_mix_f32 v35, v91, v35, 0 op_sel:[0,1,0] op_sel_hi:[0,1,0]
  v_cvt_pk_bf16_f32 v37, v34, v35
  ds_write_b64 v19, v[36:37] offset:2048
  s_setprio 0
  s_waitcnt lgkmcnt(2)
  v_mfma_f32_16x16x32_bf16 v[200:203], v[52:55], v[68:71], v[200:203]
  ds_read_b128 v[64:67], v16 offset:41984
  v_cvt_pk_f16_f32 v32, v92, v93
  v_pk_fma_f16 v33, v32, v32, s92
  v_mfma_f32_16x16x32_bf16 v[208:211], v[52:55], v[72:75], v[208:211]
  v_pk_mul_f16 v33, v33, v32 neg_lo:[1,0] neg_hi:[1,0]
  v_exp_f16_sdwa v32, v33 dst_sel:WORD_0 dst_unused:UNUSED_PAD src0_sel:WORD_0
  v_mfma_f32_16x16x32_bf16 v[216:219], v[52:55], v[76:79], v[216:219]
  v_exp_f16_sdwa v32, v33 dst_sel:WORD_1 dst_unused:UNUSED_PRESERVE src0_sel:WORD_1
  v_mfma_f32_16x16x32_bf16 v[204:207], v[56:59], v[68:71], v[204:207]
  s_waitcnt vmcnt(6)
  s_waitcnt lgkmcnt(0)
  s_barrier
  s_setprio 3
  ds_read_b128 v[52:55], v17 offset:0
  v_pk_fma_f16 v32, v32, s93, s93
  v_rcp_f16_sdwa v33, v32 dst_sel:WORD_0 dst_unused:UNUSED_PAD src0_sel:WORD_0
  v_mfma_f32_16x16x32_bf16 v[212:215], v[56:59], v[72:75], v[212:215]
  v_rcp_f16_sdwa v33, v32 dst_sel:WORD_1 dst_unused:UNUSED_PRESERVE src0_sel:WORD_1
  v_mfma_f32_16x16x32_bf16 v[220:223], v[56:59], v[76:79], v[220:223]
  v_fma_mix_f32 v32, v92, v33, 0 op_sel_hi:[0,1,0]
  v_fma_mix_f32 v33, v93, v33, 0 op_sel:[0,1,0] op_sel_hi:[0,1,0]
  v_cvt_pk_bf16_f32 v36, v32, v33
  v_mfma_f32_16x16x32_bf16 v[224:227], v[60:63], v[68:71], v[224:227]
  ds_read_b128 v[56:59], v17 offset:1024
  v_cvt_pk_f16_f32 v34, v94, v95
  v_pk_fma_f16 v35, v34, v34, s92
  v_mfma_f32_16x16x32_bf16 v[232:235], v[60:63], v[72:75], v[232:235]
  v_pk_mul_f16 v35, v35, v34 neg_lo:[1,0] neg_hi:[1,0]
  v_exp_f16_sdwa v34, v35 dst_sel:WORD_0 dst_unused:UNUSED_PAD src0_sel:WORD_0
  v_mfma_f32_16x16x32_bf16 v[240:243], v[60:63], v[76:79], v[240:243]
  v_exp_f16_sdwa v34, v35 dst_sel:WORD_1 dst_unused:UNUSED_PRESERVE src0_sel:WORD_1
  s_add_u32 m0, s57, 24576
  s_mov_b32 s94, 319488
  buffer_load_dwordx4 v20, s[8:11], s94 offen offset:0 lds
  v_mfma_f32_16x16x32_bf16 v[228:231], v[64:67], v[68:71], v[228:231]
  ds_read_b128 v[60:63], v17 offset:2048
  v_pk_fma_f16 v34, v34, s93, s93
  v_rcp_f16_sdwa v35, v34 dst_sel:WORD_0 dst_unused:UNUSED_PAD src0_sel:WORD_0
  v_mfma_f32_16x16x32_bf16 v[236:239], v[64:67], v[72:75], v[236:239]
  v_rcp_f16_sdwa v35, v34 dst_sel:WORD_1 dst_unused:UNUSED_PRESERVE src0_sel:WORD_1
  v_mfma_f32_16x16x32_bf16 v[244:247], v[64:67], v[76:79], v[244:247]
  v_fma_mix_f32 v34, v94, v35, 0 op_sel_hi:[0,1,0]
  v_fma_mix_f32 v35, v95, v35, 0 op_sel:[0,1,0] op_sel_hi:[0,1,0]
  v_cvt_pk_bf16_f32 v37, v34, v35
  ds_write_b64 v19, v[36:37] offset:12288
  s_waitcnt lgkmcnt(2)
  v_mfma_f32_16x16x32_bf16 v[80:83], v[52:55], v[104:107], 0
  ds_read_b128 v[64:67], v17 offset:3072
  ds_read_b128 v[68:71], v18 offset:0
  v_cvt_pk_f16_f32 v32, v96, v97
  v_pk_fma_f16 v33, v32, v32, s92
  v_mfma_f32_16x16x32_bf16 v[84:87], v[52:55], v[108:111], 0
  v_pk_mul_f16 v33, v33, v32 neg_lo:[1,0] neg_hi:[1,0]
  v_exp_f16_sdwa v32, v33 dst_sel:WORD_0 dst_unused:UNUSED_PAD src0_sel:WORD_0
  v_mfma_f32_16x16x32_bf16 v[88:91], v[52:55], v[112:115], 0
  v_exp_f16_sdwa v32, v33 dst_sel:WORD_1 dst_unused:UNUSED_PRESERVE src0_sel:WORD_1
  buffer_load_dwordx4 v20, s[8:11], s94 offen offset:1024 lds
  v_mfma_f32_16x16x32_bf16 v[80:83], v[56:59], v[116:119], v[80:83]
  ds_read_b128 v[52:55], v17 offset:4096
  ds_read_b128 v[72:75], v18 offset:1024
  v_pk_fma_f16 v32, v32, s93, s93
  v_rcp_f16_sdwa v33, v32 dst_sel:WORD_0 dst_unused:UNUSED_PAD src0_sel:WORD_0
  v_mfma_f32_16x16x32_bf16 v[84:87], v[56:59], v[120:123], v[84:87]
  v_rcp_f16_sdwa v33, v32 dst_sel:WORD_1 dst_unused:UNUSED_PRESERVE src0_sel:WORD_1
  v_mfma_f32_16x16x32_bf16 v[88:91], v[56:59], v[124:127], v[88:91]
  v_fma_mix_f32 v32, v96, v33, 0 op_sel_hi:[0,1,0]
  v_fma_mix_f32 v33, v97, v33, 0 op_sel:[0,1,0] op_sel_hi:[0,1,0]
  v_cvt_pk_bf16_f32 v38, v32, v33
  s_waitcnt lgkmcnt(3)
  v_mfma_f32_16x16x32_bf16 v[80:83], v[60:63], v[128:131], v[80:83]
  ds_read_b128 v[56:59], v17 offset:5120
  ds_read_b128 v[76:79], v18 offset:2048
  v_cvt_pk_f16_f32 v34, v98, v99
  v_pk_fma_f16 v35, v34, v34, s92
  v_mfma_f32_16x16x32_bf16 v[84:87], v[60:63], v[132:135], v[84:87]
  v_pk_mul_f16 v35, v35, v34 neg_lo:[1,0] neg_hi:[1,0]
  v_exp_f16_sdwa v34, v35 dst_sel:WORD_0 dst_unused:UNUSED_PAD src0_sel:WORD_0
  v_mfma_f32_16x16x32_bf16 v[88:91], v[60:63], v[136:139], v[88:91]
  v_exp_f16_sdwa v34, v35 dst_sel:WORD_1 dst_unused:UNUSED_PRESERVE src0_sel:WORD_1
  buffer_load_dwordx4 v20, s[8:11], s94 offen offset:2048 lds
  v_mfma_f32_16x16x32_bf16 v[80:83], v[64:67], v[140:143], v[80:83]
  ds_read_b128 v[60:63], v17 offset:12288
  v_pk_fma_f16 v34, v34, s93, s93
  v_rcp_f16_sdwa v35, v34 dst_sel:WORD_0 dst_unused:UNUSED_PAD src0_sel:WORD_0
  v_mfma_f32_16x16x32_bf16 v[84:87], v[64:67], v[144:147], v[84:87]
  v_rcp_f16_sdwa v35, v34 dst_sel:WORD_1 dst_unused:UNUSED_PRESERVE src0_sel:WORD_1
  v_mfma_f32_16x16x32_bf16 v[88:91], v[64:67], v[148:151], v[88:91]
  v_fma_mix_f32 v34, v98, v35, 0 op_sel_hi:[0,1,0]
  v_fma_mix_f32 v35, v99, v35, 0 op_sel:[0,1,0] op_sel_hi:[0,1,0]
  v_cvt_pk_bf16_f32 v39, v34, v35
  ds_write_b64 v19, v[38:39] offset:13312
  v_mfma_f32_16x16x32_bf16 v[224:227], v[26:29], v[40:43], v[224:227]
  v_mfma_f32_16x16x32_bf16 v[228:231], v[24:27], v[40:43], v[228:231]
  s_setprio 2
  s_waitcnt lgkmcnt(3)
  v_mfma_f32_16x16x32_bf16 v[80:83], v[52:55], v[152:155], v[80:83]
  ds_read_b128 v[64:67], v17 offset:13312
  v_cvt_pk_f16_f32 v32, v100, v101
  v_pk_fma_f16 v33, v32, v32, s92
  v_mfma_f32_16x16x32_bf16 v[84:87], v[52:55], v[156:159], v[84:87]
  v_pk_mul_f16 v33, v33, v32 neg_lo:[1,0] neg_hi:[1,0]
  v_exp_f16_sdwa v32, v33 dst_sel:WORD_0 dst_unused:UNUSED_PAD src0_sel:WORD_0
  v_mfma_f32_16x16x32_bf16 v[88:91], v[52:55], v[160:163], v[88:91]
  v_exp_f16_sdwa v32, v33 dst_sel:WORD_1 dst_unused:UNUSED_PRESERVE src0_sel:WORD_1
  v_mfma_f32_16x16x32_bf16 v[80:83], v[56:59], v[164:167], v[80:83]
  ds_read_b128 v[52:55], v17 offset:14336
  v_pk_fma_f16 v32, v32, s93, s93
  v_rcp_f16_sdwa v33, v32 dst_sel:WORD_0 dst_unused:UNUSED_PAD src0_sel:WORD_0
  v_mfma_f32_16x16x32_bf16 v[84:87], v[56:59], v[168:171], v[84:87]
  v_rcp_f16_sdwa v33, v32 dst_sel:WORD_1 dst_unused:UNUSED_PRESERVE src0_sel:WORD_1
  v_mfma_f32_16x16x32_bf16 v[88:91], v[56:59], v[172:175], v[88:91]
  v_fma_mix_f32 v32, v100, v33, 0 op_sel_hi:[0,1,0]
  v_fma_mix_f32 v33, v101, v33, 0 op_sel:[0,1,0] op_sel_hi:[0,1,0]
  v_cvt_pk_bf16_f32 v36, v32, v33
  s_waitcnt lgkmcnt(1)
  v_mfma_f32_16x16x32_bf16 v[176:179], v[60:63], v[68:71], v[176:179]
  ds_read_b128 v[56:59], v17 offset:15360
  v_cvt_pk_f16_f32 v34, v102, v103
  v_pk_fma_f16 v35, v34, v34, s92
  v_mfma_f32_16x16x32_bf16 v[184:187], v[60:63], v[72:75], v[184:187]
  v_pk_mul_f16 v35, v35, v34 neg_lo:[1,0] neg_hi:[1,0]
  v_exp_f16_sdwa v34, v35 dst_sel:WORD_0 dst_unused:UNUSED_PAD src0_sel:WORD_0
  v_mfma_f32_16x16x32_bf16 v[192:195], v[60:63], v[76:79], v[192:195]
  v_exp_f16_sdwa v34, v35 dst_sel:WORD_1 dst_unused:UNUSED_PRESERVE src0_sel:WORD_1
  s_setprio 1
  v_mfma_f32_16x16x32_bf16 v[180:183], v[64:67], v[68:71], v[180:183]
  ds_read_b128 v[60:63], v17 offset:16384
  v_pk_fma_f16 v34, v34, s93, s93
  v_rcp_f16_sdwa v35, v34 dst_sel:WORD_0 dst_unused:UNUSED_PAD src0_sel:WORD_0
  v_mfma_f32_16x16x32_bf16 v[188:191], v[64:67], v[72:75], v[188:191]
  v_rcp_f16_sdwa v35, v34 dst_sel:WORD_1 dst_unused:UNUSED_PRESERVE src0_sel:WORD_1
  v_mfma_f32_16x16x32_bf16 v[196:199], v[64:67], v[76:79], v[196:199]
  v_fma_mix_f32 v34, v102, v35, 0 op_sel_hi:[0,1,0]
  v_fma_mix_f32 v35, v103, v35, 0 op_sel:[0,1,0] op_sel_hi:[0,1,0]
  v_cvt_pk_bf16_f32 v37, v34, v35
  ds_write_b64 v19, v[36:37] offset:14336
  s_setprio 0
  s_waitcnt lgkmcnt(2)
  v_mfma_f32_16x16x32_bf16 v[200:203], v[52:55], v[68:71], v[200:203]
  ds_read_b128 v[64:67], v17 offset:17408
  v_cvt_pk_f16_f32 v32, v80, v81
  v_pk_fma_f16 v33, v32, v32, s92
  v_mfma_f32_16x16x32_bf16 v[208:211], v[52:55], v[72:75], v[208:211]
  v_pk_mul_f16 v33, v33, v32 neg_lo:[1,0] neg_hi:[1,0]
  v_exp_f16_sdwa v32, v33 dst_sel:WORD_0 dst_unused:UNUSED_PAD src0_sel:WORD_0
  v_mfma_f32_16x16x32_bf16 v[216:219], v[52:55], v[76:79], v[216:219]
  v_exp_f16_sdwa v32, v33 dst_sel:WORD_1 dst_unused:UNUSED_PRESERVE src0_sel:WORD_1
  v_mfma_f32_16x16x32_bf16 v[204:207], v[56:59], v[68:71], v[204:207]
  s_waitcnt vmcnt(4)
  s_waitcnt lgkmcnt(0)
  s_barrier
  s_setprio 3
  ds_read_b128 v[52:55], v16 offset:0
  v_pk_fma_f16 v32, v32, s93, s93
  v_rcp_f16_sdwa v33, v32 dst_sel:WORD_0 dst_unused:UNUSED_PAD src0_sel:WORD_0
  v_mfma_f32_16x16x32_bf16 v[212:215], v[56:59], v[72:75], v[212:215]
  v_rcp_f16_sdwa v33, v32 dst_sel:WORD_1 dst_unused:UNUSED_PRESERVE src0_sel:WORD_1
  v_mfma_f32_16x16x32_bf16 v[220:223], v[56:59], v[76:79], v[220:223]
  v_fma_mix_f32 v32, v80, v33, 0 op_sel_hi:[0,1,0]
  v_fma_mix_f32 v33, v81, v33, 0 op_sel:[0,1,0] op_sel_hi:[0,1,0]
  v_cvt_pk_bf16_f32 v36, v32, v33
  v_mfma_f32_16x16x32_bf16 v[224:227], v[60:63], v[68:71], v[224:227]
  ds_read_b128 v[56:59], v16 offset:1024
  v_cvt_pk_f16_f32 v34, v82, v83
  v_pk_fma_f16 v35, v34, v34, s92
  v_mfma_f32_16x16x32_bf16 v[232:235], v[60:63], v[72:75], v[232:235]
  v_pk_mul_f16 v35, v35, v34 neg_lo:[1,0] neg_hi:[1,0]
  v_exp_f16_sdwa v34, v35 dst_sel:WORD_0 dst_unused:UNUSED_PAD src0_sel:WORD_0
  v_mfma_f32_16x16x32_bf16 v[240:243], v[60:63], v[76:79], v[240:243]
  v_exp_f16_sdwa v34, v35 dst_sel:WORD_1 dst_unused:UNUSED_PRESERVE src0_sel:WORD_1
  s_add_u32 m0, s57, 49152
  s_mov_b32 s94, 344064
  buffer_load_dwordx4 v20, s[8:11], s94 offen offset:0 lds
  v_mfma_f32_16x16x32_bf16 v[228:231], v[64:67], v[68:71], v[228:231]
  ds_read_b128 v[60:63], v16 offset:2048
  v_pk_fma_f16 v34, v34, s93, s93
  v_rcp_f16_sdwa v35, v34 dst_sel:WORD_0 dst_unused:UNUSED_PAD src0_sel:WORD_0
  v_mfma_f32_16x16x32_bf16 v[236:239], v[64:67], v[72:75], v[236:239]
  v_rcp_f16_sdwa v35, v34 dst_sel:WORD_1 dst_unused:UNUSED_PRESERVE src0_sel:WORD_1
  v_mfma_f32_16x16x32_bf16 v[244:247], v[64:67], v[76:79], v[244:247]
  v_fma_mix_f32 v34, v82, v35, 0 op_sel_hi:[0,1,0]
  v_fma_mix_f32 v35, v83, v35, 0 op_sel:[0,1,0] op_sel_hi:[0,1,0]
  v_cvt_pk_bf16_f32 v37, v34, v35
  ds_write_b64 v19, v[36:37] offset:0
  s_waitcnt lgkmcnt(2)
  v_mfma_f32_16x16x32_bf16 v[92:95], v[52:55], v[104:107], 0
  ds_read_b128 v[64:67], v16 offset:3072
  ds_read_b128 v[68:71], v18 offset:12288
  v_cvt_pk_f16_f32 v32, v84, v85
  v_pk_fma_f16 v33, v32, v32, s92
  v_mfma_f32_16x16x32_bf16 v[96:99], v[52:55], v[108:111], 0
  v_pk_mul_f16 v33, v33, v32 neg_lo:[1,0] neg_hi:[1,0]
  v_exp_f16_sdwa v32, v33 dst_sel:WORD_0 dst_unused:UNUSED_PAD src0_sel:WORD_0
  v_mfma_f32_16x16x32_bf16 v[100:103], v[52:55], v[112:115], 0
  v_exp_f16_sdwa v32, v33 dst_sel:WORD_1 dst_unused:UNUSED_PRESERVE src0_sel:WORD_1
  buffer_load_dwordx4 v20, s[8:11], s94 offen offset:1024 lds
  v_mfma_f32_16x16x32_bf16 v[92:95], v[56:59], v[116:119], v[92:95]
  ds_read_b128 v[52:55], v16 offset:4096
  ds_read_b128 v[72:75], v18 offset:13312
  v_pk_fma_f16 v32, v32, s93, s93
  v_rcp_f16_sdwa v33, v32 dst_sel:WORD_0 dst_unused:UNUSED_PAD src0_sel:WORD_0
  v_mfma_f32_16x16x32_bf16 v[96:99], v[56:59], v[120:123], v[96:99]
  v_rcp_f16_sdwa v33, v32 dst_sel:WORD_1 dst_unused:UNUSED_PRESERVE src0_sel:WORD_1
  v_mfma_f32_16x16x32_bf16 v[100:103], v[56:59], v[124:127], v[100:103]
  v_fma_mix_f32 v32, v84, v33, 0 op_sel_hi:[0,1,0]
  v_fma_mix_f32 v33, v85, v33, 0 op_sel:[0,1,0] op_sel_hi:[0,1,0]
  v_cvt_pk_bf16_f32 v38, v32, v33
  s_waitcnt lgkmcnt(3)
  v_mfma_f32_16x16x32_bf16 v[92:95], v[60:63], v[128:131], v[92:95]
  ds_read_b128 v[56:59], v16 offset:5120
  ds_read_b128 v[76:79], v18 offset:14336
  v_cvt_pk_f16_f32 v34, v86, v87
  v_pk_fma_f16 v35, v34, v34, s92
  v_mfma_f32_16x16x32_bf16 v[96:99], v[60:63], v[132:135], v[96:99]
  v_pk_mul_f16 v35, v35, v34 neg_lo:[1,0] neg_hi:[1,0]
  v_exp_f16_sdwa v34, v35 dst_sel:WORD_0 dst_unused:UNUSED_PAD src0_sel:WORD_0
  v_mfma_f32_16x16x32_bf16 v[100:103], v[60:63], v[136:139], v[100:103]
  v_exp_f16_sdwa v34, v35 dst_sel:WORD_1 dst_unused:UNUSED_PRESERVE src0_sel:WORD_1
  buffer_load_dwordx4 v20, s[8:11], s94 offen offset:2048 lds
  v_mfma_f32_16x16x32_bf16 v[92:95], v[64:67], v[140:143], v[92:95]
  ds_read_b128 v[60:63], v16 offset:12288
  v_pk_fma_f16 v34, v34, s93, s93
  v_rcp_f16_sdwa v35, v34 dst_sel:WORD_0 dst_unused:UNUSED_PAD src0_sel:WORD_0
  v_mfma_f32_16x16x32_bf16 v[96:99], v[64:67], v[144:147], v[96:99]
  v_rcp_f16_sdwa v35, v34 dst_sel:WORD_1 dst_unused:UNUSED_PRESERVE src0_sel:WORD_1
  v_mfma_f32_16x16x32_bf16 v[100:103], v[64:67], v[148:151], v[100:103]
  v_fma_mix_f32 v34, v86, v35, 0 op_sel_hi:[0,1,0]
  v_fma_mix_f32 v35, v87, v35, 0 op_sel:[0,1,0] op_sel_hi:[0,1,0]
  v_cvt_pk_bf16_f32 v39, v34, v35
  ds_write_b64 v19, v[38:39] offset:1024
  v_mfma_f32_16x16x32_bf16 v[232:235], v[26:29], v[44:47], v[232:235]
  v_mfma_f32_16x16x32_bf16 v[236:239], v[24:27], v[44:47], v[236:239]
  s_setprio 2
  s_waitcnt lgkmcnt(3)
  v_mfma_f32_16x16x32_bf16 v[92:95], v[52:55], v[152:155], v[92:95]
  ds_read_b128 v[64:67], v16 offset:13312
  v_cvt_pk_f16_f32 v32, v88, v89
  v_pk_fma_f16 v33, v32, v32, s92
  v_mfma_f32_16x16x32_bf16 v[96:99], v[52:55], v[156:159], v[96:99]
  v_pk_mul_f16 v33, v33, v32 neg_lo:[1,0] neg_hi:[1,0]
  v_exp_f16_sdwa v32, v33 dst_sel:WORD_0 dst_unused:UNUSED_PAD src0_sel:WORD_0
  v_mfma_f32_16x16x32_bf16 v[100:103], v[52:55], v[160:163], v[100:103]
  v_exp_f16_sdwa v32, v33 dst_sel:WORD_1 dst_unused:UNUSED_PRESERVE src0_sel:WORD_1
  v_mfma_f32_16x16x32_bf16 v[92:95], v[56:59], v[164:167], v[92:95]
  ds_read_b128 v[52:55], v16 offset:14336
  v_pk_fma_f16 v32, v32, s93, s93
  v_rcp_f16_sdwa v33, v32 dst_sel:WORD_0 dst_unused:UNUSED_PAD src0_sel:WORD_0
  v_mfma_f32_16x16x32_bf16 v[96:99], v[56:59], v[168:171], v[96:99]
  v_rcp_f16_sdwa v33, v32 dst_sel:WORD_1 dst_unused:UNUSED_PRESERVE src0_sel:WORD_1
  v_mfma_f32_16x16x32_bf16 v[100:103], v[56:59], v[172:175], v[100:103]
  v_fma_mix_f32 v32, v88, v33, 0 op_sel_hi:[0,1,0]
  v_fma_mix_f32 v33, v89, v33, 0 op_sel:[0,1,0] op_sel_hi:[0,1,0]
  v_cvt_pk_bf16_f32 v36, v32, v33
  s_waitcnt lgkmcnt(1)
  v_mfma_f32_16x16x32_bf16 v[176:179], v[60:63], v[68:71], v[176:179]
  ds_read_b128 v[56:59], v16 offset:15360
  v_cvt_pk_f16_f32 v34, v90, v91
  v_pk_fma_f16 v35, v34, v34, s92
  v_mfma_f32_16x16x32_bf16 v[184:187], v[60:63], v[72:75], v[184:187]
  v_pk_mul_f16 v35, v35, v34 neg_lo:[1,0] neg_hi:[1,0]
  v_exp_f16_sdwa v34, v35 dst_sel:WORD_0 dst_unused:UNUSED_PAD src0_sel:WORD_0
  v_mfma_f32_16x16x32_bf16 v[192:195], v[60:63], v[76:79], v[192:195]
  v_exp_f16_sdwa v34, v35 dst_sel:WORD_1 dst_unused:UNUSED_PRESERVE src0_sel:WORD_1
  s_setprio 1
  v_mfma_f32_16x16x32_bf16 v[180:183], v[64:67], v[68:71], v[180:183]
  ds_read_b128 v[60:63], v16 offset:16384
  v_pk_fma_f16 v34, v34, s93, s93
  v_rcp_f16_sdwa v35, v34 dst_sel:WORD_0 dst_unused:UNUSED_PAD src0_sel:WORD_0
  v_mfma_f32_16x16x32_bf16 v[188:191], v[64:67], v[72:75], v[188:191]
  v_rcp_f16_sdwa v35, v34 dst_sel:WORD_1 dst_unused:UNUSED_PRESERVE src0_sel:WORD_1
  v_mfma_f32_16x16x32_bf16 v[196:199], v[64:67], v[76:79], v[196:199]
  v_fma_mix_f32 v34, v90, v35, 0 op_sel_hi:[0,1,0]
  v_fma_mix_f32 v35, v91, v35, 0 op_sel:[0,1,0] op_sel_hi:[0,1,0]
  v_cvt_pk_bf16_f32 v37, v34, v35
  ds_write_b64 v19, v[36:37] offset:2048
  s_setprio 0
  s_waitcnt lgkmcnt(2)
  v_mfma_f32_16x16x32_bf16 v[200:203], v[52:55], v[68:71], v[200:203]
  ds_read_b128 v[64:67], v16 offset:17408
  v_cvt_pk_f16_f32 v32, v92, v93
  v_pk_fma_f16 v33, v32, v32, s92
  v_mfma_f32_16x16x32_bf16 v[208:211], v[52:55], v[72:75], v[208:211]
  v_pk_mul_f16 v33, v33, v32 neg_lo:[1,0] neg_hi:[1,0]
  v_exp_f16_sdwa v32, v33 dst_sel:WORD_0 dst_unused:UNUSED_PAD src0_sel:WORD_0
  v_mfma_f32_16x16x32_bf16 v[216:219], v[52:55], v[76:79], v[216:219]
  v_exp_f16_sdwa v32, v33 dst_sel:WORD_1 dst_unused:UNUSED_PRESERVE src0_sel:WORD_1
  v_mfma_f32_16x16x32_bf16 v[204:207], v[56:59], v[68:71], v[204:207]
  s_waitcnt vmcnt(3)
  s_waitcnt lgkmcnt(0)
  s_barrier
  s_setprio 3
  ds_read_b128 v[52:55], v16 offset:24576
  v_pk_fma_f16 v32, v32, s93, s93
  v_rcp_f16_sdwa v33, v32 dst_sel:WORD_0 dst_unused:UNUSED_PAD src0_sel:WORD_0
  v_mfma_f32_16x16x32_bf16 v[212:215], v[56:59], v[72:75], v[212:215]
  v_rcp_f16_sdwa v33, v32 dst_sel:WORD_1 dst_unused:UNUSED_PRESERVE src0_sel:WORD_1
  v_mfma_f32_16x16x32_bf16 v[220:223], v[56:59], v[76:79], v[220:223]
  v_fma_mix_f32 v32, v92, v33, 0 op_sel_hi:[0,1,0]
  v_fma_mix_f32 v33, v93, v33, 0 op_sel:[0,1,0] op_sel_hi:[0,1,0]
  v_cvt_pk_bf16_f32 v36, v32, v33
  v_mfma_f32_16x16x32_bf16 v[224:227], v[60:63], v[68:71], v[224:227]
  ds_read_b128 v[56:59], v16 offset:25600
  v_cvt_pk_f16_f32 v34, v94, v95
  v_pk_fma_f16 v35, v34, v34, s92
  v_mfma_f32_16x16x32_bf16 v[232:235], v[60:63], v[72:75], v[232:235]
  v_pk_mul_f16 v35, v35, v34 neg_lo:[1,0] neg_hi:[1,0]
  v_exp_f16_sdwa v34, v35 dst_sel:WORD_0 dst_unused:UNUSED_PAD src0_sel:WORD_0
  v_mfma_f32_16x16x32_bf16 v[240:243], v[60:63], v[76:79], v[240:243]
  v_exp_f16_sdwa v34, v35 dst_sel:WORD_1 dst_unused:UNUSED_PRESERVE src0_sel:WORD_1
  s_add_u32 m0, s57, 0
  s_mov_b32 s94, 368640
  buffer_load_dwordx4 v20, s[8:11], s94 offen offset:0 lds
  v_mfma_f32_16x16x32_bf16 v[228:231], v[64:67], v[68:71], v[228:231]
  ds_read_b128 v[60:63], v16 offset:26624
  v_pk_fma_f16 v34, v34, s93, s93
  v_rcp_f16_sdwa v35, v34 dst_sel:WORD_0 dst_unused:UNUSED_PAD src0_sel:WORD_0
  v_mfma_f32_16x16x32_bf16 v[236:239], v[64:67], v[72:75], v[236:239]
  v_rcp_f16_sdwa v35, v34 dst_sel:WORD_1 dst_unused:UNUSED_PRESERVE src0_sel:WORD_1
  v_mfma_f32_16x16x32_bf16 v[244:247], v[64:67], v[76:79], v[244:247]
  v_fma_mix_f32 v34, v94, v35, 0 op_sel_hi:[0,1,0]
  v_fma_mix_f32 v35, v95, v35, 0 op_sel:[0,1,0] op_sel_hi:[0,1,0]
  v_cvt_pk_bf16_f32 v37, v34, v35
  ds_write_b64 v19, v[36:37] offset:12288
  s_waitcnt lgkmcnt(2)
  v_mfma_f32_16x16x32_bf16 v[80:83], v[52:55], v[104:107], 0
  ds_read_b128 v[64:67], v16 offset:27648
  ds_read_b128 v[68:71], v18 offset:0
  v_cvt_pk_f16_f32 v32, v96, v97
  v_pk_fma_f16 v33, v32, v32, s92
  v_mfma_f32_16x16x32_bf16 v[84:87], v[52:55], v[108:111], 0
  v_pk_mul_f16 v33, v33, v32 neg_lo:[1,0] neg_hi:[1,0]
  v_exp_f16_sdwa v32, v33 dst_sel:WORD_0 dst_unused:UNUSED_PAD src0_sel:WORD_0
  v_mfma_f32_16x16x32_bf16 v[88:91], v[52:55], v[112:115], 0
  v_exp_f16_sdwa v32, v33 dst_sel:WORD_1 dst_unused:UNUSED_PRESERVE src0_sel:WORD_1
  buffer_load_dwordx4 v20, s[8:11], s94 offen offset:1024 lds
  v_mfma_f32_16x16x32_bf16 v[80:83], v[56:59], v[116:119], v[80:83]
  ds_read_b128 v[52:55], v16 offset:28672
  ds_read_b128 v[72:75], v18 offset:1024
  v_pk_fma_f16 v32, v32, s93, s93
  v_rcp_f16_sdwa v33, v32 dst_sel:WORD_0 dst_unused:UNUSED_PAD src0_sel:WORD_0
  v_mfma_f32_16x16x32_bf16 v[84:87], v[56:59], v[120:123], v[84:87]
  v_rcp_f16_sdwa v33, v32 dst_sel:WORD_1 dst_unused:UNUSED_PRESERVE src0_sel:WORD_1
  v_mfma_f32_16x16x32_bf16 v[88:91], v[56:59], v[124:127], v[88:91]
  v_fma_mix_f32 v32, v96, v33, 0 op_sel_hi:[0,1,0]
  v_fma_mix_f32 v33, v97, v33, 0 op_sel:[0,1,0] op_sel_hi:[0,1,0]
  v_cvt_pk_bf16_f32 v38, v32, v33
  s_waitcnt lgkmcnt(3)
  v_mfma_f32_16x16x32_bf16 v[80:83], v[60:63], v[128:131], v[80:83]
  ds_read_b128 v[56:59], v16 offset:29696
  ds_read_b128 v[76:79], v18 offset:2048
  v_cvt_pk_f16_f32 v34, v98, v99
  v_pk_fma_f16 v35, v34, v34, s92
  v_mfma_f32_16x16x32_bf16 v[84:87], v[60:63], v[132:135], v[84:87]
  v_pk_mul_f16 v35, v35, v34 neg_lo:[1,0] neg_hi:[1,0]
  v_exp_f16_sdwa v34, v35 dst_sel:WORD_0 dst_unused:UNUSED_PAD src0_sel:WORD_0
  v_mfma_f32_16x16x32_bf16 v[88:91], v[60:63], v[136:139], v[88:91]
  v_exp_f16_sdwa v34, v35 dst_sel:WORD_1 dst_unused:UNUSED_PRESERVE src0_sel:WORD_1
  buffer_load_dwordx4 v20, s[8:11], s94 offen offset:2048 lds
  v_mfma_f32_16x16x32_bf16 v[80:83], v[64:67], v[140:143], v[80:83]
  ds_read_b128 v[60:63], v16 offset:36864
  v_pk_fma_f16 v34, v34, s93, s93
  v_rcp_f16_sdwa v35, v34 dst_sel:WORD_0 dst_unused:UNUSED_PAD src0_sel:WORD_0
  v_mfma_f32_16x16x32_bf16 v[84:87], v[64:67], v[144:147], v[84:87]
  v_rcp_f16_sdwa v35, v34 dst_sel:WORD_1 dst_unused:UNUSED_PRESERVE src0_sel:WORD_1
  v_mfma_f32_16x16x32_bf16 v[88:91], v[64:67], v[148:151], v[88:91]
  v_fma_mix_f32 v34, v98, v35, 0 op_sel_hi:[0,1,0]
  v_fma_mix_f32 v35, v99, v35, 0 op_sel:[0,1,0] op_sel_hi:[0,1,0]
  v_cvt_pk_bf16_f32 v39, v34, v35
  ds_write_b64 v19, v[38:39] offset:13312
  v_mfma_f32_16x16x32_bf16 v[240:243], v[26:29], v[48:51], v[240:243]
  v_mfma_f32_16x16x32_bf16 v[244:247], v[24:27], v[48:51], v[244:247]
  s_setprio 2
  s_waitcnt lgkmcnt(3)
  v_mfma_f32_16x16x32_bf16 v[80:83], v[52:55], v[152:155], v[80:83]
  ds_read_b128 v[64:67], v16 offset:37888
  v_cvt_pk_f16_f32 v32, v100, v101
  v_pk_fma_f16 v33, v32, v32, s92
  v_mfma_f32_16x16x32_bf16 v[84:87], v[52:55], v[156:159], v[84:87]
  v_pk_mul_f16 v33, v33, v32 neg_lo:[1,0] neg_hi:[1,0]
  v_exp_f16_sdwa v32, v33 dst_sel:WORD_0 dst_unused:UNUSED_PAD src0_sel:WORD_0
  v_mfma_f32_16x16x32_bf16 v[88:91], v[52:55], v[160:163], v[88:91]
  v_exp_f16_sdwa v32, v33 dst_sel:WORD_1 dst_unused:UNUSED_PRESERVE src0_sel:WORD_1
  v_mfma_f32_16x16x32_bf16 v[80:83], v[56:59], v[164:167], v[80:83]
  ds_read_b128 v[52:55], v16 offset:38912
  v_pk_fma_f16 v32, v32, s93, s93
  v_rcp_f16_sdwa v33, v32 dst_sel:WORD_0 dst_unused:UNUSED_PAD src0_sel:WORD_0
  v_mfma_f32_16x16x32_bf16 v[84:87], v[56:59], v[168:171], v[84:87]
  v_rcp_f16_sdwa v33, v32 dst_sel:WORD_1 dst_unused:UNUSED_PRESERVE src0_sel:WORD_1
  v_mfma_f32_16x16x32_bf16 v[88:91], v[56:59], v[172:175], v[88:91]
  v_fma_mix_f32 v32, v100, v33, 0 op_sel_hi:[0,1,0]
  v_fma_mix_f32 v33, v101, v33, 0 op_sel:[0,1,0] op_sel_hi:[0,1,0]
  v_cvt_pk_bf16_f32 v36, v32, v33
  s_waitcnt lgkmcnt(1)
  v_mfma_f32_16x16x32_bf16 v[176:179], v[60:63], v[68:71], v[176:179]
  ds_read_b128 v[56:59], v16 offset:39936
  v_cvt_pk_f16_f32 v34, v102, v103
  v_pk_fma_f16 v35, v34, v34, s92
  v_mfma_f32_16x16x32_bf16 v[184:187], v[60:63], v[72:75], v[184:187]
  v_pk_mul_f16 v35, v35, v34 neg_lo:[1,0] neg_hi:[1,0]
  v_exp_f16_sdwa v34, v35 dst_sel:WORD_0 dst_unused:UNUSED_PAD src0_sel:WORD_0
  v_mfma_f32_16x16x32_bf16 v[192:195], v[60:63], v[76:79], v[192:195]
  v_exp_f16_sdwa v34, v35 dst_sel:WORD_1 dst_unused:UNUSED_PRESERVE src0_sel:WORD_1
  s_setprio 1
  v_mfma_f32_16x16x32_bf16 v[180:183], v[64:67], v[68:71], v[180:183]
  ds_read_b128 v[60:63], v16 offset:40960
  v_pk_fma_f16 v34, v34, s93, s93
  v_rcp_f16_sdwa v35, v34 dst_sel:WORD_0 dst_unused:UNUSED_PAD src0_sel:WORD_0
  v_mfma_f32_16x16x32_bf16 v[188:191], v[64:67], v[72:75], v[188:191]
  v_rcp_f16_sdwa v35, v34 dst_sel:WORD_1 dst_unused:UNUSED_PRESERVE src0_sel:WORD_1
  v_mfma_f32_16x16x32_bf16 v[196:199], v[64:67], v[76:79], v[196:199]
  v_fma_mix_f32 v34, v102, v35, 0 op_sel_hi:[0,1,0]
  v_fma_mix_f32 v35, v103, v35, 0 op_sel:[0,1,0] op_sel_hi:[0,1,0]
  v_cvt_pk_bf16_f32 v37, v34, v35
  ds_write_b64 v19, v[36:37] offset:14336
  s_setprio 0
  s_waitcnt lgkmcnt(2)
  v_mfma_f32_16x16x32_bf16 v[200:203], v[52:55], v[68:71], v[200:203]
  ds_read_b128 v[64:67], v16 offset:41984
  v_cvt_pk_f16_f32 v32, v80, v81
  v_pk_fma_f16 v33, v32, v32, s92
  v_mfma_f32_16x16x32_bf16 v[208:211], v[52:55], v[72:75], v[208:211]
  v_pk_mul_f16 v33, v33, v32 neg_lo:[1,0] neg_hi:[1,0]
  v_exp_f16_sdwa v32, v33 dst_sel:WORD_0 dst_unused:UNUSED_PAD src0_sel:WORD_0
  v_mfma_f32_16x16x32_bf16 v[216:219], v[52:55], v[76:79], v[216:219]
  v_exp_f16_sdwa v32, v33 dst_sel:WORD_1 dst_unused:UNUSED_PRESERVE src0_sel:WORD_1
  v_mfma_f32_16x16x32_bf16 v[204:207], v[56:59], v[68:71], v[204:207]
  s_waitcnt vmcnt(3)
  s_waitcnt lgkmcnt(0)
  s_barrier
  s_setprio 3
  ds_read_b128 v[52:55], v17 offset:0
  v_pk_fma_f16 v32, v32, s93, s93
  v_rcp_f16_sdwa v33, v32 dst_sel:WORD_0 dst_unused:UNUSED_PAD src0_sel:WORD_0
  v_mfma_f32_16x16x32_bf16 v[212:215], v[56:59], v[72:75], v[212:215]
  v_rcp_f16_sdwa v33, v32 dst_sel:WORD_1 dst_unused:UNUSED_PRESERVE src0_sel:WORD_1
  v_mfma_f32_16x16x32_bf16 v[220:223], v[56:59], v[76:79], v[220:223]
  v_fma_mix_f32 v32, v80, v33, 0 op_sel_hi:[0,1,0]
  v_fma_mix_f32 v33, v81, v33, 0 op_sel:[0,1,0] op_sel_hi:[0,1,0]
  v_cvt_pk_bf16_f32 v36, v32, v33
  v_mfma_f32_16x16x32_bf16 v[224:227], v[60:63], v[68:71], v[224:227]
  ds_read_b128 v[56:59], v17 offset:1024
  v_cvt_pk_f16_f32 v34, v82, v83
  v_pk_fma_f16 v35, v34, v34, s92
  v_mfma_f32_16x16x32_bf16 v[232:235], v[60:63], v[72:75], v[232:235]
  v_pk_mul_f16 v35, v35, v34 neg_lo:[1,0] neg_hi:[1,0]
  v_exp_f16_sdwa v34, v35 dst_sel:WORD_0 dst_unused:UNUSED_PAD src0_sel:WORD_0
  v_mfma_f32_16x16x32_bf16 v[240:243], v[60:63], v[76:79], v[240:243]
  v_exp_f16_sdwa v34, v35 dst_sel:WORD_1 dst_unused:UNUSED_PRESERVE src0_sel:WORD_1
  s_add_u32 m0, s57, 24576
  s_mov_b32 s94, 393216
  buffer_load_dwordx4 v20, s[8:11], s94 offen offset:0 lds
  v_mfma_f32_16x16x32_bf16 v[228:231], v[64:67], v[68:71], v[228:231]
  ds_read_b128 v[60:63], v17 offset:2048
  v_pk_fma_f16 v34, v34, s93, s93
  v_rcp_f16_sdwa v35, v34 dst_sel:WORD_0 dst_unused:UNUSED_PAD src0_sel:WORD_0
  v_mfma_f32_16x16x32_bf16 v[236:239], v[64:67], v[72:75], v[236:239]
  v_rcp_f16_sdwa v35, v34 dst_sel:WORD_1 dst_unused:UNUSED_PRESERVE src0_sel:WORD_1
  v_mfma_f32_16x16x32_bf16 v[244:247], v[64:67], v[76:79], v[244:247]
  v_fma_mix_f32 v34, v82, v35, 0 op_sel_hi:[0,1,0]
  v_fma_mix_f32 v35, v83, v35, 0 op_sel:[0,1,0] op_sel_hi:[0,1,0]
  v_cvt_pk_bf16_f32 v37, v34, v35
  ds_write_b64 v19, v[36:37] offset:0
  s_waitcnt lgkmcnt(2)
  v_mfma_f32_16x16x32_bf16 v[92:95], v[52:55], v[104:107], 0
  ds_read_b128 v[64:67], v17 offset:3072
  ds_read_b128 v[68:71], v18 offset:12288
  v_cvt_pk_f16_f32 v32, v84, v85
  v_pk_fma_f16 v33, v32, v32, s92
  v_mfma_f32_16x16x32_bf16 v[96:99], v[52:55], v[108:111], 0
  v_pk_mul_f16 v33, v33, v32 neg_lo:[1,0] neg_hi:[1,0]
  v_exp_f16_sdwa v32, v33 dst_sel:WORD_0 dst_unused:UNUSED_PAD src0_sel:WORD_0
  v_mfma_f32_16x16x32_bf16 v[100:103], v[52:55], v[112:115], 0
  v_exp_f16_sdwa v32, v33 dst_sel:WORD_1 dst_unused:UNUSED_PRESERVE src0_sel:WORD_1
  buffer_load_dwordx4 v20, s[8:11], s94 offen offset:1024 lds
  v_mfma_f32_16x16x32_bf16 v[92:95], v[56:59], v[116:119], v[92:95]
  ds_read_b128 v[52:55], v17 offset:4096
  ds_read_b128 v[72:75], v18 offset:13312
  v_pk_fma_f16 v32, v32, s93, s93
  v_rcp_f16_sdwa v33, v32 dst_sel:WORD_0 dst_unused:UNUSED_PAD src0_sel:WORD_0
  v_mfma_f32_16x16x32_bf16 v[96:99], v[56:59], v[120:123], v[96:99]
  v_rcp_f16_sdwa v33, v32 dst_sel:WORD_1 dst_unused:UNUSED_PRESERVE src0_sel:WORD_1
  v_mfma_f32_16x16x32_bf16 v[100:103], v[56:59], v[124:127], v[100:103]
  v_fma_mix_f32 v32, v84, v33, 0 op_sel_hi:[0,1,0]
  v_fma_mix_f32 v33, v85, v33, 0 op_sel:[0,1,0] op_sel_hi:[0,1,0]
  v_cvt_pk_bf16_f32 v38, v32, v33
  s_waitcnt lgkmcnt(3)
  v_mfma_f32_16x16x32_bf16 v[92:95], v[60:63], v[128:131], v[92:95]
  ds_read_b128 v[56:59], v17 offset:5120
  ds_read_b128 v[76:79], v18 offset:14336
  v_cvt_pk_f16_f32 v34, v86, v87
  v_pk_fma_f16 v35, v34, v34, s92
  v_mfma_f32_16x16x32_bf16 v[96:99], v[60:63], v[132:135], v[96:99]
  v_pk_mul_f16 v35, v35, v34 neg_lo:[1,0] neg_hi:[1,0]
  v_exp_f16_sdwa v34, v35 dst_sel:WORD_0 dst_unused:UNUSED_PAD src0_sel:WORD_0
  v_mfma_f32_16x16x32_bf16 v[100:103], v[60:63], v[136:139], v[100:103]
  v_exp_f16_sdwa v34, v35 dst_sel:WORD_1 dst_unused:UNUSED_PRESERVE src0_sel:WORD_1
  buffer_load_dwordx4 v20, s[8:11], s94 offen offset:2048 lds
  v_mfma_f32_16x16x32_bf16 v[92:95], v[64:67], v[140:143], v[92:95]
  ds_read_b128 v[60:63], v17 offset:12288
  v_pk_fma_f16 v34, v34, s93, s93
  v_rcp_f16_sdwa v35, v34 dst_sel:WORD_0 dst_unused:UNUSED_PAD src0_sel:WORD_0
  v_mfma_f32_16x16x32_bf16 v[96:99], v[64:67], v[144:147], v[96:99]
  v_rcp_f16_sdwa v35, v34 dst_sel:WORD_1 dst_unused:UNUSED_PRESERVE src0_sel:WORD_1
  v_mfma_f32_16x16x32_bf16 v[100:103], v[64:67], v[148:151], v[100:103]
  v_fma_mix_f32 v34, v86, v35, 0 op_sel_hi:[0,1,0]
  v_fma_mix_f32 v35, v87, v35, 0 op_sel:[0,1,0] op_sel_hi:[0,1,0]
  v_cvt_pk_bf16_f32 v39, v34, v35
  ds_write_b64 v19, v[38:39] offset:1024
  s_sub_u32 s31, s32, 3
  s_mul_i32 s31, s31, 384
  s_add_u32 s31, s31, s45
  s_sub_u32 s31, s31, 3
  s_mul_i32 s31, s31, 384
  s_add_u32 s31, s31, 128
  v_add_u32 v30, s31, v0
  buffer_load_dword v248, v30, s[4:7], 0 offen
  s_setprio 2
  s_waitcnt lgkmcnt(3)
  v_mfma_f32_16x16x32_bf16 v[92:95], v[52:55], v[152:155], v[92:95]
  ds_read_b128 v[64:67], v17 offset:13312
  v_cvt_pk_f16_f32 v32, v88, v89
  v_pk_fma_f16 v33, v32, v32, s92
  v_mfma_f32_16x16x32_bf16 v[96:99], v[52:55], v[156:159], v[96:99]
  v_pk_mul_f16 v33, v33, v32 neg_lo:[1,0] neg_hi:[1,0]
  v_exp_f16_sdwa v32, v33 dst_sel:WORD_0 dst_unused:UNUSED_PAD src0_sel:WORD_0
  v_mfma_f32_16x16x32_bf16 v[100:103], v[52:55], v[160:163], v[100:103]
  v_exp_f16_sdwa v32, v33 dst_sel:WORD_1 dst_unused:UNUSED_PRESERVE src0_sel:WORD_1
  v_mfma_f32_16x16x32_bf16 v[92:95], v[56:59], v[164:167], v[92:95]
  ds_read_b128 v[52:55], v17 offset:14336
  v_pk_fma_f16 v32, v32, s93, s93
  v_rcp_f16_sdwa v33, v32 dst_sel:WORD_0 dst_unused:UNUSED_PAD src0_sel:WORD_0
  v_mfma_f32_16x16x32_bf16 v[96:99], v[56:59], v[168:171], v[96:99]
  v_rcp_f16_sdwa v33, v32 dst_sel:WORD_1 dst_unused:UNUSED_PRESERVE src0_sel:WORD_1
  v_mfma_f32_16x16x32_bf16 v[100:103], v[56:59], v[172:175], v[100:103]
  v_fma_mix_f32 v32, v88, v33, 0 op_sel_hi:[0,1,0]
  v_fma_mix_f32 v33, v89, v33, 0 op_sel:[0,1,0] op_sel_hi:[0,1,0]
  v_cvt_pk_bf16_f32 v36, v32, v33
  s_waitcnt lgkmcnt(1)
  v_mfma_f32_16x16x32_bf16 v[176:179], v[60:63], v[68:71], v[176:179]
  ds_read_b128 v[56:59], v17 offset:15360
  v_cvt_pk_f16_f32 v34, v90, v91
  v_pk_fma_f16 v35, v34, v34, s92
  v_mfma_f32_16x16x32_bf16 v[184:187], v[60:63], v[72:75], v[184:187]
  v_pk_mul_f16 v35, v35, v34 neg_lo:[1,0] neg_hi:[1,0]
  v_exp_f16_sdwa v34, v35 dst_sel:WORD_0 dst_unused:UNUSED_PAD src0_sel:WORD_0
  v_mfma_f32_16x16x32_bf16 v[192:195], v[60:63], v[76:79], v[192:195]
  v_exp_f16_sdwa v34, v35 dst_sel:WORD_1 dst_unused:UNUSED_PRESERVE src0_sel:WORD_1
  s_setprio 1
  v_mfma_f32_16x16x32_bf16 v[180:183], v[64:67], v[68:71], v[180:183]
  ds_read_b128 v[60:63], v17 offset:16384
  v_pk_fma_f16 v34, v34, s93, s93
  v_rcp_f16_sdwa v35, v34 dst_sel:WORD_0 dst_unused:UNUSED_PAD src0_sel:WORD_0
  v_mfma_f32_16x16x32_bf16 v[188:191], v[64:67], v[72:75], v[188:191]
  v_rcp_f16_sdwa v35, v34 dst_sel:WORD_1 dst_unused:UNUSED_PRESERVE src0_sel:WORD_1
  v_mfma_f32_16x16x32_bf16 v[196:199], v[64:67], v[76:79], v[196:199]
  v_fma_mix_f32 v34, v90, v35, 0 op_sel_hi:[0,1,0]
  v_fma_mix_f32 v35, v91, v35, 0 op_sel:[0,1,0] op_sel_hi:[0,1,0]
  v_cvt_pk_bf16_f32 v37, v34, v35
  ds_write_b64 v19, v[36:37] offset:2048
  s_setprio 0
  s_waitcnt lgkmcnt(2)
  v_mfma_f32_16x16x32_bf16 v[200:203], v[52:55], v[68:71], v[200:203]
  ds_read_b128 v[64:67], v17 offset:17408
  v_cvt_pk_f16_f32 v32, v92, v93
  v_pk_fma_f16 v33, v32, v32, s92
  v_mfma_f32_16x16x32_bf16 v[208:211], v[52:55], v[72:75], v[208:211]
  v_pk_mul_f16 v33, v33, v32 neg_lo:[1,0] neg_hi:[1,0]
  v_exp_f16_sdwa v32, v33 dst_sel:WORD_0 dst_unused:UNUSED_PAD src0_sel:WORD_0
  v_mfma_f32_16x16x32_bf16 v[216:219], v[52:55], v[76:79], v[216:219]
  v_exp_f16_sdwa v32, v33 dst_sel:WORD_1 dst_unused:UNUSED_PRESERVE src0_sel:WORD_1
  v_mfma_f32_16x16x32_bf16 v[204:207], v[56:59], v[68:71], v[204:207]
  s_waitcnt vmcnt(4)
  s_waitcnt lgkmcnt(0)
  s_barrier
  s_setprio 3
  ds_read_b128 v[52:55], v16 offset:0
  v_pk_fma_f16 v32, v32, s93, s93
  v_rcp_f16_sdwa v33, v32 dst_sel:WORD_0 dst_unused:UNUSED_PAD src0_sel:WORD_0
  v_mfma_f32_16x16x32_bf16 v[212:215], v[56:59], v[72:75], v[212:215]
  v_rcp_f16_sdwa v33, v32 dst_sel:WORD_1 dst_unused:UNUSED_PRESERVE src0_sel:WORD_1
  v_mfma_f32_16x16x32_bf16 v[220:223], v[56:59], v[76:79], v[220:223]
  v_fma_mix_f32 v32, v92, v33, 0 op_sel_hi:[0,1,0]
  v_fma_mix_f32 v33, v93, v33, 0 op_sel:[0,1,0] op_sel_hi:[0,1,0]
  v_cvt_pk_bf16_f32 v36, v32, v33
  v_mfma_f32_16x16x32_bf16 v[224:227], v[60:63], v[68:71], v[224:227]
  ds_read_b128 v[56:59], v16 offset:1024
  v_cvt_pk_f16_f32 v34, v94, v95
  v_pk_fma_f16 v35, v34, v34, s92
  v_mfma_f32_16x16x32_bf16 v[232:235], v[60:63], v[72:75], v[232:235]
  v_pk_mul_f16 v35, v35, v34 neg_lo:[1,0] neg_hi:[1,0]
  v_exp_f16_sdwa v34, v35 dst_sel:WORD_0 dst_unused:UNUSED_PAD src0_sel:WORD_0
  v_mfma_f32_16x16x32_bf16 v[240:243], v[60:63], v[76:79], v[240:243]
  v_exp_f16_sdwa v34, v35 dst_sel:WORD_1 dst_unused:UNUSED_PRESERVE src0_sel:WORD_1
  s_add_u32 m0, s57, 49152
  s_mov_b32 s94, 417792
  buffer_load_dwordx4 v20, s[8:11], s94 offen offset:0 lds
  v_mfma_f32_16x16x32_bf16 v[228:231], v[64:67], v[68:71], v[228:231]
  ds_read_b128 v[60:63], v16 offset:2048
  v_pk_fma_f16 v34, v34, s93, s93
  v_rcp_f16_sdwa v35, v34 dst_sel:WORD_0 dst_unused:UNUSED_PAD src0_sel:WORD_0
  v_mfma_f32_16x16x32_bf16 v[236:239], v[64:67], v[72:75], v[236:239]
  v_rcp_f16_sdwa v35, v34 dst_sel:WORD_1 dst_unused:UNUSED_PRESERVE src0_sel:WORD_1
  v_mfma_f32_16x16x32_bf16 v[244:247], v[64:67], v[76:79], v[244:247]
  v_fma_mix_f32 v34, v94, v35, 0 op_sel_hi:[0,1,0]
  v_fma_mix_f32 v35, v95, v35, 0 op_sel:[0,1,0] op_sel_hi:[0,1,0]
  v_cvt_pk_bf16_f32 v37, v34, v35
  ds_write_b64 v19, v[36:37] offset:12288
  s_waitcnt lgkmcnt(2)
  v_mfma_f32_16x16x32_bf16 v[80:83], v[52:55], v[104:107], 0
  ds_read_b128 v[64:67], v16 offset:3072
  ds_read_b128 v[68:71], v18 offset:0
  v_cvt_pk_f16_f32 v32, v96, v97
  v_pk_fma_f16 v33, v32, v32, s92
  v_mfma_f32_16x16x32_bf16 v[84:87], v[52:55], v[108:111], 0
  v_pk_mul_f16 v33, v33, v32 neg_lo:[1,0] neg_hi:[1,0]
  v_exp_f16_sdwa v32, v33 dst_sel:WORD_0 dst_unused:UNUSED_PAD src0_sel:WORD_0
  v_mfma_f32_16x16x32_bf16 v[88:91], v[52:55], v[112:115], 0
  v_exp_f16_sdwa v32, v33 dst_sel:WORD_1 dst_unused:UNUSED_PRESERVE src0_sel:WORD_1
  buffer_load_dwordx4 v20, s[8:11], s94 offen offset:1024 lds
  v_mfma_f32_16x16x32_bf16 v[80:83], v[56:59], v[116:119], v[80:83]
  ds_read_b128 v[52:55], v16 offset:4096
  ds_read_b128 v[72:75], v18 offset:1024
  v_pk_fma_f16 v32, v32, s93, s93
  v_rcp_f16_sdwa v33, v32 dst_sel:WORD_0 dst_unused:UNUSED_PAD src0_sel:WORD_0
  v_mfma_f32_16x16x32_bf16 v[84:87], v[56:59], v[120:123], v[84:87]
  v_rcp_f16_sdwa v33, v32 dst_sel:WORD_1 dst_unused:UNUSED_PRESERVE src0_sel:WORD_1
  v_mfma_f32_16x16x32_bf16 v[88:91], v[56:59], v[124:127], v[88:91]
  v_fma_mix_f32 v32, v96, v33, 0 op_sel_hi:[0,1,0]
  v_fma_mix_f32 v33, v97, v33, 0 op_sel:[0,1,0] op_sel_hi:[0,1,0]
  v_cvt_pk_bf16_f32 v38, v32, v33
  s_waitcnt lgkmcnt(3)
  v_mfma_f32_16x16x32_bf16 v[80:83], v[60:63], v[128:131], v[80:83]
  ds_read_b128 v[56:59], v16 offset:5120
  ds_read_b128 v[76:79], v18 offset:2048
  v_cvt_pk_f16_f32 v34, v98, v99
  v_pk_fma_f16 v35, v34, v34, s92
  v_mfma_f32_16x16x32_bf16 v[84:87], v[60:63], v[132:135], v[84:87]
  v_pk_mul_f16 v35, v35, v34 neg_lo:[1,0] neg_hi:[1,0]
  v_exp_f16_sdwa v34, v35 dst_sel:WORD_0 dst_unused:UNUSED_PAD src0_sel:WORD_0
  v_mfma_f32_16x16x32_bf16 v[88:91], v[60:63], v[136:139], v[88:91]
  v_exp_f16_sdwa v34, v35 dst_sel:WORD_1 dst_unused:UNUSED_PRESERVE src0_sel:WORD_1
  buffer_load_dwordx4 v20, s[8:11], s94 offen offset:2048 lds
  v_mfma_f32_16x16x32_bf16 v[80:83], v[64:67], v[140:143], v[80:83]
  ds_read_b128 v[60:63], v16 offset:12288
  v_pk_fma_f16 v34, v34, s93, s93
  v_rcp_f16_sdwa v35, v34 dst_sel:WORD_0 dst_unused:UNUSED_PAD src0_sel:WORD_0
  v_mfma_f32_16x16x32_bf16 v[84:87], v[64:67], v[144:147], v[84:87]
  v_rcp_f16_sdwa v35, v34 dst_sel:WORD_1 dst_unused:UNUSED_PRESERVE src0_sel:WORD_1
  v_mfma_f32_16x16x32_bf16 v[88:91], v[64:67], v[148:151], v[88:91]
  v_fma_mix_f32 v34, v98, v35, 0 op_sel_hi:[0,1,0]
  v_fma_mix_f32 v35, v99, v35, 0 op_sel:[0,1,0] op_sel_hi:[0,1,0]
  v_cvt_pk_bf16_f32 v39, v34, v35
  ds_write_b64 v19, v[38:39] offset:13312
  s_setprio 2
  s_waitcnt lgkmcnt(3)
  v_mfma_f32_16x16x32_bf16 v[80:83], v[52:55], v[152:155], v[80:83]
  ds_read_b128 v[64:67], v16 offset:13312
  v_cvt_pk_f16_f32 v32, v100, v101
  v_pk_fma_f16 v33, v32, v32, s92
  v_mfma_f32_16x16x32_bf16 v[84:87], v[52:55], v[156:159], v[84:87]
  v_pk_mul_f16 v33, v33, v32 neg_lo:[1,0] neg_hi:[1,0]
  v_exp_f16_sdwa v32, v33 dst_sel:WORD_0 dst_unused:UNUSED_PAD src0_sel:WORD_0
  v_mfma_f32_16x16x32_bf16 v[88:91], v[52:55], v[160:163], v[88:91]
  v_exp_f16_sdwa v32, v33 dst_sel:WORD_1 dst_unused:UNUSED_PRESERVE src0_sel:WORD_1
  v_mfma_f32_16x16x32_bf16 v[80:83], v[56:59], v[164:167], v[80:83]
  ds_read_b128 v[52:55], v16 offset:14336
  v_pk_fma_f16 v32, v32, s93, s93
  v_rcp_f16_sdwa v33, v32 dst_sel:WORD_0 dst_unused:UNUSED_PAD src0_sel:WORD_0
  v_mfma_f32_16x16x32_bf16 v[84:87], v[56:59], v[168:171], v[84:87]
  v_rcp_f16_sdwa v33, v32 dst_sel:WORD_1 dst_unused:UNUSED_PRESERVE src0_sel:WORD_1
  v_mfma_f32_16x16x32_bf16 v[88:91], v[56:59], v[172:175], v[88:91]
  v_fma_mix_f32 v32, v100, v33, 0 op_sel_hi:[0,1,0]
  v_fma_mix_f32 v33, v101, v33, 0 op_sel:[0,1,0] op_sel_hi:[0,1,0]
  v_cvt_pk_bf16_f32 v36, v32, v33
  s_waitcnt lgkmcnt(1)
  v_mfma_f32_16x16x32_bf16 v[176:179], v[60:63], v[68:71], v[176:179]
  ds_read_b128 v[56:59], v16 offset:15360
  v_cvt_pk_f16_f32 v34, v102, v103
  v_pk_fma_f16 v35, v34, v34, s92
  v_mfma_f32_16x16x32_bf16 v[184:187], v[60:63], v[72:75], v[184:187]
  v_pk_mul_f16 v35, v35, v34 neg_lo:[1,0] neg_hi:[1,0]
  v_exp_f16_sdwa v34, v35 dst_sel:WORD_0 dst_unused:UNUSED_PAD src0_sel:WORD_0
  v_mfma_f32_16x16x32_bf16 v[192:195], v[60:63], v[76:79], v[192:195]
  v_exp_f16_sdwa v34, v35 dst_sel:WORD_1 dst_unused:UNUSED_PRESERVE src0_sel:WORD_1
  s_setprio 1
  v_mfma_f32_16x16x32_bf16 v[180:183], v[64:67], v[68:71], v[180:183]
  ds_read_b128 v[60:63], v16 offset:16384
  v_pk_fma_f16 v34, v34, s93, s93
  v_rcp_f16_sdwa v35, v34 dst_sel:WORD_0 dst_unused:UNUSED_PAD src0_sel:WORD_0
  v_mfma_f32_16x16x32_bf16 v[188:191], v[64:67], v[72:75], v[188:191]
  v_rcp_f16_sdwa v35, v34 dst_sel:WORD_1 dst_unused:UNUSED_PRESERVE src0_sel:WORD_1
  v_mfma_f32_16x16x32_bf16 v[196:199], v[64:67], v[76:79], v[196:199]
  v_fma_mix_f32 v34, v102, v35, 0 op_sel_hi:[0,1,0]
  v_fma_mix_f32 v35, v103, v35, 0 op_sel:[0,1,0] op_sel_hi:[0,1,0]
  v_cvt_pk_bf16_f32 v37, v34, v35
  ds_write_b64 v19, v[36:37] offset:14336
  s_setprio 0
  s_waitcnt lgkmcnt(2)
  v_mfma_f32_16x16x32_bf16 v[200:203], v[52:55], v[68:71], v[200:203]
  ds_read_b128 v[64:67], v16 offset:17408
  v_cvt_pk_f16_f32 v32, v80, v81
  v_pk_fma_f16 v33, v32, v32, s92
  v_mfma_f32_16x16x32_bf16 v[208:211], v[52:55], v[72:75], v[208:211]
  v_pk_mul_f16 v33, v33, v32 neg_lo:[1,0] neg_hi:[1,0]
  v_exp_f16_sdwa v32, v33 dst_sel:WORD_0 dst_unused:UNUSED_PAD src0_sel:WORD_0
  v_mfma_f32_16x16x32_bf16 v[216:219], v[52:55], v[76:79], v[216:219]
  v_exp_f16_sdwa v32, v33 dst_sel:WORD_1 dst_unused:UNUSED_PRESERVE src0_sel:WORD_1
  v_mfma_f32_16x16x32_bf16 v[204:207], v[56:59], v[68:71], v[204:207]
  s_waitcnt vmcnt(4)
  s_waitcnt lgkmcnt(0)
  s_barrier
  s_setprio 3
  ds_read_b128 v[52:55], v16 offset:24576
  v_pk_fma_f16 v32, v32, s93, s93
  v_rcp_f16_sdwa v33, v32 dst_sel:WORD_0 dst_unused:UNUSED_PAD src0_sel:WORD_0
  v_mfma_f32_16x16x32_bf16 v[212:215], v[56:59], v[72:75], v[212:215]
  v_rcp_f16_sdwa v33, v32 dst_sel:WORD_1 dst_unused:UNUSED_PRESERVE src0_sel:WORD_1
  v_mfma_f32_16x16x32_bf16 v[220:223], v[56:59], v[76:79], v[220:223]
  v_fma_mix_f32 v32, v80, v33, 0 op_sel_hi:[0,1,0]
  v_fma_mix_f32 v33, v81, v33, 0 op_sel:[0,1,0] op_sel_hi:[0,1,0]
  v_cvt_pk_bf16_f32 v36, v32, v33
  v_mfma_f32_16x16x32_bf16 v[224:227], v[60:63], v[68:71], v[224:227]
  ds_read_b128 v[56:59], v16 offset:25600
  v_cvt_pk_f16_f32 v34, v82, v83
  v_pk_fma_f16 v35, v34, v34, s92
  v_mfma_f32_16x16x32_bf16 v[232:235], v[60:63], v[72:75], v[232:235]
  v_pk_mul_f16 v35, v35, v34 neg_lo:[1,0] neg_hi:[1,0]
  v_exp_f16_sdwa v34, v35 dst_sel:WORD_0 dst_unused:UNUSED_PAD src0_sel:WORD_0
  v_mfma_f32_16x16x32_bf16 v[240:243], v[60:63], v[76:79], v[240:243]
  v_exp_f16_sdwa v34, v35 dst_sel:WORD_1 dst_unused:UNUSED_PRESERVE src0_sel:WORD_1
  s_add_u32 m0, s57, 0
  s_mov_b32 s94, 442368
  buffer_load_dwordx4 v20, s[8:11], s94 offen offset:0 lds
  v_mfma_f32_16x16x32_bf16 v[228:231], v[64:67], v[68:71], v[228:231]
  ds_read_b128 v[60:63], v16 offset:26624
  v_pk_fma_f16 v34, v34, s93, s93
  v_rcp_f16_sdwa v35, v34 dst_sel:WORD_0 dst_unused:UNUSED_PAD src0_sel:WORD_0
  v_mfma_f32_16x16x32_bf16 v[236:239], v[64:67], v[72:75], v[236:239]
  v_rcp_f16_sdwa v35, v34 dst_sel:WORD_1 dst_unused:UNUSED_PRESERVE src0_sel:WORD_1
  v_mfma_f32_16x16x32_bf16 v[244:247], v[64:67], v[76:79], v[244:247]
  v_fma_mix_f32 v34, v82, v35, 0 op_sel_hi:[0,1,0]
  v_fma_mix_f32 v35, v83, v35, 0 op_sel:[0,1,0] op_sel_hi:[0,1,0]
  v_cvt_pk_bf16_f32 v37, v34, v35
  ds_write_b64 v19, v[36:37] offset:0
  s_waitcnt lgkmcnt(2)
  v_mfma_f32_16x16x32_bf16 v[92:95], v[52:55], v[104:107], 0
  ds_read_b128 v[64:67], v16 offset:27648
  ds_read_b128 v[68:71], v18 offset:12288
  v_cvt_pk_f16_f32 v32, v84, v85
  v_pk_fma_f16 v33, v32, v32, s92
  v_mfma_f32_16x16x32_bf16 v[96:99], v[52:55], v[108:111], 0
  v_pk_mul_f16 v33, v33, v32 neg_lo:[1,0] neg_hi:[1,0]
  v_exp_f16_sdwa v32, v33 dst_sel:WORD_0 dst_unused:UNUSED_PAD src0_sel:WORD_0
  v_mfma_f32_16x16x32_bf16 v[100:103], v[52:55], v[112:115], 0
  v_exp_f16_sdwa v32, v33 dst_sel:WORD_1 dst_unused:UNUSED_PRESERVE src0_sel:WORD_1
  buffer_load_dwordx4 v20, s[8:11], s94 offen offset:1024 lds
  v_mfma_f32_16x16x32_bf16 v[92:95], v[56:59], v[116:119], v[92:95]
  ds_read_b128 v[52:55], v16 offset:28672
  ds_read_b128 v[72:75], v18 offset:13312
  v_pk_fma_f16 v32, v32, s93, s93
  v_rcp_f16_sdwa v33, v32 dst_sel:WORD_0 dst_unused:UNUSED_PAD src0_sel:WORD_0
  v_mfma_f32_16x16x32_bf16 v[96:99], v[56:59], v[120:123], v[96:99]
  v_rcp_f16_sdwa v33, v32 dst_sel:WORD_1 dst_unused:UNUSED_PRESERVE src0_sel:WORD_1
  v_mfma_f32_16x16x32_bf16 v[100:103], v[56:59], v[124:127], v[100:103]
  v_fma_mix_f32 v32, v84, v33, 0 op_sel_hi:[0,1,0]
  v_fma_mix_f32 v33, v85, v33, 0 op_sel:[0,1,0] op_sel_hi:[0,1,0]
  v_cvt_pk_bf16_f32 v38, v32, v33
  s_waitcnt lgkmcnt(3)
  v_mfma_f32_16x16x32_bf16 v[92:95], v[60:63], v[128:131], v[92:95]
  ds_read_b128 v[56:59], v16 offset:29696
  ds_read_b128 v[76:79], v18 offset:14336
  v_cvt_pk_f16_f32 v34, v86, v87
  v_pk_fma_f16 v35, v34, v34, s92
  v_mfma_f32_16x16x32_bf16 v[96:99], v[60:63], v[132:135], v[96:99]
  v_pk_mul_f16 v35, v35, v34 neg_lo:[1,0] neg_hi:[1,0]
  v_exp_f16_sdwa v34, v35 dst_sel:WORD_0 dst_unused:UNUSED_PAD src0_sel:WORD_0
  v_mfma_f32_16x16x32_bf16 v[100:103], v[60:63], v[136:139], v[100:103]
  v_exp_f16_sdwa v34, v35 dst_sel:WORD_1 dst_unused:UNUSED_PRESERVE src0_sel:WORD_1
  buffer_load_dwordx4 v20, s[8:11], s94 offen offset:2048 lds
  v_mfma_f32_16x16x32_bf16 v[92:95], v[64:67], v[140:143], v[92:95]
  ds_read_b128 v[60:63], v16 offset:36864
  v_pk_fma_f16 v34, v34, s93, s93
  v_rcp_f16_sdwa v35, v34 dst_sel:WORD_0 dst_unused:UNUSED_PAD src0_sel:WORD_0
  v_mfma_f32_16x16x32_bf16 v[96:99], v[64:67], v[144:147], v[96:99]
  v_rcp_f16_sdwa v35, v34 dst_sel:WORD_1 dst_unused:UNUSED_PRESERVE src0_sel:WORD_1
  v_mfma_f32_16x16x32_bf16 v[100:103], v[64:67], v[148:151], v[100:103]
  v_fma_mix_f32 v34, v86, v35, 0 op_sel_hi:[0,1,0]
  v_fma_mix_f32 v35, v87, v35, 0 op_sel:[0,1,0] op_sel_hi:[0,1,0]
  v_cvt_pk_bf16_f32 v39, v34, v35
  ds_write_b64 v19, v[38:39] offset:1024
  s_setprio 2
  s_waitcnt lgkmcnt(3)
  v_mfma_f32_16x16x32_bf16 v[92:95], v[52:55], v[152:155], v[92:95]
  ds_read_b128 v[64:67], v16 offset:37888
  v_cvt_pk_f16_f32 v32, v88, v89
  v_pk_fma_f16 v33, v32, v32, s92
  v_mfma_f32_16x16x32_bf16 v[96:99], v[52:55], v[156:159], v[96:99]
  v_pk_mul_f16 v33, v33, v32 neg_lo:[1,0] neg_hi:[1,0]
  v_exp_f16_sdwa v32, v33 dst_sel:WORD_0 dst_unused:UNUSED_PAD src0_sel:WORD_0
  v_mfma_f32_16x16x32_bf16 v[100:103], v[52:55], v[160:163], v[100:103]
  v_exp_f16_sdwa v32, v33 dst_sel:WORD_1 dst_unused:UNUSED_PRESERVE src0_sel:WORD_1
  v_mfma_f32_16x16x32_bf16 v[92:95], v[56:59], v[164:167], v[92:95]
  ds_read_b128 v[52:55], v16 offset:38912
  v_pk_fma_f16 v32, v32, s93, s93
  v_rcp_f16_sdwa v33, v32 dst_sel:WORD_0 dst_unused:UNUSED_PAD src0_sel:WORD_0
  v_mfma_f32_16x16x32_bf16 v[96:99], v[56:59], v[168:171], v[96:99]
  v_rcp_f16_sdwa v33, v32 dst_sel:WORD_1 dst_unused:UNUSED_PRESERVE src0_sel:WORD_1
  v_mfma_f32_16x16x32_bf16 v[100:103], v[56:59], v[172:175], v[100:103]
  v_fma_mix_f32 v32, v88, v33, 0 op_sel_hi:[0,1,0]
  v_fma_mix_f32 v33, v89, v33, 0 op_sel:[0,1,0] op_sel_hi:[0,1,0]
  v_cvt_pk_bf16_f32 v36, v32, v33
  s_waitcnt lgkmcnt(1)
  v_mfma_f32_16x16x32_bf16 v[176:179], v[60:63], v[68:71], v[176:179]
  ds_read_b128 v[56:59], v16 offset:39936
  v_cvt_pk_f16_f32 v34, v90, v91
  v_pk_fma_f16 v35, v34, v34, s92
  v_mfma_f32_16x16x32_bf16 v[184:187], v[60:63], v[72:75], v[184:187]
  v_pk_mul_f16 v35, v35, v34 neg_lo:[1,0] neg_hi:[1,0]
  v_exp_f16_sdwa v34, v35 dst_sel:WORD_0 dst_unused:UNUSED_PAD src0_sel:WORD_0
  v_mfma_f32_16x16x32_bf16 v[192:195], v[60:63], v[76:79], v[192:195]
  v_exp_f16_sdwa v34, v35 dst_sel:WORD_1 dst_unused:UNUSED_PRESERVE src0_sel:WORD_1
  s_setprio 1
  v_mfma_f32_16x16x32_bf16 v[180:183], v[64:67], v[68:71], v[180:183]
  ds_read_b128 v[60:63], v16 offset:40960
  v_pk_fma_f16 v34, v34, s93, s93
  v_rcp_f16_sdwa v35, v34 dst_sel:WORD_0 dst_unused:UNUSED_PAD src0_sel:WORD_0
  v_mfma_f32_16x16x32_bf16 v[188:191], v[64:67], v[72:75], v[188:191]
  v_rcp_f16_sdwa v35, v34 dst_sel:WORD_1 dst_unused:UNUSED_PRESERVE src0_sel:WORD_1
  v_mfma_f32_16x16x32_bf16 v[196:199], v[64:67], v[76:79], v[196:199]
  v_fma_mix_f32 v34, v90, v35, 0 op_sel_hi:[0,1,0]
  v_fma_mix_f32 v35, v91, v35, 0 op_sel:[0,1,0] op_sel_hi:[0,1,0]
  v_cvt_pk_bf16_f32 v37, v34, v35
  ds_write_b64 v19, v[36:37] offset:2048
  s_setprio 0
  s_waitcnt lgkmcnt(2)
  v_mfma_f32_16x16x32_bf16 v[200:203], v[52:55], v[68:71], v[200:203]
  ds_read_b128 v[64:67], v16 offset:41984
  v_cvt_pk_f16_f32 v32, v92, v93
  v_pk_fma_f16 v33, v32, v32, s92
  v_mfma_f32_16x16x32_bf16 v[208:211], v[52:55], v[72:75], v[208:211]
  v_pk_mul_f16 v33, v33, v32 neg_lo:[1,0] neg_hi:[1,0]
  v_exp_f16_sdwa v32, v33 dst_sel:WORD_0 dst_unused:UNUSED_PAD src0_sel:WORD_0
  v_mfma_f32_16x16x32_bf16 v[216:219], v[52:55], v[76:79], v[216:219]
  v_exp_f16_sdwa v32, v33 dst_sel:WORD_1 dst_unused:UNUSED_PRESERVE src0_sel:WORD_1
  v_mfma_f32_16x16x32_bf16 v[204:207], v[56:59], v[68:71], v[204:207]
  s_waitcnt vmcnt(3)
  s_waitcnt lgkmcnt(0)
  s_barrier
  s_setprio 3
  ds_read_b128 v[52:55], v17 offset:0
  v_pk_fma_f16 v32, v32, s93, s93
  v_rcp_f16_sdwa v33, v32 dst_sel:WORD_0 dst_unused:UNUSED_PAD src0_sel:WORD_0
  v_mfma_f32_16x16x32_bf16 v[212:215], v[56:59], v[72:75], v[212:215]
  v_rcp_f16_sdwa v33, v32 dst_sel:WORD_1 dst_unused:UNUSED_PRESERVE src0_sel:WORD_1
  v_mfma_f32_16x16x32_bf16 v[220:223], v[56:59], v[76:79], v[220:223]
  v_fma_mix_f32 v32, v92, v33, 0 op_sel_hi:[0,1,0]
  v_fma_mix_f32 v33, v93, v33, 0 op_sel:[0,1,0] op_sel_hi:[0,1,0]
  v_cvt_pk_bf16_f32 v36, v32, v33
  v_mfma_f32_16x16x32_bf16 v[224:227], v[60:63], v[68:71], v[224:227]
  ds_read_b128 v[56:59], v17 offset:1024
  v_cvt_pk_f16_f32 v34, v94, v95
  v_pk_fma_f16 v35, v34, v34, s92
  v_mfma_f32_16x16x32_bf16 v[232:235], v[60:63], v[72:75], v[232:235]
  v_pk_mul_f16 v35, v35, v34 neg_lo:[1,0] neg_hi:[1,0]
  v_exp_f16_sdwa v34, v35 dst_sel:WORD_0 dst_unused:UNUSED_PAD src0_sel:WORD_0
  v_mfma_f32_16x16x32_bf16 v[240:243], v[60:63], v[76:79], v[240:243]
  v_exp_f16_sdwa v34, v35 dst_sel:WORD_1 dst_unused:UNUSED_PRESERVE src0_sel:WORD_1
  s_add_u32 m0, s57, 24576
  s_mov_b32 s94, 466944
  buffer_load_dwordx4 v20, s[8:11], s94 offen offset:0 lds
  v_mfma_f32_16x16x32_bf16 v[228:231], v[64:67], v[68:71], v[228:231]
  ds_read_b128 v[60:63], v17 offset:2048
  v_pk_fma_f16 v34, v34, s93, s93
  v_rcp_f16_sdwa v35, v34 dst_sel:WORD_0 dst_unused:UNUSED_PAD src0_sel:WORD_0
  v_mfma_f32_16x16x32_bf16 v[236:239], v[64:67], v[72:75], v[236:239]
  v_rcp_f16_sdwa v35, v34 dst_sel:WORD_1 dst_unused:UNUSED_PRESERVE src0_sel:WORD_1
  v_mfma_f32_16x16x32_bf16 v[244:247], v[64:67], v[76:79], v[244:247]
  v_fma_mix_f32 v34, v94, v35, 0 op_sel_hi:[0,1,0]
  v_fma_mix_f32 v35, v95, v35, 0 op_sel:[0,1,0] op_sel_hi:[0,1,0]
  v_cvt_pk_bf16_f32 v37, v34, v35
  ds_write_b64 v19, v[36:37] offset:12288
  s_waitcnt lgkmcnt(2)
  v_mfma_f32_16x16x32_bf16 v[80:83], v[52:55], v[104:107], 0
  ds_read_b128 v[64:67], v17 offset:3072
  ds_read_b128 v[68:71], v18 offset:0
  v_cvt_pk_f16_f32 v32, v96, v97
  v_pk_fma_f16 v33, v32, v32, s92
  v_mfma_f32_16x16x32_bf16 v[84:87], v[52:55], v[108:111], 0
  v_pk_mul_f16 v33, v33, v32 neg_lo:[1,0] neg_hi:[1,0]
  v_exp_f16_sdwa v32, v33 dst_sel:WORD_0 dst_unused:UNUSED_PAD src0_sel:WORD_0
  v_mfma_f32_16x16x32_bf16 v[88:91], v[52:55], v[112:115], 0
  v_exp_f16_sdwa v32, v33 dst_sel:WORD_1 dst_unused:UNUSED_PRESERVE src0_sel:WORD_1
  buffer_load_dwordx4 v20, s[8:11], s94 offen offset:1024 lds
  v_mfma_f32_16x16x32_bf16 v[80:83], v[56:59], v[116:119], v[80:83]
  ds_read_b128 v[52:55], v17 offset:4096
  ds_read_b128 v[72:75], v18 offset:1024
  v_pk_fma_f16 v32, v32, s93, s93
  v_rcp_f16_sdwa v33, v32 dst_sel:WORD_0 dst_unused:UNUSED_PAD src0_sel:WORD_0
  v_mfma_f32_16x16x32_bf16 v[84:87], v[56:59], v[120:123], v[84:87]
  v_rcp_f16_sdwa v33, v32 dst_sel:WORD_1 dst_unused:UNUSED_PRESERVE src0_sel:WORD_1
  v_mfma_f32_16x16x32_bf16 v[88:91], v[56:59], v[124:127], v[88:91]
  v_fma_mix_f32 v32, v96, v33, 0 op_sel_hi:[0,1,0]
  v_fma_mix_f32 v33, v97, v33, 0 op_sel:[0,1,0] op_sel_hi:[0,1,0]
  v_cvt_pk_bf16_f32 v38, v32, v33
  s_waitcnt lgkmcnt(3)
  v_mfma_f32_16x16x32_bf16 v[80:83], v[60:63], v[128:131], v[80:83]
  ds_read_b128 v[56:59], v17 offset:5120
  ds_read_b128 v[76:79], v18 offset:2048
  v_cvt_pk_f16_f32 v34, v98, v99
  v_pk_fma_f16 v35, v34, v34, s92
  v_mfma_f32_16x16x32_bf16 v[84:87], v[60:63], v[132:135], v[84:87]
  v_pk_mul_f16 v35, v35, v34 neg_lo:[1,0] neg_hi:[1,0]
  v_exp_f16_sdwa v34, v35 dst_sel:WORD_0 dst_unused:UNUSED_PAD src0_sel:WORD_0
  v_mfma_f32_16x16x32_bf16 v[88:91], v[60:63], v[136:139], v[88:91]
  v_exp_f16_sdwa v34, v35 dst_sel:WORD_1 dst_unused:UNUSED_PRESERVE src0_sel:WORD_1
  buffer_load_dwordx4 v20, s[8:11], s94 offen offset:2048 lds
  v_mfma_f32_16x16x32_bf16 v[80:83], v[64:67], v[140:143], v[80:83]
  ds_read_b128 v[60:63], v17 offset:12288
  v_pk_fma_f16 v34, v34, s93, s93
  v_rcp_f16_sdwa v35, v34 dst_sel:WORD_0 dst_unused:UNUSED_PAD src0_sel:WORD_0
  v_mfma_f32_16x16x32_bf16 v[84:87], v[64:67], v[144:147], v[84:87]
  v_rcp_f16_sdwa v35, v34 dst_sel:WORD_1 dst_unused:UNUSED_PRESERVE src0_sel:WORD_1
  v_mfma_f32_16x16x32_bf16 v[88:91], v[64:67], v[148:151], v[88:91]
  v_fma_mix_f32 v34, v98, v35, 0 op_sel_hi:[0,1,0]
  v_fma_mix_f32 v35, v99, v35, 0 op_sel:[0,1,0] op_sel_hi:[0,1,0]
  v_cvt_pk_bf16_f32 v39, v34, v35
  ds_write_b64 v19, v[38:39] offset:13312
  s_sub_u32 s31, s32, 3
  s_mul_i32 s31, s31, 384
  s_add_u32 s31, s31, s45
  s_sub_u32 s31, s31, 3
  s_mul_i32 s31, s31, 384
  s_add_u32 s31, s31, 256
  v_add_u32 v30, s31, v0
  buffer_load_dword v248, v30, s[4:7], 0 offen
  s_setprio 2
  s_waitcnt lgkmcnt(3)
  v_mfma_f32_16x16x32_bf16 v[80:83], v[52:55], v[152:155], v[80:83]
  ds_read_b128 v[64:67], v17 offset:13312
  v_cvt_pk_f16_f32 v32, v100, v101
  v_pk_fma_f16 v33, v32, v32, s92
  v_mfma_f32_16x16x32_bf16 v[84:87], v[52:55], v[156:159], v[84:87]
  v_pk_mul_f16 v33, v33, v32 neg_lo:[1,0] neg_hi:[1,0]
  v_exp_f16_sdwa v32, v33 dst_sel:WORD_0 dst_unused:UNUSED_PAD src0_sel:WORD_0
  v_mfma_f32_16x16x32_bf16 v[88:91], v[52:55], v[160:163], v[88:91]
  v_exp_f16_sdwa v32, v33 dst_sel:WORD_1 dst_unused:UNUSED_PRESERVE src0_sel:WORD_1
  v_mfma_f32_16x16x32_bf16 v[80:83], v[56:59], v[164:167], v[80:83]
  ds_read_b128 v[52:55], v17 offset:14336
  v_pk_fma_f16 v32, v32, s93, s93
  v_rcp_f16_sdwa v33, v32 dst_sel:WORD_0 dst_unused:UNUSED_PAD src0_sel:WORD_0
  v_mfma_f32_16x16x32_bf16 v[84:87], v[56:59], v[168:171], v[84:87]
  v_rcp_f16_sdwa v33, v32 dst_sel:WORD_1 dst_unused:UNUSED_PRESERVE src0_sel:WORD_1
  v_mfma_f32_16x16x32_bf16 v[88:91], v[56:59], v[172:175], v[88:91]
  v_fma_mix_f32 v32, v100, v33, 0 op_sel_hi:[0,1,0]
  v_fma_mix_f32 v33, v101, v33, 0 op_sel:[0,1,0] op_sel_hi:[0,1,0]
  v_cvt_pk_bf16_f32 v36, v32, v33
  s_waitcnt lgkmcnt(1)
  v_mfma_f32_16x16x32_bf16 v[176:179], v[60:63], v[68:71], v[176:179]
  ds_read_b128 v[56:59], v17 offset:15360
  v_cvt_pk_f16_f32 v34, v102, v103
  v_pk_fma_f16 v35, v34, v34, s92
  v_mfma_f32_16x16x32_bf16 v[184:187], v[60:63], v[72:75], v[184:187]
  v_pk_mul_f16 v35, v35, v34 neg_lo:[1,0] neg_hi:[1,0]
  v_exp_f16_sdwa v34, v35 dst_sel:WORD_0 dst_unused:UNUSED_PAD src0_sel:WORD_0
  v_mfma_f32_16x16x32_bf16 v[192:195], v[60:63], v[76:79], v[192:195]
  v_exp_f16_sdwa v34, v35 dst_sel:WORD_1 dst_unused:UNUSED_PRESERVE src0_sel:WORD_1
  s_setprio 1
  v_mfma_f32_16x16x32_bf16 v[180:183], v[64:67], v[68:71], v[180:183]
  ds_read_b128 v[60:63], v17 offset:16384
  v_pk_fma_f16 v34, v34, s93, s93
  v_rcp_f16_sdwa v35, v34 dst_sel:WORD_0 dst_unused:UNUSED_PAD src0_sel:WORD_0
  v_mfma_f32_16x16x32_bf16 v[188:191], v[64:67], v[72:75], v[188:191]
  v_rcp_f16_sdwa v35, v34 dst_sel:WORD_1 dst_unused:UNUSED_PRESERVE src0_sel:WORD_1
  v_mfma_f32_16x16x32_bf16 v[196:199], v[64:67], v[76:79], v[196:199]
  v_fma_mix_f32 v34, v102, v35, 0 op_sel_hi:[0,1,0]
  v_fma_mix_f32 v35, v103, v35, 0 op_sel:[0,1,0] op_sel_hi:[0,1,0]
  v_cvt_pk_bf16_f32 v37, v34, v35
  ds_write_b64 v19, v[36:37] offset:14336
  s_setprio 0
  s_waitcnt lgkmcnt(2)
  v_mfma_f32_16x16x32_bf16 v[200:203], v[52:55], v[68:71], v[200:203]
  ds_read_b128 v[64:67], v17 offset:17408
  v_cvt_pk_f16_f32 v32, v80, v81
  v_pk_fma_f16 v33, v32, v32, s92
  v_mfma_f32_16x16x32_bf16 v[208:211], v[52:55], v[72:75], v[208:211]
  v_pk_mul_f16 v33, v33, v32 neg_lo:[1,0] neg_hi:[1,0]
  v_exp_f16_sdwa v32, v33 dst_sel:WORD_0 dst_unused:UNUSED_PAD src0_sel:WORD_0
  v_mfma_f32_16x16x32_bf16 v[216:219], v[52:55], v[76:79], v[216:219]
  v_exp_f16_sdwa v32, v33 dst_sel:WORD_1 dst_unused:UNUSED_PRESERVE src0_sel:WORD_1
  v_mfma_f32_16x16x32_bf16 v[204:207], v[56:59], v[68:71], v[204:207]
  s_waitcnt vmcnt(4)
  s_waitcnt lgkmcnt(0)
  s_barrier
  s_setprio 3
  ds_read_b128 v[52:55], v16 offset:0
  v_pk_fma_f16 v32, v32, s93, s93
  v_rcp_f16_sdwa v33, v32 dst_sel:WORD_0 dst_unused:UNUSED_PAD src0_sel:WORD_0
  v_mfma_f32_16x16x32_bf16 v[212:215], v[56:59], v[72:75], v[212:215]
  v_rcp_f16_sdwa v33, v32 dst_sel:WORD_1 dst_unused:UNUSED_PRESERVE src0_sel:WORD_1
  v_mfma_f32_16x16x32_bf16 v[220:223], v[56:59], v[76:79], v[220:223]
  v_fma_mix_f32 v32, v80, v33, 0 op_sel_hi:[0,1,0]
  v_fma_mix_f32 v33, v81, v33, 0 op_sel:[0,1,0] op_sel_hi:[0,1,0]
  v_cvt_pk_bf16_f32 v36, v32, v33
  v_mfma_f32_16x16x32_bf16 v[224:227], v[60:63], v[68:71], v[224:227]
  ds_read_b128 v[56:59], v16 offset:1024
  v_cvt_pk_f16_f32 v34, v82, v83
  v_pk_fma_f16 v35, v34, v34, s92
  v_mfma_f32_16x16x32_bf16 v[232:235], v[60:63], v[72:75], v[232:235]
  v_pk_mul_f16 v35, v35, v34 neg_lo:[1,0] neg_hi:[1,0]
  v_exp_f16_sdwa v34, v35 dst_sel:WORD_0 dst_unused:UNUSED_PAD src0_sel:WORD_0
  v_mfma_f32_16x16x32_bf16 v[240:243], v[60:63], v[76:79], v[240:243]
  v_exp_f16_sdwa v34, v35 dst_sel:WORD_1 dst_unused:UNUSED_PRESERVE src0_sel:WORD_1
  s_add_u32 m0, s57, 49152
  s_mov_b32 s94, 491520
  buffer_load_dwordx4 v20, s[8:11], s94 offen offset:0 lds
  v_mfma_f32_16x16x32_bf16 v[228:231], v[64:67], v[68:71], v[228:231]
  ds_read_b128 v[60:63], v16 offset:2048
  v_pk_fma_f16 v34, v34, s93, s93
  v_rcp_f16_sdwa v35, v34 dst_sel:WORD_0 dst_unused:UNUSED_PAD src0_sel:WORD_0
  v_mfma_f32_16x16x32_bf16 v[236:239], v[64:67], v[72:75], v[236:239]
  v_rcp_f16_sdwa v35, v34 dst_sel:WORD_1 dst_unused:UNUSED_PRESERVE src0_sel:WORD_1
  v_mfma_f32_16x16x32_bf16 v[244:247], v[64:67], v[76:79], v[244:247]
  v_fma_mix_f32 v34, v82, v35, 0 op_sel_hi:[0,1,0]
  v_fma_mix_f32 v35, v83, v35, 0 op_sel:[0,1,0] op_sel_hi:[0,1,0]
  v_cvt_pk_bf16_f32 v37, v34, v35
  ds_write_b64 v19, v[36:37] offset:0
  s_waitcnt lgkmcnt(2)
  v_mfma_f32_16x16x32_bf16 v[92:95], v[52:55], v[104:107], 0
  ds_read_b128 v[64:67], v16 offset:3072
  ds_read_b128 v[68:71], v18 offset:12288
  v_cvt_pk_f16_f32 v32, v84, v85
  v_pk_fma_f16 v33, v32, v32, s92
  v_mfma_f32_16x16x32_bf16 v[96:99], v[52:55], v[108:111], 0
  v_pk_mul_f16 v33, v33, v32 neg_lo:[1,0] neg_hi:[1,0]
  v_exp_f16_sdwa v32, v33 dst_sel:WORD_0 dst_unused:UNUSED_PAD src0_sel:WORD_0
  v_mfma_f32_16x16x32_bf16 v[100:103], v[52:55], v[112:115], 0
  v_exp_f16_sdwa v32, v33 dst_sel:WORD_1 dst_unused:UNUSED_PRESERVE src0_sel:WORD_1
  buffer_load_dwordx4 v20, s[8:11], s94 offen offset:1024 lds
  v_mfma_f32_16x16x32_bf16 v[92:95], v[56:59], v[116:119], v[92:95]
  ds_read_b128 v[52:55], v16 offset:4096
  ds_read_b128 v[72:75], v18 offset:13312
  v_pk_fma_f16 v32, v32, s93, s93
  v_rcp_f16_sdwa v33, v32 dst_sel:WORD_0 dst_unused:UNUSED_PAD src0_sel:WORD_0
  v_mfma_f32_16x16x32_bf16 v[96:99], v[56:59], v[120:123], v[96:99]
  v_rcp_f16_sdwa v33, v32 dst_sel:WORD_1 dst_unused:UNUSED_PRESERVE src0_sel:WORD_1
  v_mfma_f32_16x16x32_bf16 v[100:103], v[56:59], v[124:127], v[100:103]
  v_fma_mix_f32 v32, v84, v33, 0 op_sel_hi:[0,1,0]
  v_fma_mix_f32 v33, v85, v33, 0 op_sel:[0,1,0] op_sel_hi:[0,1,0]
  v_cvt_pk_bf16_f32 v38, v32, v33
  s_waitcnt lgkmcnt(3)
  v_mfma_f32_16x16x32_bf16 v[92:95], v[60:63], v[128:131], v[92:95]
  ds_read_b128 v[56:59], v16 offset:5120
  ds_read_b128 v[76:79], v18 offset:14336
  v_cvt_pk_f16_f32 v34, v86, v87
  v_pk_fma_f16 v35, v34, v34, s92
  v_mfma_f32_16x16x32_bf16 v[96:99], v[60:63], v[132:135], v[96:99]
  v_pk_mul_f16 v35, v35, v34 neg_lo:[1,0] neg_hi:[1,0]
  v_exp_f16_sdwa v34, v35 dst_sel:WORD_0 dst_unused:UNUSED_PAD src0_sel:WORD_0
  v_mfma_f32_16x16x32_bf16 v[100:103], v[60:63], v[136:139], v[100:103]
  v_exp_f16_sdwa v34, v35 dst_sel:WORD_1 dst_unused:UNUSED_PRESERVE src0_sel:WORD_1
  buffer_load_dwordx4 v20, s[8:11], s94 offen offset:2048 lds
  v_mfma_f32_16x16x32_bf16 v[92:95], v[64:67], v[140:143], v[92:95]
  ds_read_b128 v[60:63], v16 offset:12288
  v_pk_fma_f16 v34, v34, s93, s93
  v_rcp_f16_sdwa v35, v34 dst_sel:WORD_0 dst_unused:UNUSED_PAD src0_sel:WORD_0
  v_mfma_f32_16x16x32_bf16 v[96:99], v[64:67], v[144:147], v[96:99]
  v_rcp_f16_sdwa v35, v34 dst_sel:WORD_1 dst_unused:UNUSED_PRESERVE src0_sel:WORD_1
  v_mfma_f32_16x16x32_bf16 v[100:103], v[64:67], v[148:151], v[100:103]
  v_fma_mix_f32 v34, v86, v35, 0 op_sel_hi:[0,1,0]
  v_fma_mix_f32 v35, v87, v35, 0 op_sel:[0,1,0] op_sel_hi:[0,1,0]
  v_cvt_pk_bf16_f32 v39, v34, v35
  ds_write_b64 v19, v[38:39] offset:1024
  s_setprio 2
  s_waitcnt lgkmcnt(3)
  v_mfma_f32_16x16x32_bf16 v[92:95], v[52:55], v[152:155], v[92:95]
  ds_read_b128 v[64:67], v16 offset:13312
  v_cvt_pk_f16_f32 v32, v88, v89
  v_pk_fma_f16 v33, v32, v32, s92
  v_mfma_f32_16x16x32_bf16 v[96:99], v[52:55], v[156:159], v[96:99]
  v_pk_mul_f16 v33, v33, v32 neg_lo:[1,0] neg_hi:[1,0]
  v_exp_f16_sdwa v32, v33 dst_sel:WORD_0 dst_unused:UNUSED_PAD src0_sel:WORD_0
  v_mfma_f32_16x16x32_bf16 v[100:103], v[52:55], v[160:163], v[100:103]
  v_exp_f16_sdwa v32, v33 dst_sel:WORD_1 dst_unused:UNUSED_PRESERVE src0_sel:WORD_1
  v_mfma_f32_16x16x32_bf16 v[92:95], v[56:59], v[164:167], v[92:95]
  ds_read_b128 v[52:55], v16 offset:14336
  v_pk_fma_f16 v32, v32, s93, s93
  v_rcp_f16_sdwa v33, v32 dst_sel:WORD_0 dst_unused:UNUSED_PAD src0_sel:WORD_0
  v_mfma_f32_16x16x32_bf16 v[96:99], v[56:59], v[168:171], v[96:99]
  v_rcp_f16_sdwa v33, v32 dst_sel:WORD_1 dst_unused:UNUSED_PRESERVE src0_sel:WORD_1
  v_mfma_f32_16x16x32_bf16 v[100:103], v[56:59], v[172:175], v[100:103]
  v_fma_mix_f32 v32, v88, v33, 0 op_sel_hi:[0,1,0]
  v_fma_mix_f32 v33, v89, v33, 0 op_sel:[0,1,0] op_sel_hi:[0,1,0]
  v_cvt_pk_bf16_f32 v36, v32, v33
  s_waitcnt lgkmcnt(1)
  v_mfma_f32_16x16x32_bf16 v[176:179], v[60:63], v[68:71], v[176:179]
  ds_read_b128 v[56:59], v16 offset:15360
  v_cvt_pk_f16_f32 v34, v90, v91
  v_pk_fma_f16 v35, v34, v34, s92
  v_mfma_f32_16x16x32_bf16 v[184:187], v[60:63], v[72:75], v[184:187]
  v_pk_mul_f16 v35, v35, v34 neg_lo:[1,0] neg_hi:[1,0]
  v_exp_f16_sdwa v34, v35 dst_sel:WORD_0 dst_unused:UNUSED_PAD src0_sel:WORD_0
  v_mfma_f32_16x16x32_bf16 v[192:195], v[60:63], v[76:79], v[192:195]
  v_exp_f16_sdwa v34, v35 dst_sel:WORD_1 dst_unused:UNUSED_PRESERVE src0_sel:WORD_1
  s_setprio 1
  v_mfma_f32_16x16x32_bf16 v[180:183], v[64:67], v[68:71], v[180:183]
  ds_read_b128 v[60:63], v16 offset:16384
  v_pk_fma_f16 v34, v34, s93, s93
  v_rcp_f16_sdwa v35, v34 dst_sel:WORD_0 dst_unused:UNUSED_PAD src0_sel:WORD_0
  v_mfma_f32_16x16x32_bf16 v[188:191], v[64:67], v[72:75], v[188:191]
  v_rcp_f16_sdwa v35, v34 dst_sel:WORD_1 dst_unused:UNUSED_PRESERVE src0_sel:WORD_1
  v_mfma_f32_16x16x32_bf16 v[196:199], v[64:67], v[76:79], v[196:199]
  v_fma_mix_f32 v34, v90, v35, 0 op_sel_hi:[0,1,0]
  v_fma_mix_f32 v35, v91, v35, 0 op_sel:[0,1,0] op_sel_hi:[0,1,0]
  v_cvt_pk_bf16_f32 v37, v34, v35
  ds_write_b64 v19, v[36:37] offset:2048
  s_setprio 0
  s_waitcnt lgkmcnt(2)
  v_mfma_f32_16x16x32_bf16 v[200:203], v[52:55], v[68:71], v[200:203]
  ds_read_b128 v[64:67], v16 offset:17408
  v_cvt_pk_f16_f32 v32, v92, v93
  v_pk_fma_f16 v33, v32, v32, s92
  v_mfma_f32_16x16x32_bf16 v[208:211], v[52:55], v[72:75], v[208:211]
  v_pk_mul_f16 v33, v33, v32 neg_lo:[1,0] neg_hi:[1,0]
  v_exp_f16_sdwa v32, v33 dst_sel:WORD_0 dst_unused:UNUSED_PAD src0_sel:WORD_0
  v_mfma_f32_16x16x32_bf16 v[216:219], v[52:55], v[76:79], v[216:219]
  v_exp_f16_sdwa v32, v33 dst_sel:WORD_1 dst_unused:UNUSED_PRESERVE src0_sel:WORD_1
  v_mfma_f32_16x16x32_bf16 v[204:207], v[56:59], v[68:71], v[204:207]
  s_waitcnt vmcnt(4)
  s_waitcnt lgkmcnt(0)
  s_barrier
  s_setprio 3
  ds_read_b128 v[52:55], v16 offset:24576
  v_pk_fma_f16 v32, v32, s93, s93
  v_rcp_f16_sdwa v33, v32 dst_sel:WORD_0 dst_unused:UNUSED_PAD src0_sel:WORD_0
  v_mfma_f32_16x16x32_bf16 v[212:215], v[56:59], v[72:75], v[212:215]
  v_rcp_f16_sdwa v33, v32 dst_sel:WORD_1 dst_unused:UNUSED_PRESERVE src0_sel:WORD_1
  v_mfma_f32_16x16x32_bf16 v[220:223], v[56:59], v[76:79], v[220:223]
  v_fma_mix_f32 v32, v92, v33, 0 op_sel_hi:[0,1,0]
  v_fma_mix_f32 v33, v93, v33, 0 op_sel:[0,1,0] op_sel_hi:[0,1,0]
  v_cvt_pk_bf16_f32 v36, v32, v33
  v_mfma_f32_16x16x32_bf16 v[224:227], v[60:63], v[68:71], v[224:227]
  ds_read_b128 v[56:59], v16 offset:25600
  v_cvt_pk_f16_f32 v34, v94, v95
  v_pk_fma_f16 v35, v34, v34, s92
  v_mfma_f32_16x16x32_bf16 v[232:235], v[60:63], v[72:75], v[232:235]
  v_pk_mul_f16 v35, v35, v34 neg_lo:[1,0] neg_hi:[1,0]
  v_exp_f16_sdwa v34, v35 dst_sel:WORD_0 dst_unused:UNUSED_PAD src0_sel:WORD_0
  v_mfma_f32_16x16x32_bf16 v[240:243], v[60:63], v[76:79], v[240:243]
  v_exp_f16_sdwa v34, v35 dst_sel:WORD_1 dst_unused:UNUSED_PRESERVE src0_sel:WORD_1
  s_add_u32 m0, s57, 0
  s_mov_b32 s94, 516096
  buffer_load_dwordx4 v20, s[8:11], s94 offen offset:0 lds
  v_mfma_f32_16x16x32_bf16 v[228:231], v[64:67], v[68:71], v[228:231]
  ds_read_b128 v[60:63], v16 offset:26624
  v_pk_fma_f16 v34, v34, s93, s93
  v_rcp_f16_sdwa v35, v34 dst_sel:WORD_0 dst_unused:UNUSED_PAD src0_sel:WORD_0
  v_mfma_f32_16x16x32_bf16 v[236:239], v[64:67], v[72:75], v[236:239]
  v_rcp_f16_sdwa v35, v34 dst_sel:WORD_1 dst_unused:UNUSED_PRESERVE src0_sel:WORD_1
  v_mfma_f32_16x16x32_bf16 v[244:247], v[64:67], v[76:79], v[244:247]
  v_fma_mix_f32 v34, v94, v35, 0 op_sel_hi:[0,1,0]
  v_fma_mix_f32 v35, v95, v35, 0 op_sel:[0,1,0] op_sel_hi:[0,1,0]
  v_cvt_pk_bf16_f32 v37, v34, v35
  ds_write_b64 v19, v[36:37] offset:12288
  s_waitcnt lgkmcnt(2)
  v_mfma_f32_16x16x32_bf16 v[80:83], v[52:55], v[104:107], 0
  ds_read_b128 v[64:67], v16 offset:27648
  ds_read_b128 v[68:71], v18 offset:0
  v_cvt_pk_f16_f32 v32, v96, v97
  v_pk_fma_f16 v33, v32, v32, s92
  v_mfma_f32_16x16x32_bf16 v[84:87], v[52:55], v[108:111], 0
  v_pk_mul_f16 v33, v33, v32 neg_lo:[1,0] neg_hi:[1,0]
  v_exp_f16_sdwa v32, v33 dst_sel:WORD_0 dst_unused:UNUSED_PAD src0_sel:WORD_0
  v_mfma_f32_16x16x32_bf16 v[88:91], v[52:55], v[112:115], 0
  v_exp_f16_sdwa v32, v33 dst_sel:WORD_1 dst_unused:UNUSED_PRESERVE src0_sel:WORD_1
  buffer_load_dwordx4 v20, s[8:11], s94 offen offset:1024 lds
  v_mfma_f32_16x16x32_bf16 v[80:83], v[56:59], v[116:119], v[80:83]
  ds_read_b128 v[52:55], v16 offset:28672
  ds_read_b128 v[72:75], v18 offset:1024
  v_pk_fma_f16 v32, v32, s93, s93
  v_rcp_f16_sdwa v33, v32 dst_sel:WORD_0 dst_unused:UNUSED_PAD src0_sel:WORD_0
  v_mfma_f32_16x16x32_bf16 v[84:87], v[56:59], v[120:123], v[84:87]
  v_rcp_f16_sdwa v33, v32 dst_sel:WORD_1 dst_unused:UNUSED_PRESERVE src0_sel:WORD_1
  v_mfma_f32_16x16x32_bf16 v[88:91], v[56:59], v[124:127], v[88:91]
  v_fma_mix_f32 v32, v96, v33, 0 op_sel_hi:[0,1,0]
  v_fma_mix_f32 v33, v97, v33, 0 op_sel:[0,1,0] op_sel_hi:[0,1,0]
  v_cvt_pk_bf16_f32 v38, v32, v33
  v_lshrrev_b32 v30, 3, v1
  s_add_u32 s71, s59, 256
  buffer_load_ushort v248, v30, s[12:15], s71 offen offset:0
  s_waitcnt lgkmcnt(3)
  v_mfma_f32_16x16x32_bf16 v[80:83], v[60:63], v[128:131], v[80:83]
  ds_read_b128 v[56:59], v16 offset:29696
  ds_read_b128 v[76:79], v18 offset:2048
  v_cvt_pk_f16_f32 v34, v98, v99
  v_pk_fma_f16 v35, v34, v34, s92
  v_mfma_f32_16x16x32_bf16 v[84:87], v[60:63], v[132:135], v[84:87]
  v_pk_mul_f16 v35, v35, v34 neg_lo:[1,0] neg_hi:[1,0]
  v_exp_f16_sdwa v34, v35 dst_sel:WORD_0 dst_unused:UNUSED_PAD src0_sel:WORD_0
  v_mfma_f32_16x16x32_bf16 v[88:91], v[60:63], v[136:139], v[88:91]
  v_exp_f16_sdwa v34, v35 dst_sel:WORD_1 dst_unused:UNUSED_PRESERVE src0_sel:WORD_1
  buffer_load_dwordx4 v20, s[8:11], s94 offen offset:2048 lds
  buffer_load_ushort v249, v30, s[12:15], s71 offen offset:384
  v_mfma_f32_16x16x32_bf16 v[80:83], v[64:67], v[140:143], v[80:83]
  ds_read_b128 v[60:63], v16 offset:36864
  v_pk_fma_f16 v34, v34, s93, s93
  v_rcp_f16_sdwa v35, v34 dst_sel:WORD_0 dst_unused:UNUSED_PAD src0_sel:WORD_0
  v_mfma_f32_16x16x32_bf16 v[84:87], v[64:67], v[144:147], v[84:87]
  v_rcp_f16_sdwa v35, v34 dst_sel:WORD_1 dst_unused:UNUSED_PRESERVE src0_sel:WORD_1
  v_mfma_f32_16x16x32_bf16 v[88:91], v[64:67], v[148:151], v[88:91]
  v_fma_mix_f32 v34, v98, v35, 0 op_sel_hi:[0,1,0]
  v_fma_mix_f32 v35, v99, v35, 0 op_sel:[0,1,0] op_sel_hi:[0,1,0]
  v_cvt_pk_bf16_f32 v39, v34, v35
  ds_write_b64 v19, v[38:39] offset:13312
  buffer_load_ushort v250, v30, s[12:15], s71 offen offset:768
  s_setprio 2
  s_waitcnt lgkmcnt(3)
  v_mfma_f32_16x16x32_bf16 v[80:83], v[52:55], v[152:155], v[80:83]
  ds_read_b128 v[64:67], v16 offset:37888
  v_cvt_pk_f16_f32 v32, v100, v101
  v_pk_fma_f16 v33, v32, v32, s92
  v_mfma_f32_16x16x32_bf16 v[84:87], v[52:55], v[156:159], v[84:87]
  v_pk_mul_f16 v33, v33, v32 neg_lo:[1,0] neg_hi:[1,0]
  v_exp_f16_sdwa v32, v33 dst_sel:WORD_0 dst_unused:UNUSED_PAD src0_sel:WORD_0
  v_mfma_f32_16x16x32_bf16 v[88:91], v[52:55], v[160:163], v[88:91]
  v_exp_f16_sdwa v32, v33 dst_sel:WORD_1 dst_unused:UNUSED_PRESERVE src0_sel:WORD_1
  buffer_load_ushort v251, v30, s[12:15], s71 offen offset:1152
  v_mfma_f32_16x16x32_bf16 v[80:83], v[56:59], v[164:167], v[80:83]
  ds_read_b128 v[52:55], v16 offset:38912
  v_pk_fma_f16 v32, v32, s93, s93
  v_rcp_f16_sdwa v33, v32 dst_sel:WORD_0 dst_unused:UNUSED_PAD src0_sel:WORD_0
  v_mfma_f32_16x16x32_bf16 v[84:87], v[56:59], v[168:171], v[84:87]
  v_rcp_f16_sdwa v33, v32 dst_sel:WORD_1 dst_unused:UNUSED_PRESERVE src0_sel:WORD_1
  v_mfma_f32_16x16x32_bf16 v[88:91], v[56:59], v[172:175], v[88:91]
  v_fma_mix_f32 v32, v100, v33, 0 op_sel_hi:[0,1,0]
  v_fma_mix_f32 v33, v101, v33, 0 op_sel:[0,1,0] op_sel_hi:[0,1,0]
  v_cvt_pk_bf16_f32 v36, v32, v33
  buffer_load_ushort v252, v30, s[12:15], s71 offen offset:1536
  s_waitcnt lgkmcnt(1)
  v_mfma_f32_16x16x32_bf16 v[176:179], v[60:63], v[68:71], v[176:179]
  ds_read_b128 v[56:59], v16 offset:39936
  v_cvt_pk_f16_f32 v34, v102, v103
  v_pk_fma_f16 v35, v34, v34, s92
  v_mfma_f32_16x16x32_bf16 v[184:187], v[60:63], v[72:75], v[184:187]
  v_pk_mul_f16 v35, v35, v34 neg_lo:[1,0] neg_hi:[1,0]
  v_exp_f16_sdwa v34, v35 dst_sel:WORD_0 dst_unused:UNUSED_PAD src0_sel:WORD_0
  v_mfma_f32_16x16x32_bf16 v[192:195], v[60:63], v[76:79], v[192:195]
  v_exp_f16_sdwa v34, v35 dst_sel:WORD_1 dst_unused:UNUSED_PRESERVE src0_sel:WORD_1
  buffer_load_ushort v253, v30, s[12:15], s71 offen offset:1920
  s_setprio 1
  v_mfma_f32_16x16x32_bf16 v[180:183], v[64:67], v[68:71], v[180:183]
  ds_read_b128 v[60:63], v16 offset:40960
  v_pk_fma_f16 v34, v34, s93, s93
  v_rcp_f16_sdwa v35, v34 dst_sel:WORD_0 dst_unused:UNUSED_PAD src0_sel:WORD_0
  v_mfma_f32_16x16x32_bf16 v[188:191], v[64:67], v[72:75], v[188:191]
  v_rcp_f16_sdwa v35, v34 dst_sel:WORD_1 dst_unused:UNUSED_PRESERVE src0_sel:WORD_1
  v_mfma_f32_16x16x32_bf16 v[196:199], v[64:67], v[76:79], v[196:199]
  v_fma_mix_f32 v34, v102, v35, 0 op_sel_hi:[0,1,0]
  v_fma_mix_f32 v35, v103, v35, 0 op_sel:[0,1,0] op_sel_hi:[0,1,0]
  v_cvt_pk_bf16_f32 v37, v34, v35
  ds_write_b64 v19, v[36:37] offset:14336
  buffer_load_ushort v254, v30, s[12:15], s71 offen offset:2304
  s_setprio 0
  s_waitcnt lgkmcnt(2)
  v_mfma_f32_16x16x32_bf16 v[200:203], v[52:55], v[68:71], v[200:203]
  ds_read_b128 v[64:67], v16 offset:41984
  v_cvt_pk_f16_f32 v32, v80, v81
  v_pk_fma_f16 v33, v32, v32, s92
  v_mfma_f32_16x16x32_bf16 v[208:211], v[52:55], v[72:75], v[208:211]
  v_pk_mul_f16 v33, v33, v32 neg_lo:[1,0] neg_hi:[1,0]
  v_exp_f16_sdwa v32, v33 dst_sel:WORD_0 dst_unused:UNUSED_PAD src0_sel:WORD_0
  v_mfma_f32_16x16x32_bf16 v[216:219], v[52:55], v[76:79], v[216:219]
  v_exp_f16_sdwa v32, v33 dst_sel:WORD_1 dst_unused:UNUSED_PRESERVE src0_sel:WORD_1
  v_mfma_f32_16x16x32_bf16 v[204:207], v[56:59], v[68:71], v[204:207]
  s_waitcnt vmcnt(10)
  s_waitcnt lgkmcnt(0)
  s_barrier
  s_setprio 3
  ds_read_b128 v[52:55], v17 offset:0
  v_pk_fma_f16 v32, v32, s93, s93
  v_rcp_f16_sdwa v33, v32 dst_sel:WORD_0 dst_unused:UNUSED_PAD src0_sel:WORD_0
  v_mfma_f32_16x16x32_bf16 v[212:215], v[56:59], v[72:75], v[212:215]
  v_rcp_f16_sdwa v33, v32 dst_sel:WORD_1 dst_unused:UNUSED_PRESERVE src0_sel:WORD_1
  v_mfma_f32_16x16x32_bf16 v[220:223], v[56:59], v[76:79], v[220:223]
  v_fma_mix_f32 v32, v80, v33, 0 op_sel_hi:[0,1,0]
  v_fma_mix_f32 v33, v81, v33, 0 op_sel:[0,1,0] op_sel_hi:[0,1,0]
  v_cvt_pk_bf16_f32 v36, v32, v33
  v_mfma_f32_16x16x32_bf16 v[224:227], v[60:63], v[68:71], v[224:227]
  ds_read_b128 v[56:59], v17 offset:1024
  v_cvt_pk_f16_f32 v34, v82, v83
  v_pk_fma_f16 v35, v34, v34, s92
  v_mfma_f32_16x16x32_bf16 v[232:235], v[60:63], v[72:75], v[232:235]
  v_pk_mul_f16 v35, v35, v34 neg_lo:[1,0] neg_hi:[1,0]
  v_exp_f16_sdwa v34, v35 dst_sel:WORD_0 dst_unused:UNUSED_PAD src0_sel:WORD_0
  v_mfma_f32_16x16x32_bf16 v[240:243], v[60:63], v[76:79], v[240:243]
  v_exp_f16_sdwa v34, v35 dst_sel:WORD_1 dst_unused:UNUSED_PRESERVE src0_sel:WORD_1
  s_add_u32 m0, s57, 24576
  s_mov_b32 s94, 540672
  buffer_load_dwordx4 v20, s[8:11], s94 offen offset:0 lds
  v_mfma_f32_16x16x32_bf16 v[228:231], v[64:67], v[68:71], v[228:231]
  ds_read_b128 v[60:63], v17 offset:2048
  v_pk_fma_f16 v34, v34, s93, s93
  v_rcp_f16_sdwa v35, v34 dst_sel:WORD_0 dst_unused:UNUSED_PAD src0_sel:WORD_0
  v_mfma_f32_16x16x32_bf16 v[236:239], v[64:67], v[72:75], v[236:239]
  v_rcp_f16_sdwa v35, v34 dst_sel:WORD_1 dst_unused:UNUSED_PRESERVE src0_sel:WORD_1
  v_mfma_f32_16x16x32_bf16 v[244:247], v[64:67], v[76:79], v[244:247]
  v_fma_mix_f32 v34, v82, v35, 0 op_sel_hi:[0,1,0]
  v_fma_mix_f32 v35, v83, v35, 0 op_sel:[0,1,0] op_sel_hi:[0,1,0]
  v_cvt_pk_bf16_f32 v37, v34, v35
  ds_write_b64 v19, v[36:37] offset:0
  s_waitcnt lgkmcnt(2)
  v_mfma_f32_16x16x32_bf16 v[92:95], v[52:55], v[104:107], 0
  ds_read_b128 v[64:67], v17 offset:3072
  ds_read_b128 v[68:71], v18 offset:12288
  v_cvt_pk_f16_f32 v32, v84, v85
  v_pk_fma_f16 v33, v32, v32, s92
  v_mfma_f32_16x16x32_bf16 v[96:99], v[52:55], v[108:111], 0
  v_pk_mul_f16 v33, v33, v32 neg_lo:[1,0] neg_hi:[1,0]
  v_exp_f16_sdwa v32, v33 dst_sel:WORD_0 dst_unused:UNUSED_PAD src0_sel:WORD_0
  v_mfma_f32_16x16x32_bf16 v[100:103], v[52:55], v[112:115], 0
  v_exp_f16_sdwa v32, v33 dst_sel:WORD_1 dst_unused:UNUSED_PRESERVE src0_sel:WORD_1
  buffer_load_dwordx4 v20, s[8:11], s94 offen offset:1024 lds
  v_mfma_f32_16x16x32_bf16 v[92:95], v[56:59], v[116:119], v[92:95]
  ds_read_b128 v[52:55], v17 offset:4096
  ds_read_b128 v[72:75], v18 offset:13312
  v_pk_fma_f16 v32, v32, s93, s93
  v_rcp_f16_sdwa v33, v32 dst_sel:WORD_0 dst_unused:UNUSED_PAD src0_sel:WORD_0
  v_mfma_f32_16x16x32_bf16 v[96:99], v[56:59], v[120:123], v[96:99]
  v_rcp_f16_sdwa v33, v32 dst_sel:WORD_1 dst_unused:UNUSED_PRESERVE src0_sel:WORD_1
  v_mfma_f32_16x16x32_bf16 v[100:103], v[56:59], v[124:127], v[100:103]
  v_fma_mix_f32 v32, v84, v33, 0 op_sel_hi:[0,1,0]
  v_fma_mix_f32 v33, v85, v33, 0 op_sel:[0,1,0] op_sel_hi:[0,1,0]
  v_cvt_pk_bf16_f32 v38, v32, v33
  s_waitcnt lgkmcnt(3)
  v_mfma_f32_16x16x32_bf16 v[92:95], v[60:63], v[128:131], v[92:95]
  ds_read_b128 v[56:59], v17 offset:5120
  ds_read_b128 v[76:79], v18 offset:14336
  v_cvt_pk_f16_f32 v34, v86, v87
  v_pk_fma_f16 v35, v34, v34, s92
  v_mfma_f32_16x16x32_bf16 v[96:99], v[60:63], v[132:135], v[96:99]
  v_pk_mul_f16 v35, v35, v34 neg_lo:[1,0] neg_hi:[1,0]
  v_exp_f16_sdwa v34, v35 dst_sel:WORD_0 dst_unused:UNUSED_PAD src0_sel:WORD_0
  v_mfma_f32_16x16x32_bf16 v[100:103], v[60:63], v[136:139], v[100:103]
  v_exp_f16_sdwa v34, v35 dst_sel:WORD_1 dst_unused:UNUSED_PRESERVE src0_sel:WORD_1
  buffer_load_dwordx4 v20, s[8:11], s94 offen offset:2048 lds
  v_mfma_f32_16x16x32_bf16 v[92:95], v[64:67], v[140:143], v[92:95]
  ds_read_b128 v[60:63], v17 offset:12288
  v_pk_fma_f16 v34, v34, s93, s93
  v_rcp_f16_sdwa v35, v34 dst_sel:WORD_0 dst_unused:UNUSED_PAD src0_sel:WORD_0
  v_mfma_f32_16x16x32_bf16 v[96:99], v[64:67], v[144:147], v[96:99]
  v_rcp_f16_sdwa v35, v34 dst_sel:WORD_1 dst_unused:UNUSED_PRESERVE src0_sel:WORD_1
  v_mfma_f32_16x16x32_bf16 v[100:103], v[64:67], v[148:151], v[100:103]
  v_fma_mix_f32 v34, v86, v35, 0 op_sel_hi:[0,1,0]
  v_fma_mix_f32 v35, v87, v35, 0 op_sel:[0,1,0] op_sel_hi:[0,1,0]
  v_cvt_pk_bf16_f32 v39, v34, v35
  ds_write_b64 v19, v[38:39] offset:1024
  s_setprio 2
  s_waitcnt lgkmcnt(3)
  v_mfma_f32_16x16x32_bf16 v[92:95], v[52:55], v[152:155], v[92:95]
  ds_read_b128 v[64:67], v17 offset:13312
  v_cvt_pk_f16_f32 v32, v88, v89
  v_pk_fma_f16 v33, v32, v32, s92
  v_mfma_f32_16x16x32_bf16 v[96:99], v[52:55], v[156:159], v[96:99]
  v_pk_mul_f16 v33, v33, v32 neg_lo:[1,0] neg_hi:[1,0]
  v_exp_f16_sdwa v32, v33 dst_sel:WORD_0 dst_unused:UNUSED_PAD src0_sel:WORD_0
  v_mfma_f32_16x16x32_bf16 v[100:103], v[52:55], v[160:163], v[100:103]
  v_exp_f16_sdwa v32, v33 dst_sel:WORD_1 dst_unused:UNUSED_PRESERVE src0_sel:WORD_1
  v_mfma_f32_16x16x32_bf16 v[92:95], v[56:59], v[164:167], v[92:95]
  ds_read_b128 v[52:55], v17 offset:14336
  v_pk_fma_f16 v32, v32, s93, s93
  v_rcp_f16_sdwa v33, v32 dst_sel:WORD_0 dst_unused:UNUSED_PAD src0_sel:WORD_0
  v_mfma_f32_16x16x32_bf16 v[96:99], v[56:59], v[168:171], v[96:99]
  v_rcp_f16_sdwa v33, v32 dst_sel:WORD_1 dst_unused:UNUSED_PRESERVE src0_sel:WORD_1
  v_mfma_f32_16x16x32_bf16 v[100:103], v[56:59], v[172:175], v[100:103]
  v_fma_mix_f32 v32, v88, v33, 0 op_sel_hi:[0,1,0]
  v_fma_mix_f32 v33, v89, v33, 0 op_sel:[0,1,0] op_sel_hi:[0,1,0]
  v_cvt_pk_bf16_f32 v36, v32, v33
  s_waitcnt lgkmcnt(1)
  v_mfma_f32_16x16x32_bf16 v[176:179], v[60:63], v[68:71], v[176:179]
  ds_read_b128 v[56:59], v17 offset:15360
  v_cvt_pk_f16_f32 v34, v90, v91
  v_pk_fma_f16 v35, v34, v34, s92
  v_mfma_f32_16x16x32_bf16 v[184:187], v[60:63], v[72:75], v[184:187]
  v_pk_mul_f16 v35, v35, v34 neg_lo:[1,0] neg_hi:[1,0]
  v_exp_f16_sdwa v34, v35 dst_sel:WORD_0 dst_unused:UNUSED_PAD src0_sel:WORD_0
  v_mfma_f32_16x16x32_bf16 v[192:195], v[60:63], v[76:79], v[192:195]
  v_exp_f16_sdwa v34, v35 dst_sel:WORD_1 dst_unused:UNUSED_PRESERVE src0_sel:WORD_1
  s_setprio 1
  v_mfma_f32_16x16x32_bf16 v[180:183], v[64:67], v[68:71], v[180:183]
  ds_read_b128 v[60:63], v17 offset:16384
  v_pk_fma_f16 v34, v34, s93, s93
  v_rcp_f16_sdwa v35, v34 dst_sel:WORD_0 dst_unused:UNUSED_PAD src0_sel:WORD_0
  v_mfma_f32_16x16x32_bf16 v[188:191], v[64:67], v[72:75], v[188:191]
  v_rcp_f16_sdwa v35, v34 dst_sel:WORD_1 dst_unused:UNUSED_PRESERVE src0_sel:WORD_1
  v_mfma_f32_16x16x32_bf16 v[196:199], v[64:67], v[76:79], v[196:199]
  v_fma_mix_f32 v34, v90, v35, 0 op_sel_hi:[0,1,0]
  v_fma_mix_f32 v35, v91, v35, 0 op_sel:[0,1,0] op_sel_hi:[0,1,0]
  v_cvt_pk_bf16_f32 v37, v34, v35
  ds_write_b64 v19, v[36:37] offset:2048
  s_setprio 0
  s_waitcnt lgkmcnt(2)
  v_mfma_f32_16x16x32_bf16 v[200:203], v[52:55], v[68:71], v[200:203]
  ds_read_b128 v[64:67], v17 offset:17408
  v_cvt_pk_f16_f32 v32, v92, v93
  v_pk_fma_f16 v33, v32, v32, s92
  v_mfma_f32_16x16x32_bf16 v[208:211], v[52:55], v[72:75], v[208:211]
  v_pk_mul_f16 v33, v33, v32 neg_lo:[1,0] neg_hi:[1,0]
  v_exp_f16_sdwa v32, v33 dst_sel:WORD_0 dst_unused:UNUSED_PAD src0_sel:WORD_0
  v_mfma_f32_16x16x32_bf16 v[216:219], v[52:55], v[76:79], v[216:219]
  v_exp_f16_sdwa v32, v33 dst_sel:WORD_1 dst_unused:UNUSED_PRESERVE src0_sel:WORD_1
  v_mfma_f32_16x16x32_bf16 v[204:207], v[56:59], v[68:71], v[204:207]
  s_waitcnt vmcnt(9)
  s_waitcnt lgkmcnt(0)
  s_barrier
  s_setprio 3
  ds_read_b128 v[52:55], v16 offset:0
  v_pk_fma_f16 v32, v32, s93, s93
  v_rcp_f16_sdwa v33, v32 dst_sel:WORD_0 dst_unused:UNUSED_PAD src0_sel:WORD_0
  v_mfma_f32_16x16x32_bf16 v[212:215], v[56:59], v[72:75], v[212:215]
  v_rcp_f16_sdwa v33, v32 dst_sel:WORD_1 dst_unused:UNUSED_PRESERVE src0_sel:WORD_1
  v_mfma_f32_16x16x32_bf16 v[220:223], v[56:59], v[76:79], v[220:223]
  v_fma_mix_f32 v32, v92, v33, 0 op_sel_hi:[0,1,0]
  v_fma_mix_f32 v33, v93, v33, 0 op_sel:[0,1,0] op_sel_hi:[0,1,0]
  v_cvt_pk_bf16_f32 v36, v32, v33
  v_mfma_f32_16x16x32_bf16 v[224:227], v[60:63], v[68:71], v[224:227]
  ds_read_b128 v[56:59], v16 offset:1024
  v_cvt_pk_f16_f32 v34, v94, v95
  v_pk_fma_f16 v35, v34, v34, s92
  v_mfma_f32_16x16x32_bf16 v[232:235], v[60:63], v[72:75], v[232:235]
  v_pk_mul_f16 v35, v35, v34 neg_lo:[1,0] neg_hi:[1,0]
  v_exp_f16_sdwa v34, v35 dst_sel:WORD_0 dst_unused:UNUSED_PAD src0_sel:WORD_0
  v_mfma_f32_16x16x32_bf16 v[240:243], v[60:63], v[76:79], v[240:243]
  v_exp_f16_sdwa v34, v35 dst_sel:WORD_1 dst_unused:UNUSED_PRESERVE src0_sel:WORD_1
  s_cmp_eq_u32 s35, 0
  s_cbranch_scc1 standalone__convnext_block__vision_kernel_ws23_0
  s_add_u32 m0, s57, 49152
  s_mov_b32 s94, 565248
  buffer_load_dwordx4 v20, s[8:11], s94 offen offset:0 lds
standalone__convnext_block__vision_kernel_ws23_0:
  v_mfma_f32_16x16x32_bf16 v[228:231], v[64:67], v[68:71], v[228:231]
  ds_read_b128 v[60:63], v16 offset:2048
  v_pk_fma_f16 v34, v34, s93, s93
  v_rcp_f16_sdwa v35, v34 dst_sel:WORD_0 dst_unused:UNUSED_PAD src0_sel:WORD_0
  v_mfma_f32_16x16x32_bf16 v[236:239], v[64:67], v[72:75], v[236:239]
  v_rcp_f16_sdwa v35, v34 dst_sel:WORD_1 dst_unused:UNUSED_PRESERVE src0_sel:WORD_1
  v_mfma_f32_16x16x32_bf16 v[244:247], v[64:67], v[76:79], v[244:247]
  v_fma_mix_f32 v34, v94, v35, 0 op_sel_hi:[0,1,0]
  v_fma_mix_f32 v35, v95, v35, 0 op_sel:[0,1,0] op_sel_hi:[0,1,0]
  v_cvt_pk_bf16_f32 v37, v34, v35
  ds_write_b64 v19, v[36:37] offset:12288
  s_waitcnt lgkmcnt(2)
  v_mfma_f32_16x16x32_bf16 v[80:83], v[52:55], v[104:107], 0
  ds_read_b128 v[64:67], v16 offset:3072
  ds_read_b128 v[68:71], v18 offset:0
  v_cvt_pk_f16_f32 v32, v96, v97
  v_pk_fma_f16 v33, v32, v32, s92
  v_mfma_f32_16x16x32_bf16 v[84:87], v[52:55], v[108:111], 0
  v_pk_mul_f16 v33, v33, v32 neg_lo:[1,0] neg_hi:[1,0]
  v_exp_f16_sdwa v32, v33 dst_sel:WORD_0 dst_unused:UNUSED_PAD src0_sel:WORD_0
  v_mfma_f32_16x16x32_bf16 v[88:91], v[52:55], v[112:115], 0
  v_exp_f16_sdwa v32, v33 dst_sel:WORD_1 dst_unused:UNUSED_PRESERVE src0_sel:WORD_1
  s_cmp_eq_u32 s35, 0
  s_cbranch_scc1 standalone__convnext_block__vision_kernel_ws23_1
  buffer_load_dwordx4 v20, s[8:11], s94 offen offset:1024 lds
standalone__convnext_block__vision_kernel_ws23_1:
  v_mfma_f32_16x16x32_bf16 v[80:83], v[56:59], v[116:119], v[80:83]
  ds_read_b128 v[52:55], v16 offset:4096
  ds_read_b128 v[72:75], v18 offset:1024
  v_pk_fma_f16 v32, v32, s93, s93
  v_rcp_f16_sdwa v33, v32 dst_sel:WORD_0 dst_unused:UNUSED_PAD src0_sel:WORD_0
  v_mfma_f32_16x16x32_bf16 v[84:87], v[56:59], v[120:123], v[84:87]
  v_rcp_f16_sdwa v33, v32 dst_sel:WORD_1 dst_unused:UNUSED_PRESERVE src0_sel:WORD_1
  v_mfma_f32_16x16x32_bf16 v[88:91], v[56:59], v[124:127], v[88:91]
  v_fma_mix_f32 v32, v96, v33, 0 op_sel_hi:[0,1,0]
  v_fma_mix_f32 v33, v97, v33, 0 op_sel:[0,1,0] op_sel_hi:[0,1,0]
  v_cvt_pk_bf16_f32 v38, v32, v33
  s_waitcnt lgkmcnt(3)
  v_mfma_f32_16x16x32_bf16 v[80:83], v[60:63], v[128:131], v[80:83]
  ds_read_b128 v[56:59], v16 offset:5120
  ds_read_b128 v[76:79], v18 offset:2048
  v_cvt_pk_f16_f32 v34, v98, v99
  v_pk_fma_f16 v35, v34, v34, s92
  v_mfma_f32_16x16x32_bf16 v[84:87], v[60:63], v[132:135], v[84:87]
  v_pk_mul_f16 v35, v35, v34 neg_lo:[1,0] neg_hi:[1,0]
  v_exp_f16_sdwa v34, v35 dst_sel:WORD_0 dst_unused:UNUSED_PAD src0_sel:WORD_0
  v_mfma_f32_16x16x32_bf16 v[88:91], v[60:63], v[136:139], v[88:91]
  v_exp_f16_sdwa v34, v35 dst_sel:WORD_1 dst_unused:UNUSED_PRESERVE src0_sel:WORD_1
  s_cmp_eq_u32 s35, 0
  s_cbranch_scc1 standalone__convnext_block__vision_kernel_ws23_2
  buffer_load_dwordx4 v20, s[8:11], s94 offen offset:2048 lds
standalone__convnext_block__vision_kernel_ws23_2:
  v_mfma_f32_16x16x32_bf16 v[80:83], v[64:67], v[140:143], v[80:83]
  ds_read_b128 v[60:63], v16 offset:12288
  v_pk_fma_f16 v34, v34, s93, s93
  v_rcp_f16_sdwa v35, v34 dst_sel:WORD_0 dst_unused:UNUSED_PAD src0_sel:WORD_0
  v_mfma_f32_16x16x32_bf16 v[84:87], v[64:67], v[144:147], v[84:87]
  v_rcp_f16_sdwa v35, v34 dst_sel:WORD_1 dst_unused:UNUSED_PRESERVE src0_sel:WORD_1
  v_mfma_f32_16x16x32_bf16 v[88:91], v[64:67], v[148:151], v[88:91]
  v_fma_mix_f32 v34, v98, v35, 0 op_sel_hi:[0,1,0]
  v_fma_mix_f32 v35, v99, v35, 0 op_sel:[0,1,0] op_sel_hi:[0,1,0]
  v_cvt_pk_bf16_f32 v39, v34, v35
  ds_write_b64 v19, v[38:39] offset:13312
  s_setprio 2
  s_waitcnt lgkmcnt(3)
  v_mfma_f32_16x16x32_bf16 v[80:83], v[52:55], v[152:155], v[80:83]
  ds_read_b128 v[64:67], v16 offset:13312
  v_cvt_pk_f16_f32 v32, v100, v101
  v_pk_fma_f16 v33, v32, v32, s92
  v_mfma_f32_16x16x32_bf16 v[84:87], v[52:55], v[156:159], v[84:87]
  v_pk_mul_f16 v33, v33, v32 neg_lo:[1,0] neg_hi:[1,0]
  v_exp_f16_sdwa v32, v33 dst_sel:WORD_0 dst_unused:UNUSED_PAD src0_sel:WORD_0
  v_mfma_f32_16x16x32_bf16 v[88:91], v[52:55], v[160:163], v[88:91]
  v_exp_f16_sdwa v32, v33 dst_sel:WORD_1 dst_unused:UNUSED_PRESERVE src0_sel:WORD_1
  v_mfma_f32_16x16x32_bf16 v[80:83], v[56:59], v[164:167], v[80:83]
  ds_read_b128 v[52:55], v16 offset:14336
  v_pk_fma_f16 v32, v32, s93, s93
  v_rcp_f16_sdwa v33, v32 dst_sel:WORD_0 dst_unused:UNUSED_PAD src0_sel:WORD_0
  v_mfma_f32_16x16x32_bf16 v[84:87], v[56:59], v[168:171], v[84:87]
  v_rcp_f16_sdwa v33, v32 dst_sel:WORD_1 dst_unused:UNUSED_PRESERVE src0_sel:WORD_1
  v_mfma_f32_16x16x32_bf16 v[88:91], v[56:59], v[172:175], v[88:91]
  v_fma_mix_f32 v32, v100, v33, 0 op_sel_hi:[0,1,0]
  v_fma_mix_f32 v33, v101, v33, 0 op_sel:[0,1,0] op_sel_hi:[0,1,0]
  v_cvt_pk_bf16_f32 v36, v32, v33
  s_waitcnt lgkmcnt(1)
  v_mfma_f32_16x16x32_bf16 v[176:179], v[60:63], v[68:71], v[176:179]
  ds_read_b128 v[56:59], v16 offset:15360
  v_cvt_pk_f16_f32 v34, v102, v103
  v_pk_fma_f16 v35, v34, v34, s92
  v_mfma_f32_16x16x32_bf16 v[184:187], v[60:63], v[72:75], v[184:187]
  v_pk_mul_f16 v35, v35, v34 neg_lo:[1,0] neg_hi:[1,0]
  v_exp_f16_sdwa v34, v35 dst_sel:WORD_0 dst_unused:UNUSED_PAD src0_sel:WORD_0
  v_mfma_f32_16x16x32_bf16 v[192:195], v[60:63], v[76:79], v[192:195]
  v_exp_f16_sdwa v34, v35 dst_sel:WORD_1 dst_unused:UNUSED_PRESERVE src0_sel:WORD_1
  s_setprio 1
  v_mfma_f32_16x16x32_bf16 v[180:183], v[64:67], v[68:71], v[180:183]
  ds_read_b128 v[60:63], v16 offset:16384
  v_pk_fma_f16 v34, v34, s93, s93
  v_rcp_f16_sdwa v35, v34 dst_sel:WORD_0 dst_unused:UNUSED_PAD src0_sel:WORD_0
  v_mfma_f32_16x16x32_bf16 v[188:191], v[64:67], v[72:75], v[188:191]
  v_rcp_f16_sdwa v35, v34 dst_sel:WORD_1 dst_unused:UNUSED_PRESERVE src0_sel:WORD_1
  v_mfma_f32_16x16x32_bf16 v[196:199], v[64:67], v[76:79], v[196:199]
  v_fma_mix_f32 v34, v102, v35, 0 op_sel_hi:[0,1,0]
  v_fma_mix_f32 v35, v103, v35, 0 op_sel:[0,1,0] op_sel_hi:[0,1,0]
  v_cvt_pk_bf16_f32 v37, v34, v35
  ds_write_b64 v19, v[36:37] offset:14336
  s_setprio 0
  s_waitcnt lgkmcnt(2)
  v_mfma_f32_16x16x32_bf16 v[200:203], v[52:55], v[68:71], v[200:203]
  ds_read_b128 v[64:67], v16 offset:17408
  v_cvt_pk_f16_f32 v32, v80, v81
  v_pk_fma_f16 v33, v32, v32, s92
  v_mfma_f32_16x16x32_bf16 v[208:211], v[52:55], v[72:75], v[208:211]
  v_pk_mul_f16 v33, v33, v32 neg_lo:[1,0] neg_hi:[1,0]
  v_exp_f16_sdwa v32, v33 dst_sel:WORD_0 dst_unused:UNUSED_PAD src0_sel:WORD_0
  v_mfma_f32_16x16x32_bf16 v[216:219], v[52:55], v[76:79], v[216:219]
  v_exp_f16_sdwa v32, v33 dst_sel:WORD_1 dst_unused:UNUSED_PRESERVE src0_sel:WORD_1
  v_mfma_f32_16x16x32_bf16 v[204:207], v[56:59], v[68:71], v[204:207]
  s_waitcnt vmcnt(0)
  s_waitcnt lgkmcnt(0)
  s_barrier
  s_setprio 3
  ds_read_b128 v[52:55], v16 offset:24576
  v_pk_fma_f16 v32, v32, s93, s93
  v_rcp_f16_sdwa v33, v32 dst_sel:WORD_0 dst_unused:UNUSED_PAD src0_sel:WORD_0
  v_mfma_f32_16x16x32_bf16 v[212:215], v[56:59], v[72:75], v[212:215]
  v_rcp_f16_sdwa v33, v32 dst_sel:WORD_1 dst_unused:UNUSED_PRESERVE src0_sel:WORD_1
  v_mfma_f32_16x16x32_bf16 v[220:223], v[56:59], v[76:79], v[220:223]
  v_fma_mix_f32 v32, v80, v33, 0 op_sel_hi:[0,1,0]
  v_fma_mix_f32 v33, v81, v33, 0 op_sel:[0,1,0] op_sel_hi:[0,1,0]
  v_cvt_pk_bf16_f32 v36, v32, v33
  v_mfma_f32_16x16x32_bf16 v[224:227], v[60:63], v[68:71], v[224:227]
  ds_read_b128 v[56:59], v16 offset:25600
  v_cvt_pk_f16_f32 v34, v82, v83
  v_pk_fma_f16 v35, v34, v34, s92
  v_mfma_f32_16x16x32_bf16 v[232:235], v[60:63], v[72:75], v[232:235]
  v_pk_mul_f16 v35, v35, v34 neg_lo:[1,0] neg_hi:[1,0]
  v_exp_f16_sdwa v34, v35 dst_sel:WORD_0 dst_unused:UNUSED_PAD src0_sel:WORD_0
  v_mfma_f32_16x16x32_bf16 v[240:243], v[60:63], v[76:79], v[240:243]
  v_exp_f16_sdwa v34, v35 dst_sel:WORD_1 dst_unused:UNUSED_PRESERVE src0_sel:WORD_1
  s_cmp_eq_u32 s35, 0
  s_cbranch_scc1 standalone__convnext_block__vision_kernel_ws24_0
  s_add_u32 m0, s57, 36864
  s_mov_b32 s94, 0
  buffer_load_dwordx4 v20, s[8:11], s94 offen offset:0 lds
standalone__convnext_block__vision_kernel_ws24_0:
  v_mfma_f32_16x16x32_bf16 v[228:231], v[64:67], v[68:71], v[228:231]
  ds_read_b128 v[60:63], v16 offset:26624
  v_pk_fma_f16 v34, v34, s93, s93
  v_rcp_f16_sdwa v35, v34 dst_sel:WORD_0 dst_unused:UNUSED_PAD src0_sel:WORD_0
  v_mfma_f32_16x16x32_bf16 v[236:239], v[64:67], v[72:75], v[236:239]
  v_rcp_f16_sdwa v35, v34 dst_sel:WORD_1 dst_unused:UNUSED_PRESERVE src0_sel:WORD_1
  v_mfma_f32_16x16x32_bf16 v[244:247], v[64:67], v[76:79], v[244:247]
  v_fma_mix_f32 v34, v82, v35, 0 op_sel_hi:[0,1,0]
  v_fma_mix_f32 v35, v83, v35, 0 op_sel:[0,1,0] op_sel_hi:[0,1,0]
  v_cvt_pk_bf16_f32 v37, v34, v35
  ds_write_b64 v19, v[36:37] offset:0
  s_waitcnt lgkmcnt(2)
  v_mfma_f32_16x16x32_bf16 v[92:95], v[52:55], v[104:107], 0
  ds_read_b128 v[64:67], v16 offset:27648
  ds_read_b128 v[68:71], v18 offset:12288
  v_cvt_pk_f16_f32 v32, v84, v85
  v_pk_fma_f16 v33, v32, v32, s92
  v_mfma_f32_16x16x32_bf16 v[96:99], v[52:55], v[108:111], 0
  v_pk_mul_f16 v33, v33, v32 neg_lo:[1,0] neg_hi:[1,0]
  v_exp_f16_sdwa v32, v33 dst_sel:WORD_0 dst_unused:UNUSED_PAD src0_sel:WORD_0
  v_mfma_f32_16x16x32_bf16 v[100:103], v[52:55], v[112:115], 0
  v_exp_f16_sdwa v32, v33 dst_sel:WORD_1 dst_unused:UNUSED_PRESERVE src0_sel:WORD_1
  s_cmp_eq_u32 s35, 0
  s_cbranch_scc1 standalone__convnext_block__vision_kernel_ws24_1
  buffer_load_dwordx4 v20, s[8:11], s94 offen offset:1024 lds
standalone__convnext_block__vision_kernel_ws24_1:
  v_mfma_f32_16x16x32_bf16 v[92:95], v[56:59], v[116:119], v[92:95]
  ds_read_b128 v[52:55], v16 offset:28672
  ds_read_b128 v[72:75], v18 offset:13312
  v_pk_fma_f16 v32, v32, s93, s93
  v_rcp_f16_sdwa v33, v32 dst_sel:WORD_0 dst_unused:UNUSED_PAD src0_sel:WORD_0
  v_mfma_f32_16x16x32_bf16 v[96:99], v[56:59], v[120:123], v[96:99]
  v_rcp_f16_sdwa v33, v32 dst_sel:WORD_1 dst_unused:UNUSED_PRESERVE src0_sel:WORD_1
  v_mfma_f32_16x16x32_bf16 v[100:103], v[56:59], v[124:127], v[100:103]
  v_fma_mix_f32 v32, v84, v33, 0 op_sel_hi:[0,1,0]
  v_fma_mix_f32 v33, v85, v33, 0 op_sel:[0,1,0] op_sel_hi:[0,1,0]
  v_cvt_pk_bf16_f32 v38, v32, v33
  s_waitcnt lgkmcnt(3)
  v_mfma_f32_16x16x32_bf16 v[92:95], v[60:63], v[128:131], v[92:95]
  ds_read_b128 v[56:59], v16 offset:29696
  ds_read_b128 v[76:79], v18 offset:14336
  v_cvt_pk_f16_f32 v34, v86, v87
  v_pk_fma_f16 v35, v34, v34, s92
  v_mfma_f32_16x16x32_bf16 v[96:99], v[60:63], v[132:135], v[96:99]
  v_pk_mul_f16 v35, v35, v34 neg_lo:[1,0] neg_hi:[1,0]
  v_exp_f16_sdwa v34, v35 dst_sel:WORD_0 dst_unused:UNUSED_PAD src0_sel:WORD_0
  v_mfma_f32_16x16x32_bf16 v[100:103], v[60:63], v[136:139], v[100:103]
  v_exp_f16_sdwa v34, v35 dst_sel:WORD_1 dst_unused:UNUSED_PRESERVE src0_sel:WORD_1
  s_cmp_eq_u32 s35, 0
  s_cbranch_scc1 standalone__convnext_block__vision_kernel_ws24_2
  buffer_load_dwordx4 v20, s[8:11], s94 offen offset:2048 lds
standalone__convnext_block__vision_kernel_ws24_2:
  v_mfma_f32_16x16x32_bf16 v[92:95], v[64:67], v[140:143], v[92:95]
  ds_read_b128 v[60:63], v16 offset:36864
  v_pk_fma_f16 v34, v34, s93, s93
  v_rcp_f16_sdwa v35, v34 dst_sel:WORD_0 dst_unused:UNUSED_PAD src0_sel:WORD_0
  v_mfma_f32_16x16x32_bf16 v[96:99], v[64:67], v[144:147], v[96:99]
  v_rcp_f16_sdwa v35, v34 dst_sel:WORD_1 dst_unused:UNUSED_PRESERVE src0_sel:WORD_1
  v_mfma_f32_16x16x32_bf16 v[100:103], v[64:67], v[148:151], v[100:103]
  v_fma_mix_f32 v34, v86, v35, 0 op_sel_hi:[0,1,0]
  v_fma_mix_f32 v35, v87, v35, 0 op_sel:[0,1,0] op_sel_hi:[0,1,0]
  v_cvt_pk_bf16_f32 v39, v34, v35
  ds_write_b64 v19, v[38:39] offset:1024
  s_setprio 2
  s_waitcnt lgkmcnt(3)
  v_mfma_f32_16x16x32_bf16 v[92:95], v[52:55], v[152:155], v[92:95]
  ds_read_b128 v[64:67], v16 offset:37888
  v_cvt_pk_f16_f32 v32, v88, v89
  v_pk_fma_f16 v33, v32, v32, s92
  v_mfma_f32_16x16x32_bf16 v[96:99], v[52:55], v[156:159], v[96:99]
  v_pk_mul_f16 v33, v33, v32 neg_lo:[1,0] neg_hi:[1,0]
  v_exp_f16_sdwa v32, v33 dst_sel:WORD_0 dst_unused:UNUSED_PAD src0_sel:WORD_0
  v_mfma_f32_16x16x32_bf16 v[100:103], v[52:55], v[160:163], v[100:103]
  v_exp_f16_sdwa v32, v33 dst_sel:WORD_1 dst_unused:UNUSED_PRESERVE src0_sel:WORD_1
  v_mfma_f32_16x16x32_bf16 v[92:95], v[56:59], v[164:167], v[92:95]
  ds_read_b128 v[52:55], v16 offset:38912
  v_pk_fma_f16 v32, v32, s93, s93
  v_rcp_f16_sdwa v33, v32 dst_sel:WORD_0 dst_unused:UNUSED_PAD src0_sel:WORD_0
  v_mfma_f32_16x16x32_bf16 v[96:99], v[56:59], v[168:171], v[96:99]
  v_rcp_f16_sdwa v33, v32 dst_sel:WORD_1 dst_unused:UNUSED_PRESERVE src0_sel:WORD_1
  v_mfma_f32_16x16x32_bf16 v[100:103], v[56:59], v[172:175], v[100:103]
  v_fma_mix_f32 v32, v88, v33, 0 op_sel_hi:[0,1,0]
  v_fma_mix_f32 v33, v89, v33, 0 op_sel:[0,1,0] op_sel_hi:[0,1,0]
  v_cvt_pk_bf16_f32 v36, v32, v33
  s_waitcnt lgkmcnt(1)
  v_mfma_f32_16x16x32_bf16 v[176:179], v[60:63], v[68:71], v[176:179]
  ds_read_b128 v[56:59], v16 offset:39936
  v_cvt_pk_f16_f32 v34, v90, v91
  v_pk_fma_f16 v35, v34, v34, s92
  v_mfma_f32_16x16x32_bf16 v[184:187], v[60:63], v[72:75], v[184:187]
  v_pk_mul_f16 v35, v35, v34 neg_lo:[1,0] neg_hi:[1,0]
  v_exp_f16_sdwa v34, v35 dst_sel:WORD_0 dst_unused:UNUSED_PAD src0_sel:WORD_0
  v_mfma_f32_16x16x32_bf16 v[192:195], v[60:63], v[76:79], v[192:195]
  v_exp_f16_sdwa v34, v35 dst_sel:WORD_1 dst_unused:UNUSED_PRESERVE src0_sel:WORD_1
  v_lshrrev_b32 v30, 3, v1
  s_add_u32 s71, s59, 0
  buffer_load_ushort v104, v30, s[12:15], s71 offen offset:0
  s_setprio 1
  v_mfma_f32_16x16x32_bf16 v[180:183], v[64:67], v[68:71], v[180:183]
  ds_read_b128 v[60:63], v16 offset:40960
  v_pk_fma_f16 v34, v34, s93, s93
  v_rcp_f16_sdwa v35, v34 dst_sel:WORD_0 dst_unused:UNUSED_PAD src0_sel:WORD_0
  v_mfma_f32_16x16x32_bf16 v[188:191], v[64:67], v[72:75], v[188:191]
  v_rcp_f16_sdwa v35, v34 dst_sel:WORD_1 dst_unused:UNUSED_PRESERVE src0_sel:WORD_1
  v_mfma_f32_16x16x32_bf16 v[196:199], v[64:67], v[76:79], v[196:199]
  v_fma_mix_f32 v34, v90, v35, 0 op_sel_hi:[0,1,0]
  v_fma_mix_f32 v35, v91, v35, 0 op_sel:[0,1,0] op_sel_hi:[0,1,0]
  v_cvt_pk_bf16_f32 v37, v34, v35
  ds_write_b64 v19, v[36:37] offset:2048
  buffer_load_ushort v105, v30, s[12:15], s71 offen offset:384
  s_setprio 0
  s_waitcnt lgkmcnt(2)
  v_mfma_f32_16x16x32_bf16 v[200:203], v[52:55], v[68:71], v[200:203]
  ds_read_b128 v[64:67], v16 offset:41984
  v_cvt_pk_f16_f32 v32, v92, v93
  v_pk_fma_f16 v33, v32, v32, s92
  v_mfma_f32_16x16x32_bf16 v[208:211], v[52:55], v[72:75], v[208:211]
  v_pk_mul_f16 v33, v33, v32 neg_lo:[1,0] neg_hi:[1,0]
  v_exp_f16_sdwa v32, v33 dst_sel:WORD_0 dst_unused:UNUSED_PAD src0_sel:WORD_0
  v_mfma_f32_16x16x32_bf16 v[216:219], v[52:55], v[76:79], v[216:219]
  v_exp_f16_sdwa v32, v33 dst_sel:WORD_1 dst_unused:UNUSED_PRESERVE src0_sel:WORD_1
  buffer_load_ushort v106, v30, s[12:15], s71 offen offset:768
  v_mfma_f32_16x16x32_bf16 v[204:207], v[56:59], v[68:71], v[204:207]
  s_waitcnt lgkmcnt(0)
  s_barrier
  s_setprio 3
  ds_read_b128 v[52:55], v17 offset:12288
  v_pk_fma_f16 v32, v32, s93, s93
  v_rcp_f16_sdwa v33, v32 dst_sel:WORD_0 dst_unused:UNUSED_PAD src0_sel:WORD_0
  v_mfma_f32_16x16x32_bf16 v[212:215], v[56:59], v[72:75], v[212:215]
  v_rcp_f16_sdwa v33, v32 dst_sel:WORD_1 dst_unused:UNUSED_PRESERVE src0_sel:WORD_1
  v_mfma_f32_16x16x32_bf16 v[220:223], v[56:59], v[76:79], v[220:223]
  v_fma_mix_f32 v32, v92, v33, 0 op_sel_hi:[0,1,0]
  v_fma_mix_f32 v33, v93, v33, 0 op_sel:[0,1,0] op_sel_hi:[0,1,0]
  v_cvt_pk_bf16_f32 v36, v32, v33
  buffer_load_ushort v107, v30, s[12:15], s71 offen offset:1152
  v_mfma_f32_16x16x32_bf16 v[224:227], v[60:63], v[68:71], v[224:227]
  ds_read_b128 v[56:59], v17 offset:13312
  v_cvt_pk_f16_f32 v34, v94, v95
  v_pk_fma_f16 v35, v34, v34, s92
  v_mfma_f32_16x16x32_bf16 v[232:235], v[60:63], v[72:75], v[232:235]
  v_pk_mul_f16 v35, v35, v34 neg_lo:[1,0] neg_hi:[1,0]
  v_exp_f16_sdwa v34, v35 dst_sel:WORD_0 dst_unused:UNUSED_PAD src0_sel:WORD_0
  v_mfma_f32_16x16x32_bf16 v[240:243], v[60:63], v[76:79], v[240:243]
  v_exp_f16_sdwa v34, v35 dst_sel:WORD_1 dst_unused:UNUSED_PRESERVE src0_sel:WORD_1
  buffer_load_ushort v108, v30, s[12:15], s71 offen offset:1536
  v_mfma_f32_16x16x32_bf16 v[228:231], v[64:67], v[68:71], v[228:231]
  ds_read_b128 v[60:63], v17 offset:14336
  v_pk_fma_f16 v34, v34, s93, s93
  v_rcp_f16_sdwa v35, v34 dst_sel:WORD_0 dst_unused:UNUSED_PAD src0_sel:WORD_0
  v_mfma_f32_16x16x32_bf16 v[236:239], v[64:67], v[72:75], v[236:239]
  v_rcp_f16_sdwa v35, v34 dst_sel:WORD_1 dst_unused:UNUSED_PRESERVE src0_sel:WORD_1
  v_mfma_f32_16x16x32_bf16 v[244:247], v[64:67], v[76:79], v[244:247]
  v_fma_mix_f32 v34, v94, v35, 0 op_sel_hi:[0,1,0]
  v_fma_mix_f32 v35, v95, v35, 0 op_sel:[0,1,0] op_sel_hi:[0,1,0]
  v_cvt_pk_bf16_f32 v37, v34, v35
  ds_write_b64 v19, v[36:37] offset:12288
  buffer_load_ushort v109, v30, s[12:15], s71 offen offset:1920
  ds_read_b128 v[68:71], v18 offset:0
  ds_read_b128 v[72:75], v18 offset:1024
  ds_read_b128 v[76:79], v18 offset:2048
  v_cvt_pk_f16_f32 v32, v96, v97
  v_pk_fma_f16 v33, v32, v32, s92
  s_nop 0
  v_pk_mul_f16 v33, v33, v32 neg_lo:[1,0] neg_hi:[1,0]
  v_exp_f16_sdwa v32, v33 dst_sel:WORD_0 dst_unused:UNUSED_PAD src0_sel:WORD_0
  s_nop 0
  v_exp_f16_sdwa v32, v33 dst_sel:WORD_1 dst_unused:UNUSED_PRESERVE src0_sel:WORD_1
  s_sub_u32 s31, s32, 3
  s_mul_i32 s31, s31, 384
  s_add_u32 s31, s31, s45
  s_sub_u32 s31, s31, 3
  s_mul_i32 s31, s31, 384
  s_add_u32 s31, s31, 128
  s_cmp_gt_i32 s100, 0
  s_cbranch_scc0 standalone__convnext_block__vision_kernel_xbe0
  s_add_u32 m0, s58, 0
  v_add_u32 v120, s31, v2
  buffer_load_dwordx4 v120, s[4:7], 0 offen lds
standalone__convnext_block__vision_kernel_xbe0:
  buffer_load_ushort v110, v30, s[12:15], s71 offen offset:2304
  s_waitcnt lgkmcnt(0)
  v_mfma_f32_16x16x32_bf16 v[176:179], v[52:55], v[68:71], v[176:179]
  ds_read_b128 v[64:67], v17 offset:15360
  v_pk_fma_f16 v32, v32, s93, s93
  v_rcp_f16_sdwa v33, v32 dst_sel:WORD_0 dst_unused:UNUSED_PAD src0_sel:WORD_0
  v_mfma_f32_16x16x32_bf16 v[184:187], v[52:55], v[72:75], v[184:187]
  v_rcp_f16_sdwa v33, v32 dst_sel:WORD_1 dst_unused:UNUSED_PRESERVE src0_sel:WORD_1
  v_mfma_f32_16x16x32_bf16 v[192:195], v[52:55], v[76:79], v[192:195]
  v_fma_mix_f32 v32, v96, v33, 0 op_sel_hi:[0,1,0]
  v_fma_mix_f32 v33, v97, v33, 0 op_sel:[0,1,0] op_sel_hi:[0,1,0]
  v_cvt_pk_bf16_f32 v38, v32, v33
  s_cmp_gt_i32 s100, 1
  s_cbranch_scc0 standalone__convnext_block__vision_kernel_xbe1
  s_add_u32 m0, s58, 1024
  v_add_u32 v121, s31, v3
  buffer_load_dwordx4 v121, s[4:7], 0 offen lds
standalone__convnext_block__vision_kernel_xbe1:
  s_add_u32 s71, s59, 128
  buffer_load_ushort v112, v30, s[12:15], s71 offen offset:0
  v_mfma_f32_16x16x32_bf16 v[180:183], v[56:59], v[68:71], v[180:183]
  ds_read_b128 v[52:55], v17 offset:16384
  v_cvt_pk_f16_f32 v34, v98, v99
  v_pk_fma_f16 v35, v34, v34, s92
  v_mfma_f32_16x16x32_bf16 v[188:191], v[56:59], v[72:75], v[188:191]
  v_pk_mul_f16 v35, v35, v34 neg_lo:[1,0] neg_hi:[1,0]
  v_exp_f16_sdwa v34, v35 dst_sel:WORD_0 dst_unused:UNUSED_PAD src0_sel:WORD_0
  v_mfma_f32_16x16x32_bf16 v[196:199], v[56:59], v[76:79], v[196:199]
  v_exp_f16_sdwa v34, v35 dst_sel:WORD_1 dst_unused:UNUSED_PRESERVE src0_sel:WORD_1
  s_cmp_gt_i32 s100, 2
  s_cbranch_scc0 standalone__convnext_block__vision_kernel_xbe2
  s_add_u32 m0, s58, 2048
  v_add_u32 v120, s31, v4
  buffer_load_dwordx4 v120, s[4:7], 0 offen lds
standalone__convnext_block__vision_kernel_xbe2:
  buffer_load_ushort v113, v30, s[12:15], s71 offen offset:384
  v_mfma_f32_16x16x32_bf16 v[200:203], v[60:63], v[68:71], v[200:203]
  ds_read_b128 v[56:59], v17 offset:17408
  v_pk_fma_f16 v34, v34, s93, s93
  v_rcp_f16_sdwa v35, v34 dst_sel:WORD_0 dst_unused:UNUSED_PAD src0_sel:WORD_0
  v_mfma_f32_16x16x32_bf16 v[208:211], v[60:63], v[72:75], v[208:211]
  v_rcp_f16_sdwa v35, v34 dst_sel:WORD_1 dst_unused:UNUSED_PRESERVE src0_sel:WORD_1
  v_mfma_f32_16x16x32_bf16 v[216:219], v[60:63], v[76:79], v[216:219]
  v_fma_mix_f32 v34, v98, v35, 0 op_sel_hi:[0,1,0]
  v_fma_mix_f32 v35, v99, v35, 0 op_sel:[0,1,0] op_sel_hi:[0,1,0]
  v_cvt_pk_bf16_f32 v39, v34, v35
  ds_write_b64 v19, v[38:39] offset:13312
  s_cmp_gt_i32 s100, 3
  s_cbranch_scc0 standalone__convnext_block__vision_kernel_xbe3
  s_add_u32 m0, s58, 3072
  v_add_u32 v121, s31, v5
  buffer_load_dwordx4 v121, s[4:7], 0 offen lds
standalone__convnext_block__vision_kernel_xbe3:
  buffer_load_ushort v114, v30, s[12:15], s71 offen offset:768
  s_setprio 2
  s_waitcnt lgkmcnt(3)
  v_mfma_f32_16x16x32_bf16 v[204:207], v[64:67], v[68:71], v[204:207]
  v_cvt_pk_f16_f32 v32, v100, v101
  v_pk_fma_f16 v33, v32, v32, s92
  v_mfma_f32_16x16x32_bf16 v[212:215], v[64:67], v[72:75], v[212:215]
  v_pk_mul_f16 v33, v33, v32 neg_lo:[1,0] neg_hi:[1,0]
  v_exp_f16_sdwa v32, v33 dst_sel:WORD_0 dst_unused:UNUSED_PAD src0_sel:WORD_0
  v_mfma_f32_16x16x32_bf16 v[220:223], v[64:67], v[76:79], v[220:223]
  v_exp_f16_sdwa v32, v33 dst_sel:WORD_1 dst_unused:UNUSED_PRESERVE src0_sel:WORD_1
  s_cmp_gt_i32 s100, 4
  s_cbranch_scc0 standalone__convnext_block__vision_kernel_xbe4
  s_add_u32 m0, s58, 4096
  v_add_u32 v120, s31, v6
  buffer_load_dwordx4 v120, s[4:7], 0 offen lds
standalone__convnext_block__vision_kernel_xbe4:
  buffer_load_ushort v115, v30, s[12:15], s71 offen offset:1152
  s_waitcnt lgkmcnt(2)
  v_mfma_f32_16x16x32_bf16 v[224:227], v[52:55], v[68:71], v[224:227]
  v_pk_fma_f16 v32, v32, s93, s93
  v_rcp_f16_sdwa v33, v32 dst_sel:WORD_0 dst_unused:UNUSED_PAD src0_sel:WORD_0
  v_mfma_f32_16x16x32_bf16 v[232:235], v[52:55], v[72:75], v[232:235]
  v_rcp_f16_sdwa v33, v32 dst_sel:WORD_1 dst_unused:UNUSED_PRESERVE src0_sel:WORD_1
  v_mfma_f32_16x16x32_bf16 v[240:243], v[52:55], v[76:79], v[240:243]
  v_fma_mix_f32 v32, v100, v33, 0 op_sel_hi:[0,1,0]
  v_fma_mix_f32 v33, v101, v33, 0 op_sel:[0,1,0] op_sel_hi:[0,1,0]
  v_cvt_pk_bf16_f32 v36, v32, v33
  s_cmp_gt_i32 s100, 5
  s_cbranch_scc0 standalone__convnext_block__vision_kernel_xbe5
  s_add_u32 m0, s58, 5120
  v_add_u32 v121, s31, v7
  buffer_load_dwordx4 v121, s[4:7], 0 offen lds
standalone__convnext_block__vision_kernel_xbe5:
  buffer_load_ushort v116, v30, s[12:15], s71 offen offset:1536
  s_waitcnt lgkmcnt(1)
  v_mfma_f32_16x16x32_bf16 v[228:231], v[56:59], v[68:71], v[228:231]
  v_cvt_pk_f16_f32 v34, v102, v103
  v_pk_fma_f16 v35, v34, v34, s92
  v_mfma_f32_16x16x32_bf16 v[236:239], v[56:59], v[72:75], v[236:239]
  v_pk_mul_f16 v35, v35, v34 neg_lo:[1,0] neg_hi:[1,0]
  v_exp_f16_sdwa v34, v35 dst_sel:WORD_0 dst_unused:UNUSED_PAD src0_sel:WORD_0
  v_mfma_f32_16x16x32_bf16 v[244:247], v[56:59], v[76:79], v[244:247]
  v_exp_f16_sdwa v34, v35 dst_sel:WORD_1 dst_unused:UNUSED_PRESERVE src0_sel:WORD_1
  s_cmp_gt_i32 s100, 6
  s_cbranch_scc0 standalone__convnext_block__vision_kernel_xbe6
  s_add_u32 m0, s58, 6144
  v_add_u32 v120, s31, v8
  buffer_load_dwordx4 v120, s[4:7], 0 offen lds
standalone__convnext_block__vision_kernel_xbe6:
  buffer_load_ushort v117, v30, s[12:15], s71 offen offset:1920
  s_setprio 1
  v_pk_fma_f16 v34, v34, s93, s93
  v_rcp_f16_sdwa v35, v34 dst_sel:WORD_0 dst_unused:UNUSED_PAD src0_sel:WORD_0
  s_nop 0
  v_rcp_f16_sdwa v35, v34 dst_sel:WORD_1 dst_unused:UNUSED_PRESERVE src0_sel:WORD_1
  s_nop 0
  v_fma_mix_f32 v34, v102, v35, 0 op_sel_hi:[0,1,0]
  v_fma_mix_f32 v35, v103, v35, 0 op_sel:[0,1,0] op_sel_hi:[0,1,0]
  v_cvt_pk_bf16_f32 v37, v34, v35
  ds_write_b64 v19, v[36:37] offset:14336
  buffer_load_ushort v118, v30, s[12:15], s71 offen offset:2304
  s_waitcnt vmcnt(14)
  s_waitcnt lgkmcnt(0)
  s_barrier
  ds_read_b128 v[68:71], v18 offset:12288
  ds_read_b128 v[72:75], v18 offset:13312
  ds_read_b128 v[76:79], v18 offset:14336
  ds_read_b128 v[60:63], v17 offset:0
  ds_read_b128 v[64:67], v17 offset:1024
  ds_read_b128 v[52:55], v17 offset:2048
  s_cmp_eq_u32 s56, 2
  s_cbranch_scc1 standalone__convnext_block__vision_kernel_final
  s_waitcnt lgkmcnt(2)
  v_mfma_f32_16x16x32_bf16 v[176:179], v[60:63], v[68:71], v[176:179]
  ds_read_b128 v[56:59], v17 offset:3072
  v_mfma_f32_16x16x32_bf16 v[184:187], v[60:63], v[72:75], v[184:187]
  v_mfma_f32_16x16x32_bf16 v[192:195], v[60:63], v[76:79], v[192:195]
  s_waitcnt lgkmcnt(2)
  v_mfma_f32_16x16x32_bf16 v[180:183], v[64:67], v[68:71], v[180:183]
  ds_read_b128 v[60:63], v17 offset:4096
  v_mfma_f32_16x16x32_bf16 v[188:191], v[64:67], v[72:75], v[188:191]
  v_mfma_f32_16x16x32_bf16 v[196:199], v[64:67], v[76:79], v[196:199]
  s_waitcnt lgkmcnt(2)
  v_mfma_f32_16x16x32_bf16 v[200:203], v[52:55], v[68:71], v[200:203]
  ds_read_b128 v[64:67], v17 offset:5120
  v_mfma_f32_16x16x32_bf16 v[208:211], v[52:55], v[72:75], v[208:211]
  v_mfma_f32_16x16x32_bf16 v[216:219], v[52:55], v[76:79], v[216:219]
  s_waitcnt lgkmcnt(2)
  v_mfma_f32_16x16x32_bf16 v[204:207], v[56:59], v[68:71], v[204:207]
  s_waitcnt lgkmcnt(0)
  s_barrier
  s_waitcnt vmcnt(0)
  v_lshl_or_b32 v80, v105, 16, v104
  v_lshl_or_b32 v81, v107, 16, v106
  v_lshl_or_b32 v82, v109, 16, v108
  v_mov_b32 v83, v110
  v_lshlrev_b32 v84, 16, v104
  v_lshl_or_b32 v85, v106, 16, v105
  v_lshl_or_b32 v86, v108, 16, v107
  v_lshl_or_b32 v87, v110, 16, v109
  v_mul_u32_u24 v30, 15, v1
  s_lshl_b32 s24, s3, 5
  s_add_u32 s24, s24, 73728
  v_add_u32 v30, s24, v30
  s_cmp_eq_u32 s3, 7
  s_cselect_b32 s24, 0, 16
  v_add_u32 v31, s24, v30
  ds_write_b128 v30, v[80:83]
  ds_write_b128 v31, v[84:87]
  v_lshl_or_b32 v88, v113, 16, v112
  v_lshl_or_b32 v89, v115, 16, v114
  v_lshl_or_b32 v90, v117, 16, v116
  v_mov_b32 v91, v118
  v_lshlrev_b32 v92, 16, v112
  v_lshl_or_b32 v93, v114, 16, v113
  v_lshl_or_b32 v94, v116, 16, v115
  v_lshl_or_b32 v95, v118, 16, v117
  v_mul_u32_u24 v30, 15, v1
  s_lshl_b32 s24, s3, 5
  s_add_u32 s24, s24, 57344
  v_add_u32 v30, s24, v30
  s_cmp_eq_u32 s3, 7
  s_cselect_b32 s24, 0, 16
  v_add_u32 v31, s24, v30
  ds_write_b128 v30, v[88:91]
  ds_write_b128 v31, v[92:95]
  s_cmp_lt_u32 s3, 6
  s_cbranch_scc1 standalone__convnext_block__vision_kernel_xblate
  s_cmp_gt_i32 s100, 0
  s_cbranch_scc1 standalone__convnext_block__vision_kernel_xbl0
  s_add_u32 m0, s58, 0
  v_add_u32 v30, s31, v2
  buffer_load_dwordx4 v30, s[4:7], 0 offen lds
standalone__convnext_block__vision_kernel_xbl0:
  s_cmp_gt_i32 s100, 1
  s_cbranch_scc1 standalone__convnext_block__vision_kernel_xbl1
  s_add_u32 m0, s58, 1024
  v_add_u32 v31, s31, v3
  buffer_load_dwordx4 v31, s[4:7], 0 offen lds
standalone__convnext_block__vision_kernel_xbl1:
  s_cmp_gt_i32 s100, 2
  s_cbranch_scc1 standalone__convnext_block__vision_kernel_xbl2
  s_add_u32 m0, s58, 2048
  v_add_u32 v30, s31, v4
  buffer_load_dwordx4 v30, s[4:7], 0 offen lds
standalone__convnext_block__vision_kernel_xbl2:
  s_cmp_gt_i32 s100, 3
  s_cbranch_scc1 standalone__convnext_block__vision_kernel_xbl3
  s_add_u32 m0, s58, 3072
  v_add_u32 v31, s31, v5
  buffer_load_dwordx4 v31, s[4:7], 0 offen lds
standalone__convnext_block__vision_kernel_xbl3:
  s_cmp_gt_i32 s100, 4
  s_cbranch_scc1 standalone__convnext_block__vision_kernel_xbl4
  s_add_u32 m0, s58, 4096
  v_add_u32 v30, s31, v6
  buffer_load_dwordx4 v30, s[4:7], 0 offen lds
standalone__convnext_block__vision_kernel_xbl4:
  s_cmp_gt_i32 s100, 5
  s_cbranch_scc1 standalone__convnext_block__vision_kernel_xbl5
  s_add_u32 m0, s58, 5120
  v_add_u32 v31, s31, v7
  buffer_load_dwordx4 v31, s[4:7], 0 offen lds
standalone__convnext_block__vision_kernel_xbl5:
  s_cmp_gt_i32 s100, 6
  s_cbranch_scc1 standalone__convnext_block__vision_kernel_xbl6
  s_add_u32 m0, s58, 6144
  v_add_u32 v30, s31, v8
  buffer_load_dwordx4 v30, s[4:7], 0 offen lds
standalone__convnext_block__vision_kernel_xbl6:
standalone__convnext_block__vision_kernel_xblate:
  v_mfma_f32_16x16x32_bf16 v[212:215], v[56:59], v[72:75], v[212:215]
  v_mfma_f32_16x16x32_bf16 v[220:223], v[56:59], v[76:79], v[220:223]
  v_mfma_f32_16x16x32_bf16 v[224:227], v[60:63], v[68:71], v[224:227]
  v_mfma_f32_16x16x32_bf16 v[232:235], v[60:63], v[72:75], v[232:235]
  v_mfma_f32_16x16x32_bf16 v[240:243], v[60:63], v[76:79], v[240:243]
  v_mfma_f32_16x16x32_bf16 v[228:231], v[64:67], v[68:71], v[228:231]
  v_mfma_f32_16x16x32_bf16 v[236:239], v[64:67], v[72:75], v[236:239]
  v_mfma_f32_16x16x32_bf16 v[244:247], v[64:67], v[76:79], v[244:247]
  s_setprio 0
  s_nop 7
  s_mov_b32 s54, s55
  v_cvt_pk_bf16_f32 v176, v176, v177
  v_cvt_pk_bf16_f32 v177, v178, v179
  v_cvt_pk_bf16_f32 v178, v180, v181
  v_cvt_pk_bf16_f32 v179, v182, v183
  v_cvt_pk_bf16_f32 v184, v184, v185
  v_cvt_pk_bf16_f32 v185, v186, v187
  v_cvt_pk_bf16_f32 v186, v188, v189
  v_cvt_pk_bf16_f32 v187, v190, v191
  v_cvt_pk_bf16_f32 v192, v192, v193
  v_cvt_pk_bf16_f32 v193, v194, v195
  v_cvt_pk_bf16_f32 v194, v196, v197
  v_cvt_pk_bf16_f32 v195, v198, v199
  v_cvt_pk_bf16_f32 v200, v200, v201
  v_cvt_pk_bf16_f32 v201, v202, v203
  v_cvt_pk_bf16_f32 v202, v204, v205
  v_cvt_pk_bf16_f32 v203, v206, v207
  v_cvt_pk_bf16_f32 v208, v208, v209
  v_cvt_pk_bf16_f32 v209, v210, v211
  v_cvt_pk_bf16_f32 v210, v212, v213
  v_cvt_pk_bf16_f32 v211, v214, v215
  v_cvt_pk_bf16_f32 v216, v216, v217
  v_cvt_pk_bf16_f32 v217, v218, v219
  v_cvt_pk_bf16_f32 v218, v220, v221
  v_cvt_pk_bf16_f32 v219, v222, v223
  v_cvt_pk_bf16_f32 v224, v224, v225
  v_cvt_pk_bf16_f32 v225, v226, v227
  v_cvt_pk_bf16_f32 v226, v228, v229
  v_cvt_pk_bf16_f32 v227, v230, v231
  v_cvt_pk_bf16_f32 v232, v232, v233
  v_cvt_pk_bf16_f32 v233, v234, v235
  v_cvt_pk_bf16_f32 v234, v236, v237
  v_cvt_pk_bf16_f32 v235, v238, v239
  v_cvt_pk_bf16_f32 v240, v240, v241
  v_cvt_pk_bf16_f32 v241, v242, v243
  v_cvt_pk_bf16_f32 v242, v244, v245
  v_cvt_pk_bf16_f32 v243, v246, v247
  s_add_u32 s55, s55, 2359296
  s_waitcnt lgkmcnt(0)
  s_barrier
  s_add_u32 s56, s56, 1
  s_cmp_lt_u32 s56, 3
  s_cbranch_scc1 standalone__convnext_block__vision_kernel_L
standalone__convnext_block__vision_kernel_final:
  s_waitcnt lgkmcnt(2)
  v_mfma_f32_16x16x32_bf16 v[176:179], v[60:63], v[68:71], v[176:179]
  ds_read_b128 v[56:59], v17 offset:3072
  v_mfma_f32_16x16x32_bf16 v[184:187], v[60:63], v[72:75], v[184:187]
  v_mfma_f32_16x16x32_bf16 v[192:195], v[60:63], v[76:79], v[192:195]
  s_waitcnt lgkmcnt(2)
  v_mfma_f32_16x16x32_bf16 v[180:183], v[64:67], v[68:71], v[180:183]
  ds_read_b128 v[60:63], v17 offset:4096
  v_mfma_f32_16x16x32_bf16 v[188:191], v[64:67], v[72:75], v[188:191]
  v_mfma_f32_16x16x32_bf16 v[196:199], v[64:67], v[76:79], v[196:199]
  s_waitcnt lgkmcnt(2)
  v_mfma_f32_16x16x32_bf16 v[200:203], v[52:55], v[68:71], v[200:203]
  ds_read_b128 v[64:67], v17 offset:5120
  v_mfma_f32_16x16x32_bf16 v[208:211], v[52:55], v[72:75], v[208:211]
  v_mfma_f32_16x16x32_bf16 v[216:219], v[52:55], v[76:79], v[216:219]
  s_waitcnt lgkmcnt(2)
  v_mfma_f32_16x16x32_bf16 v[204:207], v[56:59], v[68:71], v[204:207]
  v_mfma_f32_16x16x32_bf16 v[212:215], v[56:59], v[72:75], v[212:215]
  v_mfma_f32_16x16x32_bf16 v[220:223], v[56:59], v[76:79], v[220:223]
  v_cvt_pk_bf16_f32 v176, v176, v177
  v_cvt_pk_bf16_f32 v177, v178, v179
  v_cvt_pk_bf16_f32 v178, v180, v181
  v_cvt_pk_bf16_f32 v179, v182, v183
  buffer_store_dwordx4 v[176:179], v21, s[20:23], s55 offen offset:0 sc1
  v_cvt_pk_bf16_f32 v184, v184, v185
  v_cvt_pk_bf16_f32 v185, v186, v187
  v_cvt_pk_bf16_f32 v186, v188, v189
  v_cvt_pk_bf16_f32 v187, v190, v191
  buffer_store_dwordx4 v[184:187], v22, s[20:23], s55 offen offset:0 sc1
  v_cvt_pk_bf16_f32 v192, v192, v193
  v_cvt_pk_bf16_f32 v193, v194, v195
  v_cvt_pk_bf16_f32 v194, v196, v197
  v_cvt_pk_bf16_f32 v195, v198, v199
  buffer_store_dwordx4 v[192:195], v23, s[20:23], s55 offen offset:0 sc1
  s_waitcnt lgkmcnt(1)
  v_mfma_f32_16x16x32_bf16 v[224:227], v[60:63], v[68:71], v[224:227]
  v_mfma_f32_16x16x32_bf16 v[232:235], v[60:63], v[72:75], v[232:235]
  v_mfma_f32_16x16x32_bf16 v[240:243], v[60:63], v[76:79], v[240:243]
  s_waitcnt lgkmcnt(0)
  v_mfma_f32_16x16x32_bf16 v[228:231], v[64:67], v[68:71], v[228:231]
  v_mfma_f32_16x16x32_bf16 v[236:239], v[64:67], v[72:75], v[236:239]
  v_mfma_f32_16x16x32_bf16 v[244:247], v[64:67], v[76:79], v[244:247]
  v_cvt_pk_bf16_f32 v200, v200, v201
  v_cvt_pk_bf16_f32 v201, v202, v203
  v_cvt_pk_bf16_f32 v202, v204, v205
  v_cvt_pk_bf16_f32 v203, v206, v207
  buffer_store_dwordx4 v[200:203], v21, s[20:23], s55 offen offset:64 sc1
  v_cvt_pk_bf16_f32 v208, v208, v209
  v_cvt_pk_bf16_f32 v209, v210, v211
  v_cvt_pk_bf16_f32 v210, v212, v213
  v_cvt_pk_bf16_f32 v211, v214, v215
  buffer_store_dwordx4 v[208:211], v22, s[20:23], s55 offen offset:64 sc1
  v_cvt_pk_bf16_f32 v216, v216, v217
  v_cvt_pk_bf16_f32 v217, v218, v219
  v_cvt_pk_bf16_f32 v218, v220, v221
  v_cvt_pk_bf16_f32 v219, v222, v223
  buffer_store_dwordx4 v[216:219], v23, s[20:23], s55 offen offset:64 sc1
  s_nop 7
  v_cvt_pk_bf16_f32 v224, v224, v225
  v_cvt_pk_bf16_f32 v225, v226, v227
  v_cvt_pk_bf16_f32 v226, v228, v229
  v_cvt_pk_bf16_f32 v227, v230, v231
  buffer_store_dwordx4 v[224:227], v21, s[20:23], s55 offen offset:128 sc1
  v_cvt_pk_bf16_f32 v232, v232, v233
  v_cvt_pk_bf16_f32 v233, v234, v235
  v_cvt_pk_bf16_f32 v234, v236, v237
  v_cvt_pk_bf16_f32 v235, v238, v239
  buffer_store_dwordx4 v[232:235], v22, s[20:23], s55 offen offset:128 sc1
  v_cvt_pk_bf16_f32 v240, v240, v241
  v_cvt_pk_bf16_f32 v241, v242, v243
  v_cvt_pk_bf16_f32 v242, v244, v245
  v_cvt_pk_bf16_f32 v243, v246, v247
  buffer_store_dwordx4 v[240:243], v23, s[20:23], s55 offen offset:128 sc1
standalone__convnext_block__vision_kernel_end:
  s_endpgm
.section .rodata,"a"
.p2align 6
.amdhsa_kernel standalone__convnext_block__vision_kernel
  .amdhsa_next_free_vgpr 256
  .amdhsa_next_free_sgpr 102
  .amdhsa_accum_offset 256
  .amdhsa_group_segment_fixed_size 0
  .amdhsa_kernarg_size 56
  .amdhsa_user_sgpr_count 2
  .amdhsa_user_sgpr_kernarg_segment_ptr 1
  .amdhsa_system_sgpr_workgroup_id_x 1
  .amdhsa_float_denorm_mode_32 3
.end_amdhsa_kernel
.text
```
